```python
import torch

def _softmax(x, axis=-1):
    return torch.softmax(x, dim=axis)
def _gelu(x):
    return torch.nn.functional.gelu(x, approximate="tanh")
def _silu(x):
    return torch.nn.functional.silu(x)
def _sigmoid(x):
    return torch.sigmoid(x)
def _layernorm(x, axis=-1, eps=1e-5):
    m = x.mean(dim=axis, keepdim=True)
    v = x.var(dim=axis, keepdim=True, unbiased=False)
    return (x - m) / torch.sqrt(v + eps)
def _scatter_add(tgt, idx, src, axis=0):
    return tgt.clone().index_add_(axis, idx, src)
def _segment_sum(src, seg, n):
    out = torch.zeros((n,) + src.shape[1:], dtype=src.dtype)
    return out.index_add_(0, seg, src)
def _pad(x, pw):
    flat = tuple(v for pair in reversed(pw) for v in pair)
    return torch.nn.functional.pad(x, flat)

kernel_name = 'sequential_preLN__linear_kernel_hedgehog__glu_gated_bilinear__prompt'

def setup_inputs():

    _w = (lambda a: (lambda t: t.to(torch.bfloat16) if t.is_floating_point() else t)(torch.as_tensor(a)))
    def _A_setup():
        B, S, D, H = 1, 2048, 576, 32
        Dh = D // H
        return {
            "x": _w((lambda *s: torch.randn(*s, dtype=torch.bfloat16) * 0.05)(B, S, D)),
            "wqkv": _w((lambda *s: torch.randn(*s, dtype=torch.bfloat16) * 0.2)(D, 3 * D)),
            "w_phi": _w((lambda *s: torch.randn(*s, dtype=torch.bfloat16) * 0.2)(H, Dh, Dh) * (Dh ** -0.5)),
            "wo": _w((lambda *s: torch.randn(*s, dtype=torch.bfloat16) * 0.05)(D, D)),
        }
    _A_in = _A_setup()

    def _B_setup():
        B, S, D, F = 1, 2048, 576, 4608
        return {
            "x": _w((lambda *s: torch.randn(*s, dtype=torch.bfloat16) * 0.05)(B, S, D)),
            "w_gate": _w((lambda *s: torch.randn(*s, dtype=torch.bfloat16) * 0.4)(D, F) * (D ** -0.5)),
            "w_up": _w((lambda *s: torch.randn(*s, dtype=torch.bfloat16) * 0.4)(D, F) * (D ** -0.5)),
            "w_down": _w((lambda *s: torch.randn(*s, dtype=torch.bfloat16) * 0.4)(F, D) * (F ** -0.5)),
        }
    _B_in = _B_setup()

    return {
        "A_x": _A_in["x"],
        "A_wqkv": _A_in["wqkv"],
        "A_w_phi": _A_in["w_phi"],
        "A_wo": _A_in["wo"],
        "B_x": _B_in["x"],
        "B_w_gate": _B_in["w_gate"],
        "B_w_up": _B_in["w_up"],
        "B_w_down": _B_in["w_down"],
    }

def reference(A_x, A_wqkv, A_w_phi, A_wo, B_x, B_w_gate, B_w_up, B_w_down):
    def _A_ref(x, wqkv, w_phi, wo):
        B, S, D = x.shape
        H = 32; Dh = D // H
        qkv = (lambda x, *d: x.permute(*d))((x @ wqkv).reshape(B, S, 3, H, Dh), 2, 0, 3, 1, 4)
        q, k, v = qkv[0], qkv[1], qkv[2]
        pq = torch.einsum("bhsd,hdf->bhsf", q, w_phi)
        pk = torch.einsum("bhsd,hdf->bhsf", k, w_phi)
        phi_q = torch.concatenate([_softmax(pq, axis=-1), _softmax(-pq, axis=-1)], axis=-1)
        phi_k = torch.concatenate([_softmax(pk, axis=-1), _softmax(-pk, axis=-1)], axis=-1)
        kv = torch.einsum("bhsf,bhsd->bhfd", phi_k, v)
        z  = torch.einsum("bhsf->bhf", phi_k)
        num = torch.einsum("bhqf,bhfd->bhqd", phi_q, kv)
        den = torch.einsum("bhqf,bhf->bhq", phi_q, z)[..., None] + 1e-6
        o = num / den
        return (lambda x, *d: x.permute(*d))(o, 0, 2, 1, 3).reshape(B, S, D) @ wo

    def _B_ref(x, w_gate, w_up, w_down):
        g = torch.einsum("bsd,df->bsf", x, w_gate)
        u = torch.einsum("bsd,df->bsf", x, w_up)
        h = g * u
        return torch.einsum("bsf,fd->bsd", h, w_down)

    x = A_x
    h = x + _A_ref(_layernorm(x, axis=-1), A_wqkv, A_w_phi, A_wo)
    h2 = h + _B_ref(_layernorm(h, axis=-1), B_w_gate, B_w_up, B_w_down)
    return h2
```

```asm
; @launch grid=(256,1,1) block=(256,1,1) lds=163840
.amdgcn_target "amdgcn-amd-amdhsa--gfx950"
.text
.globl sequential_preLN__linear_kernel_hedgehog__glu_gated_bilinear__prompt_kernel
.p2align 8
.type sequential_preLN__linear_kernel_hedgehog__glu_gated_bilinear__prompt_kernel,@function
sequential_preLN__linear_kernel_hedgehog__glu_gated_bilinear__prompt_kernel:
  s_load_dwordx2 s[12:13], s[0:1], 0
  s_load_dwordx2 s[16:17], s[0:1], 8
  s_load_dwordx4 s[8:11], s[0:1], 16
  s_load_dwordx4 s[68:71], s[0:1], 72
  s_cmp_ge_u32 s2, 256
  s_cbranch_scc1 L_end
  s_getpc_b64 s[72:73]
L_pc:
  s_lshr_b32 s74, s2, 3
  s_lshl_b32 s74, s74, 11
  v_and_b32 v255, 15, v0
  v_lshl_add_u32 v255, v255, 7, s74
  v_min_u32 v255, L_code_end-L_pc-64, v255
  global_load_dword v255, v255, s[72:73]
  v_lshrrev_b32 v18, 6, v0
  v_bfe_u32 v3, v0, 4, 2
  v_readfirstlane_b32 s3, v18
  s_and_b32 s48, s2, 7
  s_lshr_b32 s37, s2, 4
  s_add_u32 s44, s48, s37
  s_mul_i32 s45, s44, 57
  s_lshr_b32 s45, s45, 9
  s_mul_i32 s45, s45, 9
  s_sub_u32 s38, s44, s45
  v_bfe_u32 v18, v0, 3, 3
  v_and_b32 v19, 7, v0
  v_xor_b32 v19, v19, v3
  v_mul_u32_u24 v20, 1152, v18
  v_lshl_add_u32 v4, v19, 4, v20
  v_xor_b32 v5, 64, v4
  v_add_u32 v5, 8192, v5
  s_lshl2_add_u32 s44, s37, s3
  s_mul_i32 s40, s44, 36864
  s_lshl_b32 s42, s3, 14
  s_add_u32 s42, s42, 92160
  s_mov_b32 s14, 2359296
  s_mov_b32 s15, 0x20000
  s_mov_b32 s39, s38
  s_lshl_b32 s44, s39, 7
  s_add_u32 s44, s44, s40
  s_add_u32 m0, s42, 0
  s_add_u32 s45, s44, 16384
  s_waitcnt lgkmcnt(0)
  buffer_load_dwordx4 v4, s[12:15], s44 offen offset:0  lds
  buffer_load_dwordx4 v5, s[12:15], s44 offen offset:1024  lds
  buffer_load_dwordx4 v4, s[12:15], s45 offen offset:2048  lds
  buffer_load_dwordx4 v5, s[12:15], s45 offen offset:3072  lds
  s_bfe_u32 s45, s2, 0x10003
  s_lshl1_add_u32 s36, s48, s45
  s_mov_b32 s18, 1990656
  s_mov_b32 s19, 0x20000
  s_and_b32 s44, s3, 2
  s_and_b32 s45, s3, 1
  s_lshl2_add_u32 s44, s44, s45
  s_mul_i32 s44, s44, 13824
  s_mul_i32 s45, s36, 72
  s_and_b32 s45, s45, -16
  s_add_u32 s44, s44, s45
  s_movk_i32 s48, 3456
  s_movk_i32 s49, 1152
  s_add_u32 s41, s44, s49
  s_mul_i32 s43, s3, 2560
  v_and_b32 v1, 63, v0
  s_add_u32 m0, s43, 0
  s_mul_i32 s44, s39, 221184
  s_add_u32 s44, s44, s41
  s_add_u32 s39, s39, 1
  v_mul_u32_u24 v22, 205, v1
  v_lshrrev_b32 v22, 10, v22
  v_mad_i32_i24 v21, v22, -5, v1
  v_lshlrev_b32 v21, 4, v21
  v_and_b32 v248, 1, v22
  v_mad_u32_u24 v21, v248, s49, v21
  v_bfe_u32 v23, v22, 1, 2
  v_and_or_b32 v22, v22, 56, v23
  v_mad_u32_u24 v6, v22, s48, v21
  buffer_load_dwordx4 v6, s[16:19], s44 offen offset:0  lds
  v_add_u32 v21, 64, v1
  v_mul_u32_u24 v22, 205, v21
  v_lshrrev_b32 v22, 10, v22
  v_mad_i32_i24 v21, v22, -5, v1
  v_lshlrev_b32 v21, 4, v21
  v_and_b32 v249, 1, v22
  v_mad_u32_u24 v21, v249, s49, v21
  v_bfe_u32 v23, v22, 1, 2
  v_and_or_b32 v22, v22, 56, v23
  v_mad_u32_u24 v7, v22, s48, v21
  buffer_load_dwordx4 v7, s[16:19], s44 offen offset:1024  lds
  v_add_u32 v21, 128, v1
  v_mul_u32_u24 v22, 205, v21
  v_lshrrev_b32 v22, 10, v22
  v_mad_i32_i24 v21, v22, -5, v1
  v_lshlrev_b32 v21, 4, v21
  v_and_b32 v250, 1, v22
  v_mad_u32_u24 v21, v250, s49, v21
  v_bfe_u32 v23, v22, 1, 2
  v_and_or_b32 v22, v22, 56, v23
  v_mad_u32_u24 v8, v22, s48, v21
  s_mov_b32 exec_hi, 0
  buffer_load_dwordx4 v8, s[16:19], s44 offen offset:2048  lds
  s_mov_b64 exec, -1
  s_cmp_eq_u32 s39, 9
  s_cselect_b32 s39, 0, s39
  s_mov_b32 s24, s10
  s_and_b32 s25, s11, 0xffff
  s_mov_b32 s26, 663552
  s_mov_b32 s27, 0x20000
  s_lshr_b32 s44, s36, 3
  s_xor_b32 s44, s44, s36
  s_and_b32 s44, s44, 1
  s_andn2_b32 s45, 2, s3
  s_or_b32 s44, s44, s45
  s_lshr_b32 s46, s36, 1
  s_lshl3_add_u32 s45, s37, s46
  s_cmp_lg_u32 s44, 0
  s_cselect_b32 s54, 72, s45
  v_and_b32 v2, 15, v0
  s_cmp_ge_u32 s54, 72
  s_cbranch_scc1 L_wb1
  s_and_b32 s44, s3, 1
  s_lshr_b32 s48, s54, 1
  s_mul_i32 s48, s48, 18
  s_and_b32 s49, s54, 1
  s_lshl2_add_u32 s48, s49, s48
  s_lshl3_add_u32 s48, s44, s48
  s_sub_u32 s49, s54, 64
  s_lshl1_add_u32 s49, s49, s44
  s_mul_i32 s49, s49, 36
  s_add_u32 s49, s49, 16
  s_cmp_lt_u32 s54, 64
  s_cselect_b32 s48, s48, s49
  s_cselect_b32 s49, 0, 16
  s_mul_i32 s48, s48, 1152
  v_lshrrev_b32 v18, 1, v3
  v_mad_u32_u24 v18, v18, s49, v3
  v_mul_u32_u24 v18, 1152, v18
  v_lshl_add_u32 v19, v2, 4, v18
  v_lshl_add_u32 v18, v2, 3, v18
  v_bfe_u32 v20, v1, 1, 2
  v_bfe_u32 v21, v1, 2, 1
  v_mad_u32_u24 v20, v21, s49, v20
  v_mul_u32_u24 v20, 1152, v20
  v_lshrrev_b32 v21, 3, v1
  v_lshl_add_u32 v20, v21, 4, v20
  buffer_load_dwordx4 v[68:71], v19, s[24:27], s48 offen offset:0
  buffer_load_dwordx4 v[72:75], v19, s[24:27], s48 offen offset:256
  buffer_load_dwordx4 v[76:79], v19, s[24:27], s48 offen offset:512
  buffer_load_dwordx4 v[80:83], v19, s[24:27], s48 offen offset:768
  buffer_load_dwordx2 v[84:85], v18, s[24:27], s48 offen offset:1024
  buffer_load_dwordx4 v[188:191], v20, s[24:27], s48 offen offset:1024
L_wb1:
  s_mov_b32 s28, s70
  s_and_b32 s29, s71, 0xffff
  s_mov_b32 s30, 67108864
  s_mov_b32 s31, 0x20000
  s_mov_b32 s20, s8
  s_and_b32 s21, s9, 0xffff
  s_mov_b32 s22, 20736
  s_mov_b32 s23, 0x20000
  s_mov_b32 s32, s68
  s_and_b32 s33, s69, 0xffff
  s_mov_b32 s34, 256
  s_mov_b32 s35, 0x20000
  s_load_dwordx8 s[4:11], s[0:1], 40
  s_sub_u32 s49, s37, 6
  s_xor_b32 s48, s3, 1
  s_or_b32 s48, s48, s36
  s_cselect_b32 s77, -1, s49
  s_lshl_b32 s48, s77, 10
  s_add_u32 s48, s48, 58720256
  s_cmp_lt_u32 s77, 10
  s_cselect_b32 s48, s48, 1073741824
  v_lshlrev_b32 v253, 4, v1
  v_mov_b32 v168, 0
  v_mov_b32 v169, 0
  v_mov_b32 v170, 0
  v_mov_b32 v171, 0
  buffer_store_dwordx4 v[168:171], v253, s[28:31], s48 offen sc1
  v_lshlrev_b32 v18, 2, v0
  s_mul_i32 s48, s36, 1296
  buffer_load_dword v104, v18, s[20:23], s48 offen
  buffer_load_dword v105, v18, s[20:23], s48 offen offset:1024
  v_bfe_u32 v18, v0, 1, 3
  v_xor_b32 v18, v18, v3
  v_lshlrev_b32 v19, 7, v2
  v_add_u32 v19, s42, v19
  v_lshl_add_u32 v9, v18, 4, v19
  v_xor_b32 v10, 64, v9
  v_lshrrev_b32 v18, 2, v1
  v_mul_u32_u24 v18, 160, v18
  s_and_b32 s48, s36, 1
  s_lshl_b32 s48, s48, 3
  v_add_u32 v18, s48, v18
  v_add_u32 v240, 92224, v18
  v_and_b32 v19, 3, v1
  v_lshl_add_u32 v11, v19, 3, v18
  v_and_b32 v19, 1, v1
  v_mul_u32_u24 v19, 48, v19
  v_add3_u32 v12, v18, v19, 64
  v_add_u32 v13, 51200, v11
  v_add_u32 v14, 51200, v12
  v_lshlrev_b32 v18, 4, v0
  v_add_u32 v18, 157696, v18
  ds_write_b128 v18, v[168:171]
  v_mov_b32 v24, 1065369472
  v_mov_b32 v25, 1065369472
  v_mov_b32 v26, 1065369472
  v_mov_b32 v27, 1065369472
  s_mov_b64 exec, 0
  s_cmp_eq_u32 s3, 0
  s_cbranch_scc1 L_hop1
  s_cmp_eq_u32 s3, 1
  s_cbranch_scc1 L_hop2
  s_cmp_eq_u32 s3, 2
  s_cbranch_scc1 L_hop3
  s_branch L_hop4
.p2align 12
L_main:
  s_mov_b64 exec, -1
  s_nop 1
  s_lshl_b32 s44, s39, 7
  s_add_u32 s44, s44, s40
  s_add_u32 m0, s42, 4096
  s_add_u32 s45, s44, 16384
  buffer_load_dwordx4 v4, s[12:15], s44 offen offset:0  lds
  buffer_load_dwordx4 v5, s[12:15], s44 offen offset:1024  lds
  buffer_load_dwordx4 v4, s[12:15], s45 offen offset:2048  lds
  buffer_load_dwordx4 v5, s[12:15], s45 offen offset:3072  lds
  s_add_u32 m0, s43, 10240
  s_mul_i32 s44, s39, 221184
  s_add_u32 s44, s44, s41
  s_add_u32 s39, s39, 1
  buffer_load_dwordx4 v6, s[16:19], s44 offen offset:0  lds
  buffer_load_dwordx4 v7, s[16:19], s44 offen offset:1024  lds
  s_mov_b32 exec_hi, 0
  buffer_load_dwordx4 v8, s[16:19], s44 offen offset:2048  lds
  s_mov_b64 exec, -1
  s_cmp_eq_u32 s39, 9
  s_cselect_b32 s39, 0, s39
  s_mov_b64 exec, 0
  s_cmp_eq_u32 s3, 0
  s_cbranch_scc1 L_hopb1
  s_cmp_eq_u32 s3, 1
  s_cbranch_scc1 L_hopb2
  s_cmp_eq_u32 s3, 2
  s_cbranch_scc1 L_hopb3
  s_branch L_hopb4
L_mainb:
  s_mov_b64 exec, -1
  s_waitcnt lgkmcnt(0)
  s_waitcnt vmcnt(10)
  s_barrier
  ds_read_b128 a[0:3], v9 offset:0
  ds_read_b128 a[4:7], v9 offset:2048
  ds_read_b64_tr_b16 v[28:29], v11 offset:0
  ds_read_b64_tr_b16 v[30:31], v11 offset:2560
  ds_read_b64_tr_b16 v[32:33], v11 offset:32
  ds_read_b64_tr_b16 v[34:35], v11 offset:2592
  ds_read_b64_tr_b16 v[44:45], v12 offset:0
  ds_read_b64_tr_b16 v[46:47], v12 offset:2560
  ds_read_b64_tr_b16 v[36:37], v11 offset:80
  ds_read_b64_tr_b16 v[38:39], v11 offset:2640
  ds_read_b64_tr_b16 v[40:41], v11 offset:120
  ds_read_b64_tr_b16 v[42:43], v11 offset:2680
  s_mul_i32 s44, s39, 221184
  s_add_u32 s44, s44, s41
  s_add_u32 m0, s43, 20480
  s_nop 0
  buffer_load_dwordx4 v6, s[16:19], s44 offen offset:0  lds
  s_lshl_b32 s46, s39, 7
  s_add_u32 s46, s46, s40
  s_add_u32 s47, s46, 16384
  s_add_u32 m0, s42, 8192
  s_nop 0
  buffer_load_dwordx4 v4, s[12:15], s46 offen offset:0  lds
  buffer_load_dwordx4 v5, s[12:15], s46 offen offset:1024  lds
  s_add_u32 m0, s43, 20480
  s_nop 0
  buffer_load_dwordx4 v7, s[16:19], s44 offen offset:1024  lds
  s_waitcnt lgkmcnt(10)
  v_mfma_f32_16x16x32_bf16 v[180:183], a[4:7], a[4:7], 0
  s_add_u32 m0, s42, 8192
  ds_read_b128 a[8:11], v10 offset:0
  v_and_b32 v18, 3, v2
  v_mfma_f32_16x16x32_bf16 v[172:175], v[24:27], a[4:7], 0
  ds_read_b128 a[12:15], v10 offset:2048
  v_cmp_eq_u32 s[56:57], 1, v18
  v_mfma_f32_16x16x32_bf16 v[168:171], v[24:27], a[0:3], 0
  buffer_load_dwordx4 v4, s[12:15], s47 offen offset:2048  lds
  v_mfma_f32_16x16x32_bf16 v[176:179], a[0:3], a[0:3], 0
  s_waitcnt lgkmcnt(6)
  ds_read_b64_tr_b16 v[48:49], v11 offset:5120
  v_cmp_eq_u32 s[58:59], 2, v18
  v_mfma_f32_16x16x32_bf16 v[108:111], v[28:31], a[0:3], 0
  ds_read_b64_tr_b16 v[50:51], v11 offset:7680
  v_cmp_eq_u32 s[60:61], 3, v18
  v_mfma_f32_16x16x32_bf16 v[116:119], v[28:31], v[24:27], 0
  ds_read_b64_tr_b16 v[52:53], v11 offset:5152
  v_cmp_eq_u32 s[62:63], 1, v3
  v_mfma_f32_16x16x32_bf16 v[112:115], v[28:31], a[4:7], 0
  ds_read_b64_tr_b16 v[54:55], v11 offset:7712
  v_lshrrev_b32 v18, 2, v2
  v_mfma_f32_16x16x32_bf16 v[124:127], v[32:35], a[4:7], 0
  ds_read_b64_tr_b16 v[64:65], v12 offset:5120
  v_lshl_add_u32 v18, v18, 4, v2
  v_mfma_f32_16x16x32_bf16 v[128:131], v[32:35], v[24:27], 0
  s_add_u32 m0, s43, 20480
  s_mov_b32 exec_hi, 0
  buffer_load_dwordx4 v8, s[16:19], s44 offen offset:2048  lds
  s_mov_b64 exec, -1
  v_mfma_f32_16x16x32_bf16 v[120:123], v[32:35], a[0:3], 0
  s_add_u32 s39, s39, 1
  ds_read_b64_tr_b16 v[66:67], v12 offset:7680
  v_lshlrev_b32 v236, 2, v18
  v_mfma_f32_16x16x32_bf16 v[156:159], v[44:47], a[0:3], 0
  s_cmp_eq_u32 s39, 9
  s_cselect_b32 s39, 0, s39
  ds_read_b64_tr_b16 v[56:57], v11 offset:5200
  v_mfma_f32_16x16x32_bf16 v[164:167], v[44:47], v[24:27], 0
  s_mul_i32 s44, s39, 221184
  ds_read_b64_tr_b16 v[58:59], v11 offset:7760
  s_add_u32 s44, s44, s41
  v_mfma_f32_16x16x32_bf16 v[160:163], v[44:47], a[4:7], 0
  s_waitcnt lgkmcnt(10)
  ds_read_b64_tr_b16 v[60:61], v11 offset:5240
  s_add_u32 m0, s42, 8192
  v_mfma_f32_16x16x32_bf16 v[136:139], v[36:39], a[4:7], 0
  s_lshl_b32 s48, s37, 2
  ds_read_b64_tr_b16 v[62:63], v11 offset:7800
  s_add_u32 s48, s48, s3
  v_mfma_f32_16x16x32_bf16 v[140:143], v[36:39], v[24:27], 0
  buffer_load_dwordx4 v5, s[12:15], s47 offen offset:3072  lds
  v_mfma_f32_16x16x32_bf16 v[132:135], v[36:39], a[0:3], 0
  s_lshl_b32 s49, s48, 7
  s_add_u32 s49, s49, 53542912
  v_mfma_f32_16x16x32_bf16 v[144:147], v[40:43], a[0:3], 0
  s_cmp_eq_u32 s36, 0
  s_cselect_b32 s64, s49, 1073741824
  v_and_b32 v18, 32, v1
  v_mfma_f32_16x16x32_bf16 v[152:155], v[40:43], v[24:27], 0
  v_lshl_add_u32 v237, v18, 21, v1
  s_mul_i32 s48, s48, 36864
  v_mfma_f32_16x16x32_bf16 v[148:151], v[40:43], a[4:7], 0
  s_add_u32 s48, s48, 50331648
  s_lshl_b32 s49, s36, 10
  s_add_u32 s65, s49, s48
  s_waitcnt lgkmcnt(10)
  s_waitcnt vmcnt(7)
  s_barrier
  v_mfma_f32_16x16x32_bf16 v[180:183], a[12:15], a[12:15], v[180:183]
  s_add_u32 m0, s43, 30720
  ds_read_b128 a[16:19], v9 offset:4096
  s_lshr_b32 s49, s36, 3
  v_mfma_f32_16x16x32_bf16 v[172:175], v[24:27], a[12:15], v[172:175]
  buffer_load_dwordx4 v6, s[16:19], s44 offen offset:0  lds
  v_mfma_f32_16x16x32_bf16 v[168:171], v[24:27], a[8:11], v[168:171]
  s_lshl_b32 s46, s39, 7
  ds_read_b128 a[20:23], v9 offset:6144
  s_add_u32 s46, s46, s40
  v_mfma_f32_16x16x32_bf16 v[176:179], a[8:11], a[8:11], v[176:179]
  s_waitcnt lgkmcnt(6)
  ds_read_b64_tr_b16 v[28:29], v11 offset:10240
  s_add_u32 s47, s46, 16384
  v_mfma_f32_16x16x32_bf16 v[108:111], v[48:51], a[8:11], v[108:111]
  s_add_u32 m0, s42, 12288
  ds_read_b64_tr_b16 v[30:31], v11 offset:12800
  s_lshl_b32 s49, s49, 10
  v_mfma_f32_16x16x32_bf16 v[116:119], v[48:51], v[24:27], v[116:119]
  buffer_load_dwordx4 v4, s[12:15], s46 offen offset:0  lds
  v_mfma_f32_16x16x32_bf16 v[112:115], v[48:51], a[12:15], v[112:115]
  s_add_u32 s48, s48, s49
  ds_read_b64_tr_b16 v[32:33], v11 offset:10272
  s_and_b32 s49, s36, 1
  v_mfma_f32_16x16x32_bf16 v[124:127], v[52:55], a[12:15], v[124:127]
  s_lshl_b32 s49, s49, 9
  ds_read_b64_tr_b16 v[34:35], v11 offset:12832
  s_add_u32 s48, s48, s49
  v_mfma_f32_16x16x32_bf16 v[128:131], v[52:55], v[24:27], v[128:131]
  s_bfe_u32 s49, s36, 0x20001
  ds_read_b64_tr_b16 v[44:45], v12 offset:10240
  s_lshl_b32 s49, s49, 7
  v_mfma_f32_16x16x32_bf16 v[120:123], v[52:55], a[8:11], v[120:123]
  buffer_load_dwordx4 v5, s[12:15], s46 offen offset:1024  lds
  v_mfma_f32_16x16x32_bf16 v[156:159], v[64:67], a[8:11], v[156:159]
  s_add_u32 m0, s43, 30720
  ds_read_b64_tr_b16 v[46:47], v12 offset:12800
  s_add_u32 s48, s48, s49
  v_mfma_f32_16x16x32_bf16 v[164:167], v[64:67], v[24:27], v[164:167]
  s_add_u32 s66, s48, 16384
  ds_read_b64_tr_b16 v[36:37], v11 offset:10320
  v_mfma_f32_16x16x32_bf16 v[160:163], v[64:67], a[12:15], v[160:163]
  s_waitcnt lgkmcnt(9)
  ds_read_b64_tr_b16 v[38:39], v11 offset:12880
  v_add_u32 v18, 0, v0
  v_mfma_f32_16x16x32_bf16 v[136:139], v[56:59], a[12:15], v[136:139]
  ds_read_b64_tr_b16 v[40:41], v11 offset:10360
  v_mul_u32_u24 v19, 7282, v18
  v_mfma_f32_16x16x32_bf16 v[140:143], v[56:59], v[24:27], v[140:143]
  buffer_load_dwordx4 v7, s[16:19], s44 offen offset:1024  lds
  v_mfma_f32_16x16x32_bf16 v[132:135], v[56:59], a[8:11], v[132:135]
  ds_read_b64_tr_b16 v[42:43], v11 offset:12920
  v_lshrrev_b32 v19, 16, v19
  v_mfma_f32_16x16x32_bf16 v[144:147], v[60:63], a[8:11], v[144:147]
  v_add_lshl_u32 v19, v19, v18, 2
  v_add_u32 v19, 158592, v19
  v_mfma_f32_16x16x32_bf16 v[152:155], v[60:63], v[24:27], v[152:155]
  v_xor_b32 v20, 0x80008000, v104
  ds_write_b32 v19, v104
  v_mfma_f32_16x16x32_bf16 v[148:151], v[60:63], a[12:15], v[148:151]
  ds_write_b32 v19, v20 offset:1440
  v_add_u32 v18, 256, v0
  s_waitcnt lgkmcnt(12)
  v_mfma_f32_16x16x32_bf16 v[180:183], a[20:23], a[20:23], v[180:183]
  s_add_u32 m0, s42, 12288
  ds_read_b128 a[24:27], v10 offset:4096
  v_mul_u32_u24 v19, 7282, v18
  v_mfma_f32_16x16x32_bf16 v[172:175], v[24:27], a[20:23], v[172:175]
  ds_read_b128 a[28:31], v10 offset:6144
  v_lshrrev_b32 v19, 16, v19
  v_mfma_f32_16x16x32_bf16 v[168:171], v[24:27], a[16:19], v[168:171]
  buffer_load_dwordx4 v4, s[12:15], s47 offen offset:2048  lds
  v_mfma_f32_16x16x32_bf16 v[176:179], a[16:19], a[16:19], v[176:179]
  s_waitcnt lgkmcnt(8)
  ds_read_b64_tr_b16 v[48:49], v11 offset:15360
  v_add_lshl_u32 v19, v19, v18, 2
  v_mfma_f32_16x16x32_bf16 v[108:111], v[28:31], a[16:19], v[108:111]
  ds_read_b64_tr_b16 v[50:51], v11 offset:17920
  v_add_u32 v19, 158592, v19
  v_mfma_f32_16x16x32_bf16 v[116:119], v[28:31], v[24:27], v[116:119]
  ds_read_b64_tr_b16 v[52:53], v11 offset:15392
  v_xor_b32 v20, 0x80008000, v105
  v_mfma_f32_16x16x32_bf16 v[112:115], v[28:31], a[20:23], v[112:115]
  ds_read_b64_tr_b16 v[54:55], v11 offset:17952
  v_cmp_gt_u32 vcc, 324, v18
  v_mfma_f32_16x16x32_bf16 v[124:127], v[32:35], a[20:23], v[124:127]
  ds_read_b64_tr_b16 v[64:65], v12 offset:15360
  v_mov_b32 v21, 161600
  v_mfma_f32_16x16x32_bf16 v[128:131], v[32:35], v[24:27], v[128:131]
  s_add_u32 m0, s43, 30720
  s_mov_b32 exec_hi, 0
  buffer_load_dwordx4 v8, s[16:19], s44 offen offset:2048  lds
  s_mov_b64 exec, -1
  v_mfma_f32_16x16x32_bf16 v[120:123], v[32:35], a[16:19], v[120:123]
  s_add_u32 s39, s39, 1
  ds_read_b64_tr_b16 v[66:67], v12 offset:17920
  v_mov_b32 v17, 1
  v_mfma_f32_16x16x32_bf16 v[156:159], v[44:47], a[16:19], v[156:159]
  s_cmp_eq_u32 s39, 9
  s_cselect_b32 s39, 0, s39
  ds_read_b64_tr_b16 v[56:57], v11 offset:15440
  v_mfma_f32_16x16x32_bf16 v[164:167], v[44:47], v[24:27], v[164:167]
  s_mul_i32 s44, s39, 221184
  ds_read_b64_tr_b16 v[58:59], v11 offset:18000
  s_add_u32 s44, s44, s41
  v_mfma_f32_16x16x32_bf16 v[160:163], v[44:47], a[20:23], v[160:163]
  s_waitcnt lgkmcnt(12)
  ds_read_b64_tr_b16 v[60:61], v11 offset:15480
  s_add_u32 m0, s42, 12288
  v_mfma_f32_16x16x32_bf16 v[136:139], v[36:39], a[20:23], v[136:139]
  ds_read_b64_tr_b16 v[62:63], v11 offset:18040
  v_cndmask_b32 v19, v21, v19, vcc
  v_mfma_f32_16x16x32_bf16 v[140:143], v[36:39], v[24:27], v[140:143]
  buffer_load_dwordx4 v5, s[12:15], s47 offen offset:3072  lds
  v_mfma_f32_16x16x32_bf16 v[132:135], v[36:39], a[16:19], v[132:135]
  ds_write_b32 v19, v105
  ds_write_b32 v19, v20 offset:1440
  v_mfma_f32_16x16x32_bf16 v[144:147], v[40:43], a[16:19], v[144:147]
  v_cmp_eq_u32 vcc, 0, v1
  v_mov_b32 v18, 1073741824
  v_mfma_f32_16x16x32_bf16 v[152:155], v[40:43], v[24:27], v[152:155]
  s_cmp_lt_u32 s77, 10
  s_cselect_b32 s48, 0, 1073741824
  v_cndmask_b32 v15, v18, 0, vcc
  v_mfma_f32_16x16x32_bf16 v[148:151], v[40:43], a[20:23], v[148:151]
  buffer_atomic_add v17, v15, s[32:35], s48 offen sc1
  s_cmp_ge_u32 s54, 72
  s_cbranch_scc1 L_wb2
  v_mov_b32 v18, 0
  v_mov_b32 v19, 0
  v_dot2_f32_bf16 v18, v68, v24, v18
  v_dot2_f32_bf16 v19, v69, v24, v19
  v_dot2_f32_bf16 v18, v70, v24, v18
  v_dot2_f32_bf16 v19, v71, v24, v19
  v_dot2_f32_bf16 v18, v72, v24, v18
  v_dot2_f32_bf16 v19, v73, v24, v19
  v_dot2_f32_bf16 v18, v74, v24, v18
  v_dot2_f32_bf16 v19, v75, v24, v19
  v_dot2_f32_bf16 v18, v76, v24, v18
  v_dot2_f32_bf16 v19, v77, v24, v19
  v_dot2_f32_bf16 v18, v78, v24, v18
  v_dot2_f32_bf16 v19, v79, v24, v19
  v_dot2_f32_bf16 v18, v80, v24, v18
  v_dot2_f32_bf16 v19, v81, v24, v19
  v_dot2_f32_bf16 v18, v82, v24, v18
  v_dot2_f32_bf16 v19, v83, v24, v19
  v_dot2_f32_bf16 v18, v84, v24, v18
  v_dot2_f32_bf16 v19, v85, v24, v19
  s_and_b32 s48, s54, -4
  s_add_u32 s48, s48, s54
  s_and_b32 s49, s3, 1
  v_add_f32 v18, v18, v19
  s_lshl2_add_u32 s48, s49, s48
  s_lshl_b32 s48, s48, 7
  v_add_f32_dpp v18, v18, v18 quad_perm:[1,0,3,2] row_mask:0xf bank_mask:0xf
  s_add_u32 s48, s48, 61865984
  v_and_b32 v19, 1, v1
  v_add_f32_dpp v18, v18, v18 quad_perm:[2,3,0,1] row_mask:0xf bank_mask:0xf
  v_cmp_eq_u32 vcc, 1, v19
  v_and_b32 v19, 6, v1
  v_add_f32_dpp v18, v18, v18 row_half_mirror row_mask:0xf bank_mask:0xf
  v_lshlrev_b32 v19, 5, v19
  v_lshrrev_b32 v21, 3, v1
  v_add_f32_dpp v18, v18, v18 row_mirror row_mask:0xf bank_mask:0xf
  v_mul_f32 v18, 0x3ae38e39, v18
  v_cvt_pk_bf16_f32 v18, v18, v18
  ds_bpermute_b32 v20, v19, v18
  v_mul_u32_u24 v21, 18304, v21
  v_add_u32 v21, v21, v253
  s_waitcnt lgkmcnt(0)
  v_cndmask_b32 v188, v188, v20, vcc
  v_cndmask_b32 v189, v189, v20, vcc
  v_cndmask_b32 v190, v190, v20, vcc
  v_cndmask_b32 v191, v191, v20, vcc
  buffer_store_dwordx4 v[188:191], v21, s[28:31], s48 offen sc1
L_wb2:
  s_waitcnt lgkmcnt(0)
  s_waitcnt vmcnt(8)
  s_barrier
  v_mfma_f32_16x16x32_bf16 v[180:183], a[28:31], a[28:31], v[180:183]
  s_add_u32 m0, s43, 40960
  ds_read_b128 a[32:35], v9 offset:8192
  s_mul_i32 s48, s2, 640
  v_mfma_f32_16x16x32_bf16 v[172:175], v[24:27], a[28:31], v[172:175]
  buffer_load_dwordx4 v6, s[16:19], s44 offen offset:0  lds
  v_mfma_f32_16x16x32_bf16 v[168:171], v[24:27], a[24:27], v[168:171]
  s_lshl_b32 s46, s39, 7
  ds_read_b128 a[36:39], v9 offset:10240
  s_add_u32 s46, s46, s40
  v_mfma_f32_16x16x32_bf16 v[176:179], a[24:27], a[24:27], v[176:179]
  ds_read_b64_tr_b16 v[28:29], v11 offset:20480
  s_add_u32 s47, s46, 16384
  v_mfma_f32_16x16x32_bf16 v[108:111], v[48:51], a[24:27], v[108:111]
  s_add_u32 m0, s42, 0
  ds_read_b64_tr_b16 v[30:31], v11 offset:23040
  s_add_u32 s48, s48, 58730496
  v_mfma_f32_16x16x32_bf16 v[116:119], v[48:51], v[24:27], v[116:119]
  buffer_load_dwordx4 v4, s[12:15], s46 offen offset:0  lds
  v_mfma_f32_16x16x32_bf16 v[112:115], v[48:51], a[28:31], v[112:115]
  ds_read_b64_tr_b16 v[32:33], v11 offset:20512
  v_add_u32 v19, 24, v0
  v_mfma_f32_16x16x32_bf16 v[124:127], v[52:55], a[28:31], v[124:127]
  ds_read_b64_tr_b16 v[34:35], v11 offset:23072
  v_lshrrev_b32 v19, 6, v19
  v_mfma_f32_16x16x32_bf16 v[128:131], v[52:55], v[24:27], v[128:131]
  ds_read_b64_tr_b16 v[44:45], v12 offset:20480
  v_lshl_add_u32 v18, v19, 28, v253
  v_mfma_f32_16x16x32_bf16 v[120:123], v[52:55], a[24:27], v[120:123]
  buffer_load_dwordx4 v5, s[12:15], s46 offen offset:1024  lds
  v_mfma_f32_16x16x32_bf16 v[156:159], v[64:67], a[24:27], v[156:159]
  s_add_u32 m0, s43, 40960
  ds_read_b64_tr_b16 v[46:47], v12 offset:23040
  v_mov_b32 v208, 0
  v_mfma_f32_16x16x32_bf16 v[164:167], v[64:67], v[24:27], v[164:167]
  ds_read_b64_tr_b16 v[36:37], v11 offset:20560
  v_mov_b32 v209, 0
  v_mfma_f32_16x16x32_bf16 v[160:163], v[64:67], a[28:31], v[160:163]
  ds_read_b64_tr_b16 v[38:39], v11 offset:23120
  v_mov_b32 v210, 0
  v_mfma_f32_16x16x32_bf16 v[136:139], v[56:59], a[28:31], v[136:139]
  ds_read_b64_tr_b16 v[40:41], v11 offset:20600
  v_mov_b32 v211, 0
  v_mfma_f32_16x16x32_bf16 v[140:143], v[56:59], v[24:27], v[140:143]
  buffer_load_dwordx4 v7, s[16:19], s44 offen offset:1024  lds
  v_mfma_f32_16x16x32_bf16 v[132:135], v[56:59], a[24:27], v[132:135]
  buffer_store_dwordx4 v[208:211], v18, s[28:31], s48 offen sc1
  v_mfma_f32_16x16x32_bf16 v[144:147], v[60:63], a[24:27], v[144:147]
  ds_read_b64_tr_b16 v[42:43], v11 offset:23160
  v_lshlrev_b32 v237, 2, v237
  v_mfma_f32_16x16x32_bf16 v[152:155], v[60:63], v[24:27], v[152:155]
  v_mul_u32_u24 v19, 9216, v3
  v_lshl_add_u32 v19, v2, 3, v19
  v_mfma_f32_16x16x32_bf16 v[148:151], v[60:63], a[28:31], v[148:151]
  v_and_b32 v18, 1, v3
  v_lshl_add_u32 v254, v18, 30, v19
  s_waitcnt lgkmcnt(10)
  v_mfma_f32_16x16x32_bf16 v[180:183], a[36:39], a[36:39], v[180:183]
  s_add_u32 m0, s42, 0
  ds_read_b128 a[40:43], v10 offset:8192
  s_lshl_b32 s48, s3, 5
  v_mfma_f32_16x16x32_bf16 v[172:175], v[24:27], a[36:39], v[172:175]
  ds_read_b128 a[44:47], v10 offset:10240
  v_add_u32 v18, s48, v2
  v_mfma_f32_16x16x32_bf16 v[168:171], v[24:27], a[32:35], v[168:171]
  buffer_load_dwordx4 v4, s[12:15], s47 offen offset:2048  lds
  v_mfma_f32_16x16x32_bf16 v[176:179], a[32:35], a[32:35], v[176:179]
  s_waitcnt lgkmcnt(6)
  ds_read_b64_tr_b16 v[48:49], v11 offset:25600
  v_mul_u32_u24 v228, 96, v18
  v_mfma_f32_16x16x32_bf16 v[108:111], v[28:31], a[32:35], v[108:111]
  ds_read_b64_tr_b16 v[50:51], v11 offset:28160
  v_lshrrev_b32 v20, 2, v2
  v_mfma_f32_16x16x32_bf16 v[116:119], v[28:31], v[24:27], v[116:119]
  ds_read_b64_tr_b16 v[52:53], v11 offset:25632
  v_add_u32 v19, 3, v3
  v_mfma_f32_16x16x32_bf16 v[112:115], v[28:31], a[36:39], v[112:115]
  ds_read_b64_tr_b16 v[54:55], v11 offset:28192
  v_and_b32 v19, 3, v19
  v_mfma_f32_16x16x32_bf16 v[124:127], v[32:35], a[36:39], v[124:127]
  ds_read_b64_tr_b16 v[64:65], v12 offset:25600
  v_xor_b32 v19, v19, v20
  v_mfma_f32_16x16x32_bf16 v[128:131], v[32:35], v[24:27], v[128:131]
  s_add_u32 m0, s43, 40960
  s_mov_b32 exec_hi, 0
  buffer_load_dwordx4 v8, s[16:19], s44 offen offset:2048  lds
  s_mov_b64 exec, -1
  v_mfma_f32_16x16x32_bf16 v[120:123], v[32:35], a[32:35], v[120:123]
  s_add_u32 s39, s39, 1
  ds_read_b64_tr_b16 v[66:67], v12 offset:28160
  v_lshl_add_u32 v229, v19, 3, v228
  v_mfma_f32_16x16x32_bf16 v[156:159], v[44:47], a[32:35], v[156:159]
  s_cmp_eq_u32 s39, 9
  s_cselect_b32 s39, 0, s39
  ds_read_b64_tr_b16 v[56:57], v11 offset:25680
  v_mfma_f32_16x16x32_bf16 v[164:167], v[44:47], v[24:27], v[164:167]
  s_mul_i32 s44, s39, 221184
  ds_read_b64_tr_b16 v[58:59], v11 offset:28240
  s_add_u32 s44, s44, s41
  v_mfma_f32_16x16x32_bf16 v[160:163], v[44:47], a[36:39], v[160:163]
  s_waitcnt lgkmcnt(10)
  ds_read_b64_tr_b16 v[60:61], v11 offset:25720
  s_add_u32 m0, s42, 0
  v_mfma_f32_16x16x32_bf16 v[136:139], v[36:39], a[36:39], v[136:139]
  ds_read_b64_tr_b16 v[62:63], v11 offset:28280
  v_xor_b32 v19, v3, v20
  v_mfma_f32_16x16x32_bf16 v[140:143], v[36:39], v[24:27], v[140:143]
  buffer_load_dwordx4 v5, s[12:15], s47 offen offset:3072  lds
  v_mfma_f32_16x16x32_bf16 v[132:135], v[36:39], a[32:35], v[132:135]
  v_lshl_add_u32 v228, v19, 3, v228
  v_mul_u32_u24 v18, 160, v18
  v_mfma_f32_16x16x32_bf16 v[144:147], v[40:43], a[32:35], v[144:147]
  v_cmp_eq_u32 vcc, 2, v3
  v_mov_b32 v19, 0x3f80
  v_mfma_f32_16x16x32_bf16 v[152:155], v[40:43], v[24:27], v[152:155]
  v_mul_u32_u24 v21, 5, v3
  v_cndmask_b32 v238, 0, v19, vcc
  v_mfma_f32_16x16x32_bf16 v[148:151], v[40:43], a[36:39], v[148:151]
  v_xor_b32 v19, v21, v20
  v_lshl_add_u32 v68, v19, 3, v18
  s_waitcnt lgkmcnt(10)
  s_waitcnt vmcnt(9)
  s_barrier
  v_mfma_f32_16x16x32_bf16 v[180:183], a[44:47], a[44:47], v[180:183]
  s_add_u32 m0, s43, 51200
  ds_read_b128 a[48:51], v9 offset:12288
  v_add_u32 v21, 1, v21
  v_mfma_f32_16x16x32_bf16 v[172:175], v[24:27], a[44:47], v[172:175]
  buffer_load_dwordx4 v6, s[16:19], s44 offen offset:0  lds
  v_mfma_f32_16x16x32_bf16 v[168:171], v[24:27], a[40:43], v[168:171]
  s_lshl_b32 s46, s39, 7
  ds_read_b128 a[52:55], v9 offset:14336
  s_add_u32 s46, s46, s40
  v_mfma_f32_16x16x32_bf16 v[176:179], a[40:43], a[40:43], v[176:179]
  s_waitcnt lgkmcnt(6)
  ds_read_b64_tr_b16 v[28:29], v11 offset:30720
  s_add_u32 s47, s46, 16384
  v_mfma_f32_16x16x32_bf16 v[108:111], v[48:51], a[40:43], v[108:111]
  s_add_u32 m0, s42, 4096
  ds_read_b64_tr_b16 v[30:31], v11 offset:33280
  v_xor_b32 v19, v21, v20
  v_mfma_f32_16x16x32_bf16 v[116:119], v[48:51], v[24:27], v[116:119]
  buffer_load_dwordx4 v4, s[12:15], s46 offen offset:0  lds
  v_mfma_f32_16x16x32_bf16 v[112:115], v[48:51], a[44:47], v[112:115]
  ds_read_b64_tr_b16 v[32:33], v11 offset:30752
  v_lshl_add_u32 v69, v19, 3, v18
  v_mfma_f32_16x16x32_bf16 v[124:127], v[52:55], a[44:47], v[124:127]
  ds_read_b64_tr_b16 v[34:35], v11 offset:33312
  v_add_u32 v21, 1, v21
  v_mfma_f32_16x16x32_bf16 v[128:131], v[52:55], v[24:27], v[128:131]
  ds_read_b64_tr_b16 v[44:45], v12 offset:30720
  v_xor_b32 v19, v21, v20
  v_mfma_f32_16x16x32_bf16 v[120:123], v[52:55], a[40:43], v[120:123]
  buffer_load_dwordx4 v5, s[12:15], s46 offen offset:1024  lds
  v_mfma_f32_16x16x32_bf16 v[156:159], v[64:67], a[40:43], v[156:159]
  s_add_u32 m0, s43, 51200
  ds_read_b64_tr_b16 v[46:47], v12 offset:33280
  v_lshl_add_u32 v70, v19, 3, v18
  v_mfma_f32_16x16x32_bf16 v[164:167], v[64:67], v[24:27], v[164:167]
  ds_read_b64_tr_b16 v[36:37], v11 offset:30800
  v_add_u32 v21, 1, v21
  v_mfma_f32_16x16x32_bf16 v[160:163], v[64:67], a[44:47], v[160:163]
  s_waitcnt lgkmcnt(9)
  ds_read_b64_tr_b16 v[38:39], v11 offset:33360
  v_xor_b32 v19, v21, v20
  v_mfma_f32_16x16x32_bf16 v[136:139], v[56:59], a[44:47], v[136:139]
  ds_read_b64_tr_b16 v[40:41], v11 offset:30840
  v_lshl_add_u32 v71, v19, 3, v18
  v_mfma_f32_16x16x32_bf16 v[140:143], v[56:59], v[24:27], v[140:143]
  buffer_load_dwordx4 v7, s[16:19], s44 offen offset:1024  lds
  v_mfma_f32_16x16x32_bf16 v[132:135], v[56:59], a[40:43], v[132:135]
  ds_read_b64_tr_b16 v[42:43], v11 offset:33400
  v_add_u32 v21, 1, v21
  v_mfma_f32_16x16x32_bf16 v[144:147], v[60:63], a[40:43], v[144:147]
  v_xor_b32 v19, v21, v20
  v_lshl_add_u32 v72, v19, 3, v18
  v_mfma_f32_16x16x32_bf16 v[152:155], v[60:63], v[24:27], v[152:155]
  v_lshrrev_b32 v18, 2, v1
  v_and_b32 v20, 1, v1
  v_mfma_f32_16x16x32_bf16 v[148:151], v[60:63], a[44:47], v[148:151]
  v_mul_u32_u24 v20, 1440, v20
  v_mad_u32_u24 v19, v18, 40, v20
  s_waitcnt lgkmcnt(10)
  v_mfma_f32_16x16x32_bf16 v[180:183], a[52:55], a[52:55], v[180:183]
  s_add_u32 m0, s42, 4096
  ds_read_b128 a[56:59], v10 offset:12288
  v_bfe_u32 v20, v1, 1, 1
  v_mfma_f32_16x16x32_bf16 v[172:175], v[24:27], a[52:55], v[172:175]
  ds_read_b128 a[60:63], v10 offset:14336
  v_mul_u32_u24 v20, 18, v20
  v_mfma_f32_16x16x32_bf16 v[168:171], v[24:27], a[48:51], v[168:171]
  buffer_load_dwordx4 v4, s[12:15], s47 offen offset:2048  lds
  v_mfma_f32_16x16x32_bf16 v[176:179], a[48:51], a[48:51], v[176:179]
  s_waitcnt lgkmcnt(6)
  ds_read_b64_tr_b16 v[48:49], v11 offset:35840
  v_sub_u32 v18, v18, v20
  v_mfma_f32_16x16x32_bf16 v[108:111], v[28:31], a[48:51], v[108:111]
  ds_read_b64_tr_b16 v[50:51], v11 offset:38400
  v_mov_b32 v20, 157696
  v_mfma_f32_16x16x32_bf16 v[116:119], v[28:31], v[24:27], v[116:119]
  ds_read_b64_tr_b16 v[52:53], v11 offset:35872
  v_cmp_gt_u32 vcc, 18, v18
  v_mfma_f32_16x16x32_bf16 v[112:115], v[28:31], a[52:55], v[112:115]
  ds_read_b64_tr_b16 v[54:55], v11 offset:38432
  v_add_u32 v19, 158592, v19
  v_mfma_f32_16x16x32_bf16 v[124:127], v[32:35], a[52:55], v[124:127]
  ds_read_b64_tr_b16 v[64:65], v12 offset:35840
  v_add_u32 v18, 16, v18
  v_mfma_f32_16x16x32_bf16 v[128:131], v[32:35], v[24:27], v[128:131]
  s_add_u32 m0, s43, 51200
  s_mov_b32 exec_hi, 0
  buffer_load_dwordx4 v8, s[16:19], s44 offen offset:2048  lds
  s_mov_b64 exec, -1
  v_mfma_f32_16x16x32_bf16 v[120:123], v[32:35], a[48:51], v[120:123]
  s_add_u32 s39, s39, 1
  ds_read_b64_tr_b16 v[66:67], v12 offset:38400
  v_cndmask_b32 v88, v20, v19, vcc
  v_mfma_f32_16x16x32_bf16 v[156:159], v[44:47], a[48:51], v[156:159]
  s_cmp_eq_u32 s39, 9
  s_cselect_b32 s39, 0, s39
  ds_read_b64_tr_b16 v[56:57], v11 offset:35920
  v_mfma_f32_16x16x32_bf16 v[164:167], v[44:47], v[24:27], v[164:167]
  s_mul_i32 s44, s39, 221184
  ds_read_b64_tr_b16 v[58:59], v11 offset:38480
  s_add_u32 s44, s44, s41
  v_mfma_f32_16x16x32_bf16 v[160:163], v[44:47], a[52:55], v[160:163]
  s_waitcnt lgkmcnt(10)
  ds_read_b64_tr_b16 v[60:61], v11 offset:35960
  s_add_u32 m0, s42, 4096
  v_mfma_f32_16x16x32_bf16 v[136:139], v[36:39], a[52:55], v[136:139]
  ds_read_b64_tr_b16 v[62:63], v11 offset:38520
  v_cmp_gt_u32 vcc, 18, v18
  v_mfma_f32_16x16x32_bf16 v[140:143], v[36:39], v[24:27], v[140:143]
  buffer_load_dwordx4 v5, s[12:15], s47 offen offset:3072  lds
  v_mfma_f32_16x16x32_bf16 v[132:135], v[36:39], a[48:51], v[132:135]
  v_add_u32 v19, 640, v19
  v_add_u32 v18, 16, v18
  v_mfma_f32_16x16x32_bf16 v[144:147], v[40:43], a[48:51], v[144:147]
  v_cndmask_b32 v89, v20, v19, vcc
  v_cmp_gt_u32 vcc, 18, v18
  v_mfma_f32_16x16x32_bf16 v[152:155], v[40:43], v[24:27], v[152:155]
  v_add_u32 v19, 640, v19
  v_add_u32 v18, 16, v18
  v_mfma_f32_16x16x32_bf16 v[148:151], v[40:43], a[52:55], v[148:151]
  v_cndmask_b32 v90, v20, v19, vcc
  v_lshrrev_b32 v18, 2, v1
  s_waitcnt lgkmcnt(10)
  s_waitcnt vmcnt(7)
  s_barrier
  v_mfma_f32_16x16x32_bf16 v[180:183], a[60:63], a[60:63], v[180:183]
  s_add_u32 m0, s43, 61440
  ds_read_b128 a[64:67], v9 offset:0
  v_and_b32 v19, 3, v1
  v_mfma_f32_16x16x32_bf16 v[172:175], v[24:27], a[60:63], v[172:175]
  buffer_load_dwordx4 v6, s[16:19], s44 offen offset:0  lds
  v_mfma_f32_16x16x32_bf16 v[168:171], v[24:27], a[56:59], v[168:171]
  s_lshl_b32 s46, s39, 7
  ds_read_b128 a[68:71], v9 offset:2048
  s_add_u32 s46, s46, s40
  v_mfma_f32_16x16x32_bf16 v[176:179], a[56:59], a[56:59], v[176:179]
  s_waitcnt lgkmcnt(6)
  ds_read_b64_tr_b16 v[28:29], v11 offset:40960
  s_add_u32 s47, s46, 16384
  v_mfma_f32_16x16x32_bf16 v[108:111], v[48:51], a[56:59], v[108:111]
  s_add_u32 m0, s42, 8192
  ds_read_b64_tr_b16 v[30:31], v11 offset:43520
  v_xor_b32 v19, v19, v3
  v_mfma_f32_16x16x32_bf16 v[116:119], v[48:51], v[24:27], v[116:119]
  buffer_load_dwordx4 v4, s[12:15], s46 offen offset:0  lds
  v_mfma_f32_16x16x32_bf16 v[112:115], v[48:51], a[60:63], v[112:115]
  ds_read_b64_tr_b16 v[32:33], v11 offset:40992
  v_mul_u32_u24 v231, 96, v18
  v_mfma_f32_16x16x32_bf16 v[124:127], v[52:55], a[60:63], v[124:127]
  ds_read_b64_tr_b16 v[34:35], v11 offset:43552
  v_lshl_add_u32 v231, v19, 3, v231
  v_mfma_f32_16x16x32_bf16 v[128:131], v[52:55], v[24:27], v[128:131]
  s_and_b32 s49, s3, 1
  ds_read_b64_tr_b16 v[44:45], v12 offset:40960
  v_add_u32 v18, s49, v18
  v_mfma_f32_16x16x32_bf16 v[120:123], v[52:55], a[56:59], v[120:123]
  buffer_load_dwordx4 v5, s[12:15], s46 offen offset:1024  lds
  v_mfma_f32_16x16x32_bf16 v[156:159], v[64:67], a[56:59], v[156:159]
  s_add_u32 m0, s43, 61440
  ds_read_b64_tr_b16 v[46:47], v12 offset:43520
  v_lshl_add_u32 v232, v18, 6, v231
  v_mfma_f32_16x16x32_bf16 v[164:167], v[64:67], v[24:27], v[164:167]
  s_min_u32 s48, s3, 2
  ds_read_b64_tr_b16 v[36:37], v11 offset:41040
  s_lshl_b32 s48, s48, 5
  v_mfma_f32_16x16x32_bf16 v[160:163], v[64:67], a[60:63], v[160:163]
  s_waitcnt lgkmcnt(9)
  ds_read_b64_tr_b16 v[38:39], v11 offset:43600
  v_add_u32 v231, s48, v231
  v_mfma_f32_16x16x32_bf16 v[136:139], v[56:59], a[60:63], v[136:139]
  ds_read_b64_tr_b16 v[40:41], v11 offset:41080
  v_add_u32 v239, 92160, v11
  v_mfma_f32_16x16x32_bf16 v[140:143], v[56:59], v[24:27], v[140:143]
  buffer_load_dwordx4 v7, s[16:19], s44 offen offset:1024  lds
  v_mfma_f32_16x16x32_bf16 v[132:135], v[56:59], a[56:59], v[132:135]
L_hop1:
  s_cbranch_execz L_hop5
  s_mul_i32 s50, s49, 1216
  ds_read_b64_tr_b16 v[42:43], v11 offset:43640
  v_mul_u32_u24 v18, 152, v3
  v_mfma_f32_16x16x32_bf16 v[144:147], v[60:63], a[56:59], v[144:147]
  v_add_u32 v18, s50, v18
  s_lshl_b32 s50, s49, 1
  v_mfma_f32_16x16x32_bf16 v[152:155], v[60:63], v[24:27], v[152:155]
  v_add_u32 v19, s50, v2
  v_subrev_u32 v20, s50, v2
  v_mfma_f32_16x16x32_bf16 v[148:151], v[60:63], a[60:63], v[148:151]
  s_lshl_b32 s51, s49, 4
  s_xor_b32 s51, s51, 16
  v_cmp_gt_u32 vcc, 2, v20
  s_waitcnt lgkmcnt(10)
  v_mfma_f32_16x16x32_bf16 v[180:183], a[68:71], a[68:71], v[180:183]
  s_add_u32 m0, s42, 8192
  ds_read_b128 a[72:75], v10 offset:0
  v_add_u32 v20, s51, v20
  v_mfma_f32_16x16x32_bf16 v[172:175], v[24:27], a[68:71], v[172:175]
  ds_read_b128 a[76:79], v10 offset:2048
  v_mov_b32 v21, 134217728
  v_mfma_f32_16x16x32_bf16 v[168:171], v[24:27], a[64:67], v[168:171]
  buffer_load_dwordx4 v4, s[12:15], s47 offen offset:2048  lds
  v_mfma_f32_16x16x32_bf16 v[176:179], a[64:67], a[64:67], v[176:179]
  s_waitcnt lgkmcnt(6)
  ds_read_b64_tr_b16 v[48:49], v11 offset:46080
  v_cndmask_b32 v20, v21, v20, vcc
  v_mfma_f32_16x16x32_bf16 v[108:111], v[28:31], a[64:67], v[108:111]
  ds_read_b64_tr_b16 v[50:51], v11 offset:48640
  v_cmp_eq_u32 vcc, 4, v2
  v_mfma_f32_16x16x32_bf16 v[116:119], v[28:31], v[24:27], v[116:119]
  ds_read_b64_tr_b16 v[52:53], v11 offset:46112
  v_add_u32 v21, 14, v2
  v_mfma_f32_16x16x32_bf16 v[112:115], v[28:31], a[68:71], v[112:115]
  ds_read_b64_tr_b16 v[54:55], v11 offset:48672
  v_lshl_add_u32 v22, v21, 3, v18
  v_mfma_f32_16x16x32_bf16 v[124:127], v[32:35], a[68:71], v[124:127]
  s_lshl_b32 s50, s36, 16
  ds_read_b64_tr_b16 v[64:65], v12 offset:46080
  v_cndmask_b32 v20, v20, v21, vcc
  v_mfma_f32_16x16x32_bf16 v[128:131], v[32:35], v[24:27], v[128:131]
  s_add_u32 m0, s43, 61440
  s_mov_b32 exec_hi, 0
  buffer_load_dwordx4 v8, s[16:19], s44 offen offset:2048  lds
  s_mov_b64 exec, -1
  v_mfma_f32_16x16x32_bf16 v[120:123], v[32:35], a[64:67], v[120:123]
  s_add_u32 s39, s39, 1
  ds_read_b64_tr_b16 v[66:67], v12 offset:48640
  v_mfma_f32_16x16x32_bf16 v[156:159], v[44:47], a[64:67], v[156:159]
  s_cmp_eq_u32 s39, 9
  s_cselect_b32 s39, 0, s39
  ds_read_b64_tr_b16 v[56:57], v11 offset:46160
  v_mfma_f32_16x16x32_bf16 v[164:167], v[44:47], v[24:27], v[164:167]
  s_mul_i32 s44, s39, 221184
  ds_read_b64_tr_b16 v[58:59], v11 offset:48720
  s_add_u32 s44, s44, s41
  v_mfma_f32_16x16x32_bf16 v[160:163], v[44:47], a[68:71], v[160:163]
  s_waitcnt lgkmcnt(10)
  ds_read_b64_tr_b16 v[60:61], v11 offset:46200
  s_add_u32 m0, s42, 8192
  v_mfma_f32_16x16x32_bf16 v[136:139], v[36:39], a[68:71], v[136:139]
  s_cmp_lt_u32 s3, 2
  s_cselect_b64 vcc, -1, 0
  ds_read_b64_tr_b16 v[62:63], v11 offset:48760
  v_mfma_f32_16x16x32_bf16 v[140:143], v[36:39], v[24:27], v[140:143]
  buffer_load_dwordx4 v5, s[12:15], s47 offen offset:3072  lds
  v_mfma_f32_16x16x32_bf16 v[132:135], v[36:39], a[64:67], v[132:135]
  v_cndmask_b32 v19, v20, v19, vcc
  v_lshl_add_u32 v234, v19, 3, v18
  v_mfma_f32_16x16x32_bf16 v[144:147], v[40:43], a[64:67], v[144:147]
  v_lshrrev_b32 v19, 1, v3
  v_cmp_le_u32 vcc, s49, v19
  v_mfma_f32_16x16x32_bf16 v[152:155], v[40:43], v[24:27], v[152:155]
  v_mov_b32 v21, 1073741824
  s_add_u32 s53, s50, 54525952
  v_mfma_f32_16x16x32_bf16 v[148:151], v[40:43], a[68:71], v[148:151]
  v_cndmask_b32 v233, v21, v234, vcc
  v_cmp_ge_u32 vcc, s49, v19
  s_waitcnt lgkmcnt(10)
  s_waitcnt vmcnt(7)
  s_barrier
  v_mfma_f32_16x16x32_bf16 v[180:183], a[76:79], a[76:79], v[180:183]
  s_add_u32 m0, s43, 71680
  ds_read_b128 a[80:83], v9 offset:4096
  s_lshl_b32 s50, s37, 12
  v_mfma_f32_16x16x32_bf16 v[172:175], v[24:27], a[76:79], v[172:175]
  buffer_load_dwordx4 v6, s[16:19], s44 offen offset:0  lds
  v_mfma_f32_16x16x32_bf16 v[168:171], v[24:27], a[72:75], v[168:171]
  s_lshl_b32 s46, s39, 7
  ds_read_b128 a[84:87], v9 offset:6144
  s_add_u32 s46, s46, s40
  v_mfma_f32_16x16x32_bf16 v[176:179], a[72:75], a[72:75], v[176:179]
  s_waitcnt lgkmcnt(6)
  ds_read_b64_tr_b16 v[28:29], v13 offset:0
  s_add_u32 s47, s46, 16384
  v_mfma_f32_16x16x32_bf16 v[108:111], v[48:51], a[72:75], v[108:111]
  s_add_u32 m0, s42, 12288
  ds_read_b64_tr_b16 v[30:31], v13 offset:2560
  s_add_u32 s55, s50, s53
  v_mfma_f32_16x16x32_bf16 v[116:119], v[48:51], v[24:27], v[116:119]
  buffer_load_dwordx4 v4, s[12:15], s46 offen offset:0  lds
  v_mfma_f32_16x16x32_bf16 v[112:115], v[48:51], a[76:79], v[112:115]
  ds_read_b64_tr_b16 v[32:33], v13 offset:32
  v_cndmask_b32 v235, v21, v234, vcc
  v_mfma_f32_16x16x32_bf16 v[124:127], v[52:55], a[76:79], v[124:127]
  ds_read_b64_tr_b16 v[34:35], v13 offset:2592
  v_subrev_u32 v21, 245, v0
  v_mfma_f32_16x16x32_bf16 v[128:131], v[52:55], v[24:27], v[128:131]
  ds_read_b64_tr_b16 v[44:45], v14 offset:0
  v_cmp_gt_u32 vcc, 4, v21
  v_mfma_f32_16x16x32_bf16 v[120:123], v[52:55], a[72:75], v[120:123]
  buffer_load_dwordx4 v5, s[12:15], s46 offen offset:1024  lds
  v_mfma_f32_16x16x32_bf16 v[156:159], v[64:67], a[72:75], v[156:159]
  s_add_u32 m0, s43, 71680
  ds_read_b64_tr_b16 v[46:47], v14 offset:2560
  s_lshl_b32 s48, s36, 7
  v_mfma_f32_16x16x32_bf16 v[164:167], v[64:67], v[24:27], v[164:167]
  s_add_u32 s48, s48, 58720256
  ds_read_b64_tr_b16 v[36:37], v13 offset:80
  v_cndmask_b32 v235, v235, v22, vcc
  v_mfma_f32_16x16x32_bf16 v[160:163], v[64:67], a[76:79], v[160:163]
  s_waitcnt lgkmcnt(9)
  ds_read_b64_tr_b16 v[38:39], v13 offset:2640
  v_mfma_f32_16x16x32_bf16 v[136:139], v[56:59], a[76:79], v[136:139]
  s_cmp_eq_u32 s3, 0
  s_cselect_b32 s52, s48, 1073741824
  ds_read_b64_tr_b16 v[40:41], v13 offset:120
  v_mfma_f32_16x16x32_bf16 v[140:143], v[56:59], v[24:27], v[140:143]
  buffer_load_dwordx4 v7, s[16:19], s44 offen offset:1024  lds
  v_mfma_f32_16x16x32_bf16 v[132:135], v[56:59], a[72:75], v[132:135]
  ds_read_b64_tr_b16 v[42:43], v13 offset:2680
  v_add_u32 v233, 158592, v233
  v_mfma_f32_16x16x32_bf16 v[144:147], v[60:63], a[72:75], v[144:147]
  v_min_u32 v233, 161792, v233
  v_add_u32 v234, 158592, v234
  v_mfma_f32_16x16x32_bf16 v[152:155], v[60:63], v[24:27], v[152:155]
  v_min_u32 v234, 161792, v234
  v_add_u32 v235, 158592, v235
  v_mfma_f32_16x16x32_bf16 v[148:151], v[60:63], a[76:79], v[148:151]
  v_min_u32 v235, 161792, v235
  s_mul_i32 s48, s3, 768
  s_waitcnt lgkmcnt(10)
  v_mfma_f32_16x16x32_bf16 v[180:183], a[84:87], a[84:87], v[180:183]
  s_add_u32 m0, s42, 12288
  ds_read_b128 a[88:91], v10 offset:4096
  s_add_u32 s55, s55, s48
  v_mfma_f32_16x16x32_bf16 v[172:175], v[24:27], a[84:87], v[172:175]
  s_add_u32 s48, s48, 158592
  ds_read_b128 a[92:95], v10 offset:6144
  v_add_u32 v230, s48, v253
  v_mfma_f32_16x16x32_bf16 v[168:171], v[24:27], a[80:83], v[168:171]
  buffer_load_dwordx4 v4, s[12:15], s47 offen offset:2048  lds
  v_mfma_f32_16x16x32_bf16 v[176:179], a[80:83], a[80:83], v[176:179]
  s_waitcnt lgkmcnt(6)
  ds_read_b64_tr_b16 v[48:49], v13 offset:5120
  v_mfma_f32_16x16x32_bf16 v[108:111], v[28:31], a[80:83], v[108:111]
  s_bitcmp1_b32 s3, 0
  s_cselect_b32 s48, 72, s54
  s_cmp_ge_u32 s48, 72
  s_cbranch_scc1 L_wb3
  buffer_atomic_add v17, v15, s[32:35], 0 offen offset:128 sc1
L_wb3:
  v_mfma_f32_16x16x32_bf16 v[116:119], v[28:31], v[24:27], v[116:119]
  buffer_load_dword v16, off, s[32:35], 0 offset:0 sc1
  v_mfma_f32_16x16x32_bf16 v[112:115], v[28:31], a[84:87], v[112:115]
  s_lshr_b32 s48, s2, 3
  ds_read_b64_tr_b16 v[50:51], v13 offset:7680
  s_lshl_b32 s48, s48, 2
  v_mfma_f32_16x16x32_bf16 v[124:127], v[32:35], a[84:87], v[124:127]
  s_add_u32 s48, s48, s3
  ds_read_b64_tr_b16 v[52:53], v13 offset:5152
  s_and_b32 s49, s2, 7
  v_mfma_f32_16x16x32_bf16 v[128:131], v[32:35], v[24:27], v[128:131]
  s_add_u32 m0, s43, 71680
  s_mov_b32 exec_hi, 0
  buffer_load_dwordx4 v8, s[16:19], s44 offen offset:2048  lds
  s_mov_b64 exec, -1
  v_mfma_f32_16x16x32_bf16 v[120:123], v[32:35], a[80:83], v[120:123]
  s_add_u32 s39, s39, 1
  ds_read_b64_tr_b16 v[54:55], v13 offset:7712
  s_mul_i32 s51, s49, 1152
  v_mfma_f32_16x16x32_bf16 v[156:159], v[44:47], a[80:83], v[156:159]
  s_cmp_eq_u32 s39, 9
  s_cselect_b32 s39, 0, s39
  ds_read_b64_tr_b16 v[64:65], v14 offset:5120
  v_mfma_f32_16x16x32_bf16 v[164:167], v[44:47], v[24:27], v[164:167]
  s_mul_i32 s44, s39, 221184
  ds_read_b64_tr_b16 v[66:67], v14 offset:7680
  s_add_u32 s44, s44, s41
  v_mfma_f32_16x16x32_bf16 v[160:163], v[44:47], a[84:87], v[160:163]
  s_waitcnt lgkmcnt(8)
  ds_read_b64_tr_b16 v[56:57], v13 offset:5200
  s_add_u32 m0, s42, 12288
  v_mfma_f32_16x16x32_bf16 v[136:139], v[36:39], a[84:87], v[136:139]
  s_mul_i32 s50, s48, 18
  ds_read_b64_tr_b16 v[58:59], v13 offset:7760
  v_min_u32 v18, 17, v1
  v_mfma_f32_16x16x32_bf16 v[140:143], v[36:39], v[24:27], v[140:143]
  buffer_load_dwordx4 v5, s[12:15], s47 offen offset:3072  lds
  v_mfma_f32_16x16x32_bf16 v[132:135], v[36:39], a[80:83], v[132:135]
  ds_read_b64_tr_b16 v[60:61], v13 offset:5240
  v_add_u32 v18, s50, v18
  v_mfma_f32_16x16x32_bf16 v[144:147], v[40:43], a[80:83], v[144:147]
  ds_read_b64_tr_b16 v[62:63], v13 offset:7800
  v_lshrrev_b32 v19, 2, v18
  v_mfma_f32_16x16x32_bf16 v[152:155], v[40:43], v[24:27], v[152:155]
  v_mul_u32_u24 v19, 8192, v19
  v_lshl_add_u32 v19, v18, 8, v19
  v_mfma_f32_16x16x32_bf16 v[148:151], v[40:43], a[84:87], v[148:151]
  v_add_u32 v244, s51, v19
  v_add_u32 v245, 128, v244
  s_waitcnt lgkmcnt(10)
  s_waitcnt vmcnt(8)
  s_barrier
  v_mfma_f32_16x16x32_bf16 v[180:183], a[92:95], a[92:95], v[180:183]
  s_add_u32 m0, s43, 81920
  ds_read_b128 a[96:99], v9 offset:8192
  s_mul_i32 s50, s48, 36
  v_mfma_f32_16x16x32_bf16 v[172:175], v[24:27], a[92:95], v[172:175]
  buffer_load_dwordx4 v6, s[16:19], s44 offen offset:0  lds
  v_mfma_f32_16x16x32_bf16 v[168:171], v[24:27], a[88:91], v[168:171]
  s_lshl_b32 s46, s39, 7
  ds_read_b128 a[100:103], v9 offset:10240
  s_add_u32 s46, s46, s40
  v_mfma_f32_16x16x32_bf16 v[176:179], a[88:91], a[88:91], v[176:179]
  s_waitcnt lgkmcnt(6)
  ds_read_b64_tr_b16 v[28:29], v13 offset:10240
  s_add_u32 s47, s46, 16384
  v_mfma_f32_16x16x32_bf16 v[108:111], v[48:51], a[88:91], v[108:111]
  s_add_u32 m0, s42, 0
  ds_read_b64_tr_b16 v[30:31], v13 offset:12800
  v_min_u32 v18, 35, v1
  v_mfma_f32_16x16x32_bf16 v[116:119], v[48:51], v[24:27], v[116:119]
  buffer_load_dwordx4 v4, s[12:15], s46 offen offset:0  lds
  v_mfma_f32_16x16x32_bf16 v[112:115], v[48:51], a[92:95], v[112:115]
  ds_read_b64_tr_b16 v[32:33], v13 offset:10272
  v_add_u32 v18, s50, v18
  v_mfma_f32_16x16x32_bf16 v[124:127], v[52:55], a[92:95], v[124:127]
  ds_read_b64_tr_b16 v[34:35], v13 offset:12832
  v_lshrrev_b32 v19, 3, v18
  v_mfma_f32_16x16x32_bf16 v[128:131], v[52:55], v[24:27], v[128:131]
  ds_read_b64_tr_b16 v[44:45], v14 offset:10240
  v_add_u32 v18, v18, v19
  v_mfma_f32_16x16x32_bf16 v[120:123], v[52:55], a[88:91], v[120:123]
  buffer_load_dwordx4 v5, s[12:15], s46 offen offset:1024  lds
  v_mfma_f32_16x16x32_bf16 v[156:159], v[64:67], a[88:91], v[156:159]
  s_add_u32 m0, s43, 81920
  ds_read_b64_tr_b16 v[46:47], v14 offset:12800
  s_mul_i32 s51, s49, 663552
  v_mfma_f32_16x16x32_bf16 v[164:167], v[64:67], v[24:27], v[164:167]
  ds_read_b64_tr_b16 v[36:37], v13 offset:10320
  v_lshl_add_u32 v246, v18, 7, s51
  v_mfma_f32_16x16x32_bf16 v[160:163], v[64:67], a[92:95], v[160:163]
  s_waitcnt lgkmcnt(9)
  ds_read_b64_tr_b16 v[38:39], v13 offset:12880
  s_and_b32 s48, s3, 1
  v_mfma_f32_16x16x32_bf16 v[136:139], v[56:59], a[92:95], v[136:139]
  s_mul_i32 s48, s48, 110592
  ds_read_b64_tr_b16 v[40:41], v13 offset:10360
  s_mul_i32 s49, s36, 72
  v_mfma_f32_16x16x32_bf16 v[140:143], v[56:59], v[24:27], v[140:143]
  buffer_load_dwordx4 v7, s[16:19], s44 offen offset:1024  lds
  v_mfma_f32_16x16x32_bf16 v[132:135], v[56:59], a[88:91], v[132:135]
  s_and_b32 s49, s49, -16
  ds_read_b64_tr_b16 v[42:43], v13 offset:12920
  s_add_u32 s48, s48, s49
  v_mfma_f32_16x16x32_bf16 v[144:147], v[60:63], a[88:91], v[144:147]
  s_lshr_b32 s49, s3, 1
  s_add_u32 s49, s49, s38
  s_add_u32 s50, s49, 0
  v_mfma_f32_16x16x32_bf16 v[152:155], v[60:63], v[24:27], v[152:155]
  s_sub_u32 s51, s50, 9
  s_cselect_b32 s50, s50, s51
  s_mul_i32 s50, s50, 221184
  v_mfma_f32_16x16x32_bf16 v[148:151], v[60:63], a[92:95], v[148:151]
  s_add_u32 s20, s50, s48
  s_add_u32 s50, s49, 2
  s_waitcnt lgkmcnt(10)
  v_mfma_f32_16x16x32_bf16 v[180:183], a[100:103], a[100:103], v[180:183]
  s_add_u32 m0, s42, 0
  ds_read_b128 a[104:107], v10 offset:8192
  v_mfma_f32_16x16x32_bf16 v[172:175], v[24:27], a[100:103], v[172:175]
  s_sub_u32 s51, s50, 9
  s_cselect_b32 s50, s50, s51
  ds_read_b128 a[108:111], v10 offset:10240
  v_mfma_f32_16x16x32_bf16 v[168:171], v[24:27], a[96:99], v[168:171]
  buffer_load_dwordx4 v4, s[12:15], s47 offen offset:2048  lds
  v_mfma_f32_16x16x32_bf16 v[176:179], a[96:99], a[96:99], v[176:179]
  s_waitcnt lgkmcnt(6)
  ds_read_b64_tr_b16 v[48:49], v13 offset:15360
  s_mul_i32 s50, s50, 221184
  v_mfma_f32_16x16x32_bf16 v[108:111], v[28:31], a[96:99], v[108:111]
  s_add_u32 s21, s50, s48
  ds_read_b64_tr_b16 v[50:51], v13 offset:17920
  s_add_u32 s50, s49, 4
  v_mfma_f32_16x16x32_bf16 v[116:119], v[28:31], v[24:27], v[116:119]
  s_sub_u32 s51, s50, 9
  s_cselect_b32 s50, s50, s51
  ds_read_b64_tr_b16 v[52:53], v13 offset:15392
  v_mfma_f32_16x16x32_bf16 v[112:115], v[28:31], a[100:103], v[112:115]
  s_mul_i32 s50, s50, 221184
  ds_read_b64_tr_b16 v[54:55], v13 offset:17952
  s_add_u32 s22, s50, s48
  v_mfma_f32_16x16x32_bf16 v[124:127], v[32:35], a[100:103], v[124:127]
  s_add_u32 s50, s49, 6
  ds_read_b64_tr_b16 v[64:65], v14 offset:15360
  v_mfma_f32_16x16x32_bf16 v[128:131], v[32:35], v[24:27], v[128:131]
  s_add_u32 m0, s43, 81920
  s_mov_b32 exec_hi, 0
  buffer_load_dwordx4 v8, s[16:19], s44 offen offset:2048  lds
  s_mov_b64 exec, -1
  v_mfma_f32_16x16x32_bf16 v[120:123], v[32:35], a[96:99], v[120:123]
  s_add_u32 s39, s39, 1
  ds_read_b64_tr_b16 v[66:67], v14 offset:17920
  v_mfma_f32_16x16x32_bf16 v[156:159], v[44:47], a[96:99], v[156:159]
  s_cmp_eq_u32 s39, 9
  s_cselect_b32 s39, 0, s39
  ds_read_b64_tr_b16 v[56:57], v13 offset:15440
  v_mfma_f32_16x16x32_bf16 v[164:167], v[44:47], v[24:27], v[164:167]
  s_mul_i32 s44, s39, 221184
  ds_read_b64_tr_b16 v[58:59], v13 offset:18000
  s_add_u32 s44, s44, s41
  v_mfma_f32_16x16x32_bf16 v[160:163], v[44:47], a[100:103], v[160:163]
  s_waitcnt lgkmcnt(10)
  ds_read_b64_tr_b16 v[60:61], v13 offset:15480
  s_add_u32 m0, s42, 0
  v_mfma_f32_16x16x32_bf16 v[136:139], v[36:39], a[100:103], v[136:139]
  s_sub_u32 s51, s50, 9
  s_cselect_b32 s50, s50, s51
  ds_read_b64_tr_b16 v[62:63], v13 offset:18040
  v_mfma_f32_16x16x32_bf16 v[140:143], v[36:39], v[24:27], v[140:143]
  buffer_load_dwordx4 v5, s[12:15], s47 offen offset:3072  lds
  v_mfma_f32_16x16x32_bf16 v[132:135], v[36:39], a[96:99], v[132:135]
  s_mul_i32 s50, s50, 221184
  s_add_u32 s23, s50, s48
  s_add_u32 s50, s38, 8
  v_mfma_f32_16x16x32_bf16 v[144:147], v[40:43], a[96:99], v[144:147]
  s_sub_u32 s51, s50, 9
  s_cselect_b32 s50, s50, s51
  s_mul_i32 s50, s50, 221184
  v_mfma_f32_16x16x32_bf16 v[152:155], v[40:43], v[24:27], v[152:155]
  s_add_u32 s78, s50, s48
  s_lshr_b32 s48, s2, 3
  s_lshl_b32 s48, s48, 2
  v_mfma_f32_16x16x32_bf16 v[148:151], v[40:43], a[100:103], v[148:151]
  s_add_u32 s48, s48, s3
  s_min_u32 s48, s48, 107
  s_mul_i32 s49, s48, 57
  s_waitcnt lgkmcnt(10)
  s_waitcnt vmcnt(7)
  s_barrier
  v_mfma_f32_16x16x32_bf16 v[180:183], a[108:111], a[108:111], v[180:183]
  global_load_dword v247, v244, s[4:5]
  v_mfma_f32_16x16x32_bf16 v[172:175], v[24:27], a[108:111], v[172:175]
  s_lshr_b32 s49, s49, 11
  ds_read_b128 a[112:115], v9 offset:12288
  s_mul_i32 s50, s49, 36
  v_mfma_f32_16x16x32_bf16 v[168:171], v[24:27], a[104:107], v[168:171]
  s_sub_u32 s48, s48, s50
  ds_read_b128 a[116:119], v9 offset:14336
  s_and_b32 s50, s2, 7
  v_mfma_f32_16x16x32_bf16 v[176:179], a[104:107], a[104:107], v[176:179]
  s_waitcnt lgkmcnt(6)
  ds_read_b64_tr_b16 v[28:29], v13 offset:20480
  s_mul_i32 s51, s50, 221184
  v_mfma_f32_16x16x32_bf16 v[108:111], v[48:51], a[104:107], v[108:111]
  global_load_dword v247, v245, s[4:5]
  v_mfma_f32_16x16x32_bf16 v[116:119], v[48:51], v[24:27], v[116:119]
  s_lshr_b32 s46, s2, 3
  ds_read_b64_tr_b16 v[30:31], v13 offset:23040
  s_lshl_b32 s46, s46, 2
  v_mfma_f32_16x16x32_bf16 v[112:115], v[48:51], a[108:111], v[112:115]
  s_add_u32 s46, s46, s3
  ds_read_b64_tr_b16 v[32:33], v13 offset:20512
  s_mul_i32 s46, s46, 9
  v_mfma_f32_16x16x32_bf16 v[124:127], v[52:55], a[108:111], v[124:127]
  s_mul_i32 s79, s49, 18432
  ds_read_b64_tr_b16 v[34:35], v13 offset:23072
  v_min_u32 v91, 8, v1
  v_mfma_f32_16x16x32_bf16 v[128:131], v[52:55], v[24:27], v[128:131]
  s_add_u32 s79, s79, s51
  ds_read_b64_tr_b16 v[44:45], v14 offset:20480
  v_add_u32 v91, s46, v91
  v_mfma_f32_16x16x32_bf16 v[120:123], v[52:55], a[104:107], v[120:123]
  s_lshl_b32 s51, s48, 9
  ds_read_b64_tr_b16 v[46:47], v14 offset:23040
  v_lshrrev_b32 v92, 1, v91
  v_mfma_f32_16x16x32_bf16 v[156:159], v[64:67], a[104:107], v[156:159]
  s_add_u32 s79, s79, s51
  ds_read_b64_tr_b16 v[36:37], v13 offset:20560
  v_mul_u32_u24 v92, 3200, v92
  v_mfma_f32_16x16x32_bf16 v[164:167], v[64:67], v[24:27], v[164:167]
  s_add_u32 s79, s79, 59768832
  ds_read_b64_tr_b16 v[38:39], v13 offset:23120
  v_lshl_add_u32 v91, v91, 7, v92
  v_mfma_f32_16x16x32_bf16 v[160:163], v[64:67], a[108:111], v[160:163]
  s_waitcnt lgkmcnt(10)
  ds_read_b64_tr_b16 v[40:41], v13 offset:20600
  s_and_b32 s46, s2, 7
  v_mfma_f32_16x16x32_bf16 v[136:139], v[56:59], a[108:111], v[136:139]
  s_lshl_b32 s46, s46, 7
  ds_read_b64_tr_b16 v[42:43], v13 offset:23160
  v_mfma_f32_16x16x32_bf16 v[140:143], v[56:59], v[24:27], v[140:143]
  buffer_load_dword v247, v91, s[16:19], s46 offen
  v_mfma_f32_16x16x32_bf16 v[132:135], v[56:59], a[104:107], v[132:135]
  s_cmp_lt_u32 s2, 216
  s_cselect_b32 s79, s79, 1073741824
  v_mul_u32_u24 v93, 55296, v3
  v_mfma_f32_16x16x32_bf16 v[144:147], v[60:63], a[104:107], v[144:147]
  v_lshl_add_u32 v93, v2, 4, v93
  s_lshl_b32 s48, s48, 4
  v_mfma_f32_16x16x32_bf16 v[152:155], v[60:63], v[24:27], v[152:155]
  v_lshrrev_b32 v94, 1, v2
  v_add_u32 v94, s48, v94
  v_mfma_f32_16x16x32_bf16 v[148:151], v[60:63], a[108:111], v[148:151]
  s_cmp_eq_u32 s49, 0
  s_cselect_b64 s[74:75], s[4:5], s[6:7]
  s_waitcnt lgkmcnt(10)
  v_mfma_f32_16x16x32_bf16 v[180:183], a[116:119], a[116:119], v[180:183]
  s_cmp_eq_u32 s49, 2
  s_cselect_b64 s[74:75], s[8:9], s[74:75]
  s_cselect_b32 s48, 1, 8
  s_cselect_b32 s51, 576, 1
  v_mfma_f32_16x16x32_bf16 v[172:175], v[24:27], a[116:119], v[172:175]
  s_mul_i32 s50, s50, s51
  ds_read_b128 a[120:123], v10 offset:12288
  v_mul_u32_u24 v94, s48, v94
  v_mfma_f32_16x16x32_bf16 v[168:171], v[24:27], a[112:115], v[168:171]
  ds_read_b128 a[124:127], v10 offset:14336
  v_add_u32 v94, s50, v94
  v_mfma_f32_16x16x32_bf16 v[176:179], a[112:115], a[112:115], v[176:179]
  s_waitcnt lgkmcnt(6)
  ds_read_b64_tr_b16 v[48:49], v13 offset:25600
  v_mul_u32_u24 v94, 1152, v94
  v_mfma_f32_16x16x32_bf16 v[108:111], v[28:31], a[112:115], v[108:111]
  ds_read_b64_tr_b16 v[50:51], v13 offset:28160
  v_lshl_add_u32 v94, v3, 5, v94
  v_mfma_f32_16x16x32_bf16 v[116:119], v[28:31], v[24:27], v[116:119]
  ds_read_b64_tr_b16 v[52:53], v13 offset:25632
  v_and_b32 v100, 1, v2
  v_mfma_f32_16x16x32_bf16 v[112:115], v[28:31], a[116:119], v[112:115]
  ds_read_b64_tr_b16 v[54:55], v13 offset:28192
  v_lshl_add_u32 v94, v100, 4, v94
  v_mfma_f32_16x16x32_bf16 v[124:127], v[32:35], a[116:119], v[124:127]
  s_mul_i32 s48, s48, 9216
  ds_read_b64_tr_b16 v[64:65], v14 offset:25600
  v_mfma_f32_16x16x32_bf16 v[128:131], v[32:35], v[24:27], v[128:131]
  global_load_dwordx4 v[100:103], v94, s[74:75] offset:1024
  v_mfma_f32_16x16x32_bf16 v[120:123], v[32:35], a[112:115], v[120:123]
  ds_read_b64_tr_b16 v[66:67], v14 offset:28160
  v_add_u32 v94, s48, v94
  v_mfma_f32_16x16x32_bf16 v[156:159], v[44:47], a[112:115], v[156:159]
  global_load_dwordx4 v[104:107], v94, s[74:75] offset:1024
  v_mfma_f32_16x16x32_bf16 v[164:167], v[44:47], v[24:27], v[164:167]
  ds_read_b64_tr_b16 v[56:57], v13 offset:25680
  v_and_b32 v18, 1, v2
  v_mfma_f32_16x16x32_bf16 v[160:163], v[44:47], a[116:119], v[160:163]
  s_waitcnt lgkmcnt(9)
  ds_read_b64_tr_b16 v[58:59], v13 offset:28240
  v_lshlrev_b32 v18, 4, v18
  v_mfma_f32_16x16x32_bf16 v[136:139], v[36:39], a[116:119], v[136:139]
  ds_read_b64_tr_b16 v[60:61], v13 offset:25720
  v_mov_b32 v19, 0x3f80
  v_mfma_f32_16x16x32_bf16 v[140:143], v[36:39], v[24:27], v[140:143]
  ds_read_b64_tr_b16 v[62:63], v13 offset:28280
  v_lshlrev_b32 v18, v18, v19
  v_mfma_f32_16x16x32_bf16 v[132:135], v[36:39], a[112:115], v[132:135]
  v_bfe_u32 v19, v2, 1, 2
  v_cmp_eq_u32 vcc, 0, v19
  v_mfma_f32_16x16x32_bf16 v[144:147], v[40:43], a[112:115], v[144:147]
  s_nop 0
  v_cndmask_b32 v20, 0, v18, vcc
  v_accvgpr_write_b32 a240, v20
  v_mfma_f32_16x16x32_bf16 v[152:155], v[40:43], v[24:27], v[152:155]
  v_cmp_eq_u32 vcc, 1, v19
  s_nop 1
  v_cndmask_b32 v20, 0, v18, vcc
  v_mfma_f32_16x16x32_bf16 v[148:151], v[40:43], a[116:119], v[148:151]
  v_accvgpr_write_b32 a241, v20
  v_cmp_eq_u32 vcc, 2, v19
  s_waitcnt lgkmcnt(10)
  v_mfma_f32_16x16x32_bf16 v[180:183], a[124:127], a[124:127], v[180:183]
  s_movk_i32 s44, 12672
  ds_read_b64_tr_b16 a[144:145], v88 offset:0
  v_mad_u32_u24 v6, v248, s44, v6
  v_mfma_f32_16x16x32_bf16 v[172:175], v[24:27], a[124:127], v[172:175]
  ds_read_b64_tr_b16 a[150:151], v88 offset:8
  v_mad_u32_u24 v7, v249, s44, v7
  v_mfma_f32_16x16x32_bf16 v[168:171], v[24:27], a[120:123], v[168:171]
  ds_read_b64_tr_b16 a[156:157], v88 offset:16
  v_mad_u32_u24 v8, v250, s44, v8
  v_mfma_f32_16x16x32_bf16 v[176:179], a[120:123], a[120:123], v[176:179]
  s_waitcnt lgkmcnt(7)
  ds_read_b64_tr_b16 a[162:163], v88 offset:24
  s_add_u32 m0, s42, 4096
  v_mfma_f32_16x16x32_bf16 v[108:111], v[48:51], a[120:123], v[108:111]
  ds_read_b64_tr_b16 a[168:169], v88 offset:32
  v_cndmask_b32 v20, 0, v18, vcc
  v_mfma_f32_16x16x32_bf16 v[116:119], v[48:51], v[24:27], v[116:119]
  ds_read_b64_tr_b16 a[146:147], v89 offset:0
  v_accvgpr_write_b32 a242, v20
  v_mfma_f32_16x16x32_bf16 v[112:115], v[48:51], a[124:127], v[112:115]
  ds_read_b64_tr_b16 a[152:153], v89 offset:8
  v_cmp_eq_u32 vcc, 3, v19
  v_mfma_f32_16x16x32_bf16 v[124:127], v[52:55], a[124:127], v[124:127]
  ds_read_b64_tr_b16 a[158:159], v89 offset:16
  v_cndmask_b32 v20, 0, v18, vcc
  v_mfma_f32_16x16x32_bf16 v[128:131], v[52:55], v[24:27], v[128:131]
  ds_read_b64_tr_b16 a[164:165], v89 offset:24
  v_accvgpr_write_b32 a243, v20
  v_mfma_f32_16x16x32_bf16 v[120:123], v[52:55], a[120:123], v[120:123]
  ds_read_b64_tr_b16 a[170:171], v89 offset:32
  v_lshlrev_b32 v241, 12, v3
  v_mfma_f32_16x16x32_bf16 v[156:159], v[64:67], a[120:123], v[156:159]
  ds_read_b64_tr_b16 a[148:149], v90 offset:0
  v_lshl_add_u32 v241, v2, 4, v241
  v_mfma_f32_16x16x32_bf16 v[164:167], v[64:67], v[24:27], v[164:167]
  s_lshl_b32 s48, s3, 8
  ds_read_b64_tr_b16 a[154:155], v90 offset:8
  s_add_u32 s53, s53, s48
  v_mfma_f32_16x16x32_bf16 v[160:163], v[64:67], a[124:127], v[160:163]
  s_waitcnt lgkmcnt(12)
  ds_read_b64_tr_b16 a[160:161], v90 offset:16
  v_and_b32 v18, 1, v3
  v_mfma_f32_16x16x32_bf16 v[136:139], v[56:59], a[124:127], v[136:139]
  ds_read_b64_tr_b16 a[166:167], v90 offset:24
  v_lshlrev_b32 v18, 3, v18
  v_mfma_f32_16x16x32_bf16 v[140:143], v[56:59], v[24:27], v[140:143]
  buffer_load_dwordx4 v6, s[16:19], s20 offen offset:0  lds
  v_mfma_f32_16x16x32_bf16 v[132:135], v[56:59], a[120:123], v[132:135]
  ds_read_b64_tr_b16 a[172:173], v90 offset:32
  v_lshl_add_u32 v18, v2, 4, v18
  v_mfma_f32_16x16x32_bf16 v[144:147], v[60:63], a[120:123], v[144:147]
  s_add_u32 s48, s48, 158592
  v_add_u32 v242, s48, v18
  v_mul_u32_u24 v19, 760, v3
  v_mfma_f32_16x16x32_bf16 v[152:155], v[60:63], v[24:27], v[152:155]
  v_add_u32 v19, 158592, v19
  v_and_b32 v20, 7, v2
  v_mfma_f32_16x16x32_bf16 v[148:151], v[60:63], a[124:127], v[148:151]
  v_lshl_add_u32 v20, v20, 3, v19
  v_and_b32 v21, 3, v2
  s_waitcnt vmcnt(6)
  s_barrier
  ds_read_b128 a[128:131], v9 offset:0
  ds_read_b128 a[132:135], v9 offset:2048
  ds_read_b64_tr_b16 v[28:29], v13 offset:30720
  ds_read_b64_tr_b16 v[30:31], v13 offset:33280
  ds_read_b64_tr_b16 v[32:33], v13 offset:30752
  ds_read_b64_tr_b16 v[34:35], v13 offset:33312
  ds_read_b64_tr_b16 v[44:45], v14 offset:30720
  ds_read_b64_tr_b16 v[46:47], v14 offset:33280
  ds_read_b64_tr_b16 v[36:37], v13 offset:30800
  ds_read_b64_tr_b16 v[38:39], v13 offset:33360
  ds_read_b64_tr_b16 v[40:41], v13 offset:30840
  ds_read_b64_tr_b16 v[42:43], v13 offset:33400
  s_waitcnt lgkmcnt(10)
  v_mfma_f32_16x16x32_bf16 v[180:183], a[132:135], a[132:135], v[180:183]
  buffer_load_dwordx4 v7, s[16:19], s20 offen offset:1024  lds
  v_mfma_f32_16x16x32_bf16 v[172:175], v[24:27], a[132:135], v[172:175]
  ds_read_b128 a[136:139], v10 offset:0
  v_lshl_add_u32 v21, v21, 3, v19
  v_mfma_f32_16x16x32_bf16 v[168:171], v[24:27], a[128:131], v[168:171]
  ds_read_b128 a[140:143], v10 offset:2048
  v_lshrrev_b32 v19, 3, v2
  v_mfma_f32_16x16x32_bf16 v[176:179], a[128:131], a[128:131], v[176:179]
  s_waitcnt lgkmcnt(6)
  ds_read_b64_tr_b16 v[48:49], v13 offset:35840
  v_lshrrev_b32 v18, 1, v3
  v_mfma_f32_16x16x32_bf16 v[108:111], v[28:31], a[128:131], v[108:111]
  ds_read_b64_tr_b16 v[50:51], v13 offset:38400
  v_cmp_eq_u32 vcc, v19, v18
  v_mfma_f32_16x16x32_bf16 v[116:119], v[28:31], v[24:27], v[116:119]
  ds_read_b64_tr_b16 v[52:53], v13 offset:35872
  v_mov_b32 v19, 157696
  v_mfma_f32_16x16x32_bf16 v[112:115], v[28:31], a[132:135], v[112:115]
  ds_read_b64_tr_b16 v[54:55], v13 offset:38432
  v_mov_b32 v217, 0
  v_mfma_f32_16x16x32_bf16 v[124:127], v[32:35], a[132:135], v[124:127]
  ds_read_b64_tr_b16 v[64:65], v14 offset:35840
  v_cndmask_b32 v243, v19, v20, vcc
  v_mfma_f32_16x16x32_bf16 v[128:131], v[32:35], v[24:27], v[128:131]
  ds_read_b64_tr_b16 v[66:67], v14 offset:38400
  v_cndmask_b32 v252, v19, v21, vcc
  v_mfma_f32_16x16x32_bf16 v[120:123], v[32:35], a[128:131], v[120:123]
  ds_read_b64_tr_b16 v[56:57], v13 offset:35920
  v_mov_b32 v227, 0
  v_mfma_f32_16x16x32_bf16 v[156:159], v[44:47], a[128:131], v[156:159]
  ds_read_b64_tr_b16 v[58:59], v13 offset:38480
  v_mfma_f32_16x16x32_bf16 v[164:167], v[44:47], v[24:27], v[164:167]
  ds_read_b64_tr_b16 v[60:61], v13 offset:35960
  v_mfma_f32_16x16x32_bf16 v[160:163], v[44:47], a[132:135], v[160:163]
  s_waitcnt lgkmcnt(11)
  ds_read_b64_tr_b16 v[62:63], v13 offset:38520
  v_mfma_f32_16x16x32_bf16 v[136:139], v[36:39], a[132:135], v[136:139]
  s_mov_b32 exec_hi, 0
  buffer_load_dwordx4 v8, s[16:19], s20 offen offset:2048  lds
  s_mov_b64 exec, -1
  v_mfma_f32_16x16x32_bf16 v[140:143], v[36:39], v[24:27], v[140:143]
  v_mfma_f32_16x16x32_bf16 v[132:135], v[36:39], a[128:131], v[132:135]
  v_mfma_f32_16x16x32_bf16 v[144:147], v[40:43], a[128:131], v[144:147]
  v_mfma_f32_16x16x32_bf16 v[152:155], v[40:43], v[24:27], v[152:155]
  v_mfma_f32_16x16x32_bf16 v[148:151], v[40:43], a[132:135], v[148:151]
  s_waitcnt lgkmcnt(10)
  v_mfma_f32_16x16x32_bf16 v[176:179], a[136:139], a[136:139], v[176:179]
  s_add_u32 m0, s42, 6656
  s_nop 0
  buffer_load_dwordx4 v6, s[16:19], s21 offen offset:0  lds
  v_mfma_f32_16x16x32_bf16 v[180:183], a[140:143], a[140:143], v[180:183]
  v_mfma_f32_16x16x32_bf16 v[172:175], v[24:27], a[140:143], v[172:175]
  v_mfma_f32_16x16x32_bf16 v[168:171], v[24:27], a[136:139], v[168:171]
  s_waitcnt lgkmcnt(4)
L_hop2:
  s_cbranch_execz L_hop6
  v_mfma_f32_16x16x32_bf16 v[108:111], v[48:51], a[136:139], v[108:111]
  v_mfma_f32_16x16x32_bf16 v[116:119], v[48:51], v[24:27], v[116:119]
  v_cndmask_b32 v176, v176, v177, s[56:57]
  v_cndmask_b32 v176, v176, v178, s[58:59]
  v_mfma_f32_16x16x32_bf16 v[112:115], v[48:51], a[140:143], v[112:115]
  v_cndmask_b32 v176, v176, v179, s[60:61]
  ds_bpermute_b32 v176, v236, v176
  v_mfma_f32_16x16x32_bf16 v[124:127], v[52:55], a[140:143], v[124:127]
  v_cndmask_b32 v180, v180, v181, s[56:57]
  v_cndmask_b32 v180, v180, v182, s[58:59]
  v_mfma_f32_16x16x32_bf16 v[128:131], v[52:55], v[24:27], v[128:131]
  v_cndmask_b32 v180, v180, v183, s[60:61]
  ds_bpermute_b32 v180, v236, v180
  v_mfma_f32_16x16x32_bf16 v[120:123], v[52:55], a[136:139], v[120:123]
  v_mul_f32 v168, 0x3ae38e39, v168
  v_mul_f32 v172, 0x3ae38e39, v172
  v_mfma_f32_16x16x32_bf16 v[156:159], v[64:67], a[136:139], v[156:159]
  v_mov_b32 v18, 0x3727c5ac
  v_mov_b32 v19, 0x3727c5ac
  v_mfma_f32_16x16x32_bf16 v[164:167], v[64:67], v[24:27], v[164:167]
  v_fma_f32 v18, -v168, v168, v18
  v_fma_f32 v19, -v172, v172, v19
  v_mfma_f32_16x16x32_bf16 v[160:163], v[64:67], a[140:143], v[160:163]
  s_waitcnt lgkmcnt(2)
  s_waitcnt lgkmcnt(0)
  v_fmac_f32 v18, 0x3ae38e39, v176
  v_mfma_f32_16x16x32_bf16 v[136:139], v[56:59], a[140:143], v[136:139]
  v_fmac_f32 v19, 0x3ae38e39, v180
  v_max_f32 v18, 0x3727c5ac, v18
  v_mfma_f32_16x16x32_bf16 v[140:143], v[56:59], v[24:27], v[140:143]
  v_max_f32 v19, 0x3727c5ac, v19
  v_mfma_f32_16x16x32_bf16 v[132:135], v[56:59], a[136:139], v[132:135]
  v_rsq_f32 v184, v18
  v_mfma_f32_16x16x32_bf16 v[144:147], v[60:63], a[136:139], v[144:147]
  v_rsq_f32 v185, v19
  v_mfma_f32_16x16x32_bf16 v[152:155], v[60:63], v[24:27], v[152:155]
  v_mul_f32 v186, -v168, v184
  v_mul_f32 v187, -v172, v185
  v_mfma_f32_16x16x32_bf16 v[148:151], v[60:63], a[140:143], v[148:151]
  buffer_load_dwordx4 v7, s[16:19], s21 offen offset:1024  lds
  v_pk_mul_f32 v[108:109], v[108:109], v[184:185] op_sel:[0,0] op_sel_hi:[1,0]
  v_pk_mul_f32 v[110:111], v[110:111], v[184:185] op_sel:[0,0] op_sel_hi:[1,0]
  v_pk_fma_f32 v[108:109], v[116:117], v[186:187], v[108:109] op_sel:[0,0,0] op_sel_hi:[1,0,1]
  v_pk_fma_f32 v[110:111], v[118:119], v[186:187], v[110:111] op_sel:[0,0,0] op_sel_hi:[1,0,1]
  v_cvt_pk_bf16_f32 v188, v108, v109
  v_cvt_pk_bf16_f32 v189, v110, v111
  v_pk_mul_f32 v[120:121], v[120:121], v[184:185] op_sel:[0,0] op_sel_hi:[1,0]
  v_pk_mul_f32 v[122:123], v[122:123], v[184:185] op_sel:[0,0] op_sel_hi:[1,0]
  v_pk_fma_f32 v[120:121], v[128:129], v[186:187], v[120:121] op_sel:[0,0,0] op_sel_hi:[1,0,1]
  v_pk_fma_f32 v[122:123], v[130:131], v[186:187], v[122:123] op_sel:[0,0,0] op_sel_hi:[1,0,1]
  v_cvt_pk_bf16_f32 v190, v120, v121
  v_cvt_pk_bf16_f32 v191, v122, v123
  v_pk_mul_f32 v[156:157], v[156:157], v[184:185] op_sel:[0,0] op_sel_hi:[1,0]
  v_pk_mul_f32 v[158:159], v[158:159], v[184:185] op_sel:[0,0] op_sel_hi:[1,0]
  v_pk_fma_f32 v[156:157], v[164:165], v[186:187], v[156:157] op_sel:[0,0,0] op_sel_hi:[1,0,1]
  v_pk_fma_f32 v[158:159], v[166:167], v[186:187], v[158:159] op_sel:[0,0,0] op_sel_hi:[1,0,1]
  v_cvt_pk_bf16_f32 v192, v156, v157
  v_cvt_pk_bf16_f32 v193, v158, v159
  v_pk_mul_f32 v[112:113], v[112:113], v[184:185] op_sel:[0,1] op_sel_hi:[1,1]
  v_pk_mul_f32 v[114:115], v[114:115], v[184:185] op_sel:[0,1] op_sel_hi:[1,1]
  v_pk_fma_f32 v[112:113], v[116:117], v[186:187], v[112:113] op_sel:[0,1,0] op_sel_hi:[1,1,1]
  v_pk_fma_f32 v[114:115], v[118:119], v[186:187], v[114:115] op_sel:[0,1,0] op_sel_hi:[1,1,1]
  v_cvt_pk_bf16_f32 v198, v112, v113
  v_cvt_pk_bf16_f32 v199, v114, v115
  v_pk_mul_f32 v[124:125], v[124:125], v[184:185] op_sel:[0,1] op_sel_hi:[1,1]
  v_pk_mul_f32 v[126:127], v[126:127], v[184:185] op_sel:[0,1] op_sel_hi:[1,1]
  v_pk_fma_f32 v[124:125], v[128:129], v[186:187], v[124:125] op_sel:[0,1,0] op_sel_hi:[1,1,1]
  v_pk_fma_f32 v[126:127], v[130:131], v[186:187], v[126:127] op_sel:[0,1,0] op_sel_hi:[1,1,1]
  v_cvt_pk_bf16_f32 v200, v124, v125
  v_cvt_pk_bf16_f32 v201, v126, v127
  v_pk_mul_f32 v[160:161], v[160:161], v[184:185] op_sel:[0,1] op_sel_hi:[1,1]
  v_pk_mul_f32 v[162:163], v[162:163], v[184:185] op_sel:[0,1] op_sel_hi:[1,1]
  v_pk_fma_f32 v[160:161], v[164:165], v[186:187], v[160:161] op_sel:[0,1,0] op_sel_hi:[1,1,1]
  v_pk_fma_f32 v[162:163], v[166:167], v[186:187], v[162:163] op_sel:[0,1,0] op_sel_hi:[1,1,1]
  v_cvt_pk_bf16_f32 v202, v160, v161
  v_cvt_pk_bf16_f32 v203, v162, v163
  v_mfma_f32_16x16x16_bf16 v[28:31], a[148:149], v[192:193], 0
  v_mul_f32 v132, v132, v184
  v_fmac_f32 v132, v140, v186
  v_mfma_f32_16x16x16_bf16 v[32:35], a[154:155], v[192:193], 0
  v_mul_f32 v133, v133, v184
  v_fmac_f32 v133, v141, v186
  v_mfma_f32_16x16x16_bf16 v[36:39], a[160:161], v[192:193], 0
  s_mov_b32 exec_hi, 0
  buffer_load_dwordx4 v8, s[16:19], s21 offen offset:2048  lds
  s_mov_b64 exec, -1
  v_mfma_f32_16x16x16_bf16 v[40:43], a[166:167], v[192:193], 0
  s_add_u32 m0, s42, 9216
  v_mul_f32 v134, v134, v184
  v_fmac_f32 v134, v142, v186
  v_mfma_f32_16x16x16_bf16 v[44:47], a[172:173], v[192:193], 0
  v_mul_f32 v135, v135, v184
  v_fmac_f32 v135, v143, v186
  v_mfma_f32_16x16x16_bf16 v[48:51], a[148:149], v[202:203], 0
  v_cvt_pk_bf16_f32 v194, v132, v133
  v_cvt_pk_bf16_f32 v195, v134, v135
  v_mfma_f32_16x16x16_bf16 v[52:55], a[154:155], v[202:203], 0
  v_mul_f32 v144, v144, v184
  v_fmac_f32 v144, v152, v186
  v_mfma_f32_16x16x16_bf16 v[56:59], a[160:161], v[202:203], 0
  v_mul_f32 v145, v145, v184
  v_fmac_f32 v145, v153, v186
  v_mfma_f32_16x16x16_bf16 v[60:63], a[166:167], v[202:203], 0
  v_mul_f32 v146, v146, v184
  v_fmac_f32 v146, v154, v186
  v_mfma_f32_16x16x16_bf16 v[64:67], a[172:173], v[202:203], 0
  v_mul_f32 v147, v147, v184
  v_fmac_f32 v147, v155, v186
  v_mfma_f32_16x16x32_bf16 v[28:31], a[144:147], v[188:191], v[28:31]
  v_cvt_pk_bf16_f32 v196, v144, v145
  v_cvt_pk_bf16_f32 v197, v146, v147
  v_mfma_f32_16x16x32_bf16 v[32:35], a[150:153], v[188:191], v[32:35]
  v_mul_f32 v136, v136, v185
  v_fmac_f32 v136, v140, v187
  v_mfma_f32_16x16x32_bf16 v[36:39], a[156:159], v[188:191], v[36:39]
  v_mul_f32 v137, v137, v185
  v_fmac_f32 v137, v141, v187
  v_mfma_f32_16x16x32_bf16 v[40:43], a[162:165], v[188:191], v[40:43]
  v_mul_f32 v138, v138, v185
  v_fmac_f32 v138, v142, v187
  v_mfma_f32_16x16x32_bf16 v[44:47], a[168:171], v[188:191], v[44:47]
  v_mul_f32 v139, v139, v185
  v_fmac_f32 v139, v143, v187
  v_mfma_f32_16x16x32_bf16 v[48:51], a[144:147], v[198:201], v[48:51]
  v_cvt_pk_bf16_f32 v204, v136, v137
  v_cvt_pk_bf16_f32 v205, v138, v139
  v_mfma_f32_16x16x32_bf16 v[52:55], a[150:153], v[198:201], v[52:55]
  v_mul_f32 v148, v148, v185
  v_fmac_f32 v148, v152, v187
  v_mfma_f32_16x16x32_bf16 v[56:59], a[156:159], v[198:201], v[56:59]
  v_mul_f32 v149, v149, v185
  v_fmac_f32 v149, v153, v187
  v_mfma_f32_16x16x32_bf16 v[60:63], a[162:165], v[198:201], v[60:63]
  v_mul_f32 v150, v150, v185
  v_fmac_f32 v150, v154, v187
  v_mfma_f32_16x16x32_bf16 v[64:67], a[168:171], v[198:201], v[64:67]
  v_mul_f32 v151, v151, v185
  v_fmac_f32 v151, v155, v187
  v_cvt_pk_bf16_f32 v206, v148, v149
  v_cvt_pk_bf16_f32 v207, v150, v151
  buffer_load_dwordx4 v6, s[16:19], s22 offen offset:0  lds
  buffer_load_dwordx4 v7, s[16:19], s22 offen offset:1024  lds
  v_max3_f32 v18, v28, v29, v30
  ds_write_b64 v228, v[194:195] offset:20480
  v_max3_f32 v19, v31, v32, v33
  v_max3_f32 v18, v18, v34, v35
  v_max3_f32 v19, v19, v36, v37
  v_max3_f32 v18, v18, v38, v39
  v_max3_f32 v19, v19, v40, v41
  v_max3_f32 v18, v18, v42, v43
  ds_write_b64 v228, v[196:197] offset:20512
  v_max3_f32 v19, v19, v44, v45
  v_max_f32 v18, v18, v19
  v_mov_b32 v19, 0x3fb8aa3b
  v_mul_f32 v18, 0xbfb8aa3b, v18
  v_pk_fma_f32 v[28:29], v[28:29], v[18:19], v[18:19] op_sel:[0,1,0] op_sel_hi:[1,1,0]
  v_pk_fma_f32 v[30:31], v[30:31], v[18:19], v[18:19] op_sel:[0,1,0] op_sel_hi:[1,1,0]
  v_pk_fma_f32 v[32:33], v[32:33], v[18:19], v[18:19] op_sel:[0,1,0] op_sel_hi:[1,1,0]
  v_cndmask_b32 v176, v238, v192, s[62:63]
  v_pk_fma_f32 v[34:35], v[34:35], v[18:19], v[18:19] op_sel:[0,1,0] op_sel_hi:[1,1,0]
  v_pk_fma_f32 v[36:37], v[36:37], v[18:19], v[18:19] op_sel:[0,1,0] op_sel_hi:[1,1,0]
  v_pk_fma_f32 v[38:39], v[38:39], v[18:19], v[18:19] op_sel:[0,1,0] op_sel_hi:[1,1,0]
  v_pk_fma_f32 v[40:41], v[40:41], v[18:19], v[18:19] op_sel:[0,1,0] op_sel_hi:[1,1,0]
  v_pk_fma_f32 v[42:43], v[42:43], v[18:19], v[18:19] op_sel:[0,1,0] op_sel_hi:[1,1,0]
  v_pk_fma_f32 v[44:45], v[44:45], v[18:19], v[18:19] op_sel:[0,1,0] op_sel_hi:[1,1,0]
  v_cndmask_b32 v177, 0, v193, s[62:63]
  v_exp_f32 v28, v28
  v_exp_f32 v29, v29
  v_exp_f32 v30, v30
  v_exp_f32 v31, v31
  v_exp_f32 v32, v32
  v_exp_f32 v33, v33
  v_exp_f32 v34, v34
  ds_write_b64 v229, v[176:177] offset:20544
  v_exp_f32 v35, v35
  v_exp_f32 v36, v36
  v_exp_f32 v37, v37
  s_mov_b32 exec_hi, 0
  buffer_load_dwordx4 v8, s[16:19], s22 offen offset:2048  lds
  s_mov_b64 exec, -1
  v_exp_f32 v38, v38
  v_exp_f32 v39, v39
  v_exp_f32 v40, v40
  v_exp_f32 v41, v41
  ds_write_b64 v228, v[204:205] offset:22016
  v_exp_f32 v42, v42
  v_exp_f32 v43, v43
  v_exp_f32 v44, v44
  v_exp_f32 v45, v45
  v_pk_add_f32 v[18:19], v[28:29], v[30:31]
  v_pk_add_f32 v[20:21], v[32:33], v[34:35]
  ds_write_b64 v228, v[206:207] offset:22048
  s_add_u32 m0, s42, 11776
  s_nop 0
  buffer_load_dwordx4 v6, s[16:19], s23 offen offset:0  lds
  v_pk_add_f32 v[18:19], v[18:19], v[36:37]
  v_pk_add_f32 v[20:21], v[20:21], v[38:39]
  v_pk_add_f32 v[18:19], v[18:19], v[40:41]
  v_pk_add_f32 v[20:21], v[20:21], v[42:43]
  v_pk_add_f32 v[18:19], v[18:19], v[44:45]
  v_pk_add_f32 v[18:19], v[18:19], v[20:21]
  v_add_f32 v18, v18, v19
  v_cndmask_b32 v178, v238, v202, s[62:63]
  v_rcp_f32 v18, v18
  s_nop 0
  v_pk_mul_f32 v[28:29], v[28:29], v[18:19] op_sel_hi:[1,0]
  v_cvt_pk_bf16_f32 v208, v28, v29
  v_pk_mul_f32 v[30:31], v[30:31], v[18:19] op_sel_hi:[1,0]
  v_cvt_pk_bf16_f32 v209, v30, v31
  v_pk_mul_f32 v[32:33], v[32:33], v[18:19] op_sel_hi:[1,0]
  v_cndmask_b32 v179, 0, v203, s[62:63]
  v_cvt_pk_bf16_f32 v210, v32, v33
  v_pk_mul_f32 v[34:35], v[34:35], v[18:19] op_sel_hi:[1,0]
  v_cvt_pk_bf16_f32 v211, v34, v35
  v_pk_mul_f32 v[36:37], v[36:37], v[18:19] op_sel_hi:[1,0]
  v_cvt_pk_bf16_f32 v212, v36, v37
  v_pk_mul_f32 v[38:39], v[38:39], v[18:19] op_sel_hi:[1,0]
  v_cvt_pk_bf16_f32 v213, v38, v39
  ds_write_b64 v229, v[178:179] offset:22080
  v_pk_mul_f32 v[40:41], v[40:41], v[18:19] op_sel_hi:[1,0]
  v_cvt_pk_bf16_f32 v214, v40, v41
  v_pk_mul_f32 v[42:43], v[42:43], v[18:19] op_sel_hi:[1,0]
  v_cvt_pk_bf16_f32 v215, v42, v43
  v_pk_mul_f32 v[44:45], v[44:45], v[18:19] op_sel_hi:[1,0]
  v_cvt_pk_bf16_f32 v216, v44, v45
  v_max3_f32 v248, v48, v49, v50
  ds_write_b64 v68, v[208:209] offset:0
  v_max3_f32 v249, v51, v52, v53
  v_max3_f32 v248, v248, v54, v55
  v_max3_f32 v249, v249, v56, v57
  v_max3_f32 v248, v248, v58, v59
  v_max3_f32 v249, v249, v60, v61
  v_max3_f32 v248, v248, v62, v63
  v_max3_f32 v249, v249, v64, v65
  v_max_f32 v248, v248, v249
  v_mov_b32 v249, 0x3fb8aa3b
  ds_write_b64 v69, v[210:211] offset:0
  v_mul_f32 v248, 0xbfb8aa3b, v248
  buffer_load_dwordx4 v7, s[16:19], s23 offen offset:1024  lds
  v_pk_fma_f32 v[48:49], v[48:49], v[248:249], v[248:249] op_sel:[0,1,0] op_sel_hi:[1,1,0]
  v_pk_fma_f32 v[50:51], v[50:51], v[248:249], v[248:249] op_sel:[0,1,0] op_sel_hi:[1,1,0]
  v_pk_fma_f32 v[52:53], v[52:53], v[248:249], v[248:249] op_sel:[0,1,0] op_sel_hi:[1,1,0]
  v_pk_fma_f32 v[54:55], v[54:55], v[248:249], v[248:249] op_sel:[0,1,0] op_sel_hi:[1,1,0]
  v_pk_fma_f32 v[56:57], v[56:57], v[248:249], v[248:249] op_sel:[0,1,0] op_sel_hi:[1,1,0]
  v_pk_fma_f32 v[58:59], v[58:59], v[248:249], v[248:249] op_sel:[0,1,0] op_sel_hi:[1,1,0]
  v_pk_fma_f32 v[60:61], v[60:61], v[248:249], v[248:249] op_sel:[0,1,0] op_sel_hi:[1,1,0]
  v_pk_fma_f32 v[62:63], v[62:63], v[248:249], v[248:249] op_sel:[0,1,0] op_sel_hi:[1,1,0]
  v_pk_fma_f32 v[64:65], v[64:65], v[248:249], v[248:249] op_sel:[0,1,0] op_sel_hi:[1,1,0]
  ds_write_b64 v70, v[212:213] offset:0
  s_waitcnt vmcnt(11)
  v_exp_f32 v48, v48
  v_exp_f32 v49, v49
  v_exp_f32 v50, v50
  v_exp_f32 v51, v51
  v_exp_f32 v52, v52
  v_exp_f32 v53, v53
  v_exp_f32 v54, v54
  v_exp_f32 v55, v55
  v_exp_f32 v56, v56
  ds_write_b64 v71, v[214:215] offset:0
  buffer_store_dwordx4 v[100:103], v93, s[28:31], s79 offen offset:0 sc1
  v_exp_f32 v57, v57
  v_exp_f32 v58, v58
  v_exp_f32 v59, v59
  v_exp_f32 v60, v60
  v_exp_f32 v61, v61
  v_exp_f32 v62, v62
  v_exp_f32 v63, v63
  s_mov_b32 exec_hi, 0
  buffer_load_dwordx4 v8, s[16:19], s23 offen offset:2048  lds
  s_mov_b64 exec, -1
  v_exp_f32 v64, v64
  v_exp_f32 v65, v65
  v_pk_add_f32 v[248:249], v[48:49], v[50:51]
  ds_write_b64 v72, v[216:217] offset:0
  buffer_store_dwordx4 v[104:107], v93, s[28:31], s79 offen offset:256 sc1
  v_pk_add_f32 v[250:251], v[52:53], v[54:55]
  v_pk_add_f32 v[248:249], v[248:249], v[56:57]
  v_pk_add_f32 v[250:251], v[250:251], v[58:59]
  v_pk_add_f32 v[248:249], v[248:249], v[60:61]
  v_pk_add_f32 v[250:251], v[250:251], v[62:63]
  v_pk_add_f32 v[248:249], v[248:249], v[64:65]
  v_pk_add_f32 v[248:249], v[248:249], v[250:251]
  v_add_f32 v248, v248, v249
  v_rcp_f32 v248, v248
  s_nop 0
  v_pk_mul_f32 v[48:49], v[48:49], v[248:249] op_sel_hi:[1,0]
  v_cvt_pk_bf16_f32 v218, v48, v49
  v_pk_mul_f32 v[50:51], v[50:51], v[248:249] op_sel_hi:[1,0]
  s_add_u32 m0, s42, 0
  s_nop 0
  buffer_load_dwordx4 v6, s[16:19], s78 offen offset:0  lds
  v_cvt_pk_bf16_f32 v219, v50, v51
  ds_write_b64 v68, v[218:219] offset:2560
  v_pk_mul_f32 v[52:53], v[52:53], v[248:249] op_sel_hi:[1,0]
  v_cvt_pk_bf16_f32 v220, v52, v53
  v_pk_mul_f32 v[54:55], v[54:55], v[248:249] op_sel_hi:[1,0]
  v_cvt_pk_bf16_f32 v221, v54, v55
  ds_write_b64 v69, v[220:221] offset:2560
  v_pk_mul_f32 v[56:57], v[56:57], v[248:249] op_sel_hi:[1,0]
  v_cvt_pk_bf16_f32 v222, v56, v57
  v_pk_mul_f32 v[58:59], v[58:59], v[248:249] op_sel_hi:[1,0]
  v_cvt_pk_bf16_f32 v223, v58, v59
  ds_write_b64 v70, v[222:223] offset:2560
  v_pk_mul_f32 v[60:61], v[60:61], v[248:249] op_sel_hi:[1,0]
  v_cvt_pk_bf16_f32 v224, v60, v61
  v_pk_mul_f32 v[62:63], v[62:63], v[248:249] op_sel_hi:[1,0]
  v_cvt_pk_bf16_f32 v225, v62, v63
  ds_write_b64 v71, v[224:225] offset:2560
  v_pk_mul_f32 v[64:65], v[64:65], v[248:249] op_sel_hi:[1,0]
  v_cvt_pk_bf16_f32 v226, v64, v65
  ds_write_b64 v72, v[226:227] offset:2560
  s_waitcnt vmcnt(9)
  s_waitcnt lgkmcnt(0)
  s_barrier
  ds_read_b64_tr_b16 v[28:29], v231 offset:20480
  ds_read_b64_tr_b16 v[30:31], v231 offset:22016
  ds_read_b64_tr_b16 v[32:33], v232 offset:0
  ds_read_b64_tr_b16 v[34:35], v232 offset:2560
  ds_read_b64_tr_b16 v[36:37], v232 offset:32
  ds_read_b64_tr_b16 v[38:39], v232 offset:2592
  ds_read_b64_tr_b16 v[40:41], v232 offset:64
  ds_read_b64_tr_b16 v[42:43], v232 offset:2624
  ds_read_b64_tr_b16 v[44:45], v231 offset:23552
  ds_read_b64_tr_b16 v[46:47], v231 offset:25088
  ds_read_b64_tr_b16 v[48:49], v232 offset:5120
  ds_read_b64_tr_b16 v[50:51], v232 offset:7680
  ds_read_b64_tr_b16 v[52:53], v232 offset:5152
  ds_read_b64_tr_b16 v[54:55], v232 offset:7712
  ds_read_b64_tr_b16 v[56:57], v232 offset:5184
  ds_read_b64_tr_b16 v[58:59], v232 offset:7744
  s_waitcnt lgkmcnt(8)
  v_mfma_f32_16x16x32_bf16 v[108:111], v[32:35], v[28:31], 0
  v_mfma_f32_16x16x32_bf16 v[112:115], v[36:39], v[28:31], 0
  v_mfma_f32_16x16x32_bf16 v[116:119], v[40:43], v[28:31], 0
  ds_read_b64_tr_b16 v[60:61], v231 offset:26624
  ds_read_b64_tr_b16 v[62:63], v231 offset:28160
  ds_read_b64_tr_b16 v[64:65], v232 offset:10240
  ds_read_b64_tr_b16 v[66:67], v232 offset:12800
  ds_read_b64_tr_b16 v[68:69], v232 offset:10272
  ds_read_b64_tr_b16 v[70:71], v232 offset:12832
  ds_read_b64_tr_b16 v[72:73], v232 offset:10304
  ds_read_b64_tr_b16 v[74:75], v232 offset:12864
  s_waitcnt lgkmcnt(8)
  v_mfma_f32_16x16x32_bf16 v[108:111], v[48:51], v[44:47], v[108:111]
  v_mfma_f32_16x16x32_bf16 v[112:115], v[52:55], v[44:47], v[112:115]
  v_mfma_f32_16x16x32_bf16 v[116:119], v[56:59], v[44:47], v[116:119]
  ds_read_b64_tr_b16 v[76:77], v231 offset:29696
  ds_read_b64_tr_b16 v[78:79], v231 offset:31232
  ds_read_b64_tr_b16 v[80:81], v232 offset:15360
  ds_read_b64_tr_b16 v[82:83], v232 offset:17920
  ds_read_b64_tr_b16 v[84:85], v232 offset:15392
  ds_read_b64_tr_b16 v[86:87], v232 offset:17952
  ds_read_b64_tr_b16 v[88:89], v232 offset:15424
  ds_read_b64_tr_b16 v[90:91], v232 offset:17984
  s_waitcnt lgkmcnt(8)
  v_mfma_f32_16x16x32_bf16 v[108:111], v[64:67], v[60:63], v[108:111]
  v_mfma_f32_16x16x32_bf16 v[112:115], v[68:71], v[60:63], v[112:115]
  v_mfma_f32_16x16x32_bf16 v[116:119], v[72:75], v[60:63], v[116:119]
  s_waitcnt lgkmcnt(0)
  v_mfma_f32_16x16x32_bf16 v[108:111], v[80:83], v[76:79], v[108:111]
  v_mfma_f32_16x16x32_bf16 v[112:115], v[84:87], v[76:79], v[112:115]
  v_mfma_f32_16x16x32_bf16 v[116:119], v[88:91], v[76:79], v[116:119]
  ds_read_b64_tr_b16 v[28:29], v239 offset:4096
  ds_read_b64_tr_b16 v[30:31], v239 offset:4176
  ds_read_b64_tr_b16 v[40:41], v239 offset:20480
  ds_read_b64_tr_b16 v[42:43], v239 offset:20560
  ds_read_b64_tr_b16 v[32:33], v239 offset:4128
  ds_read_b64_tr_b16 v[34:35], v239 offset:4208
  ds_read_b64_tr_b16 v[44:45], v239 offset:20512
  ds_read_b64_tr_b16 v[46:47], v239 offset:20592
  v_cvt_pk_bf16_f32 v108, v108, v109
  v_cvt_pk_bf16_f32 v109, v110, v111
  ds_write_b64 v233, v[108:109] offset:0
  v_cvt_pk_bf16_f32 v112, v112, v113
  v_cvt_pk_bf16_f32 v113, v114, v115
  ds_write_b64 v234, v[112:113] offset:608
  v_cvt_pk_bf16_f32 v116, v116, v117
  v_cvt_pk_bf16_f32 v117, v118, v119
  ds_write_b64 v235, v[116:117] offset:1216
  ds_read_b64_tr_b16 v[36:37], v240 offset:4096
  ds_read_b64_tr_b16 v[38:39], v240 offset:4176
  ds_read_b64_tr_b16 v[48:49], v240 offset:20480
  ds_read_b64_tr_b16 v[50:51], v240 offset:20560
  s_waitcnt lgkmcnt(4)
  s_barrier
  ds_read_b128 v[108:111], v230
  v_mfma_f32_16x16x32_bf16 v[120:123], v[28:31], a[0:3], 0
  ds_read_b64_tr_b16 v[52:53], v239 offset:36864
  v_mfma_f32_16x16x32_bf16 v[120:123], v[40:43], a[8:11], v[120:123]
  s_waitcnt lgkmcnt(1)
  s_mov_b32 exec_hi, 0xffff
  buffer_store_dwordx4 v[108:111], v253, s[28:31], s55 offen sc1
  s_mov_b64 exec, -1
  v_mfma_f32_16x16x32_bf16 v[128:131], v[40:43], v[24:27], 0
  ds_read_b64_tr_b16 v[54:55], v239 offset:36944
  v_mfma_f32_16x16x32_bf16 v[128:131], v[28:31], v[24:27], v[128:131]
  ds_read_b64_tr_b16 v[64:65], v239 offset:53248
  v_mfma_f32_16x16x32_bf16 v[124:127], v[28:31], a[4:7], 0
  ds_read_b64_tr_b16 v[66:67], v239 offset:53328
  v_mfma_f32_16x16x32_bf16 v[124:127], v[40:43], a[12:15], v[124:127]
  ds_read_b64_tr_b16 v[56:57], v239 offset:36896
  buffer_load_dwordx4 v7, s[16:19], s78 offen offset:1024  lds
  v_mfma_f32_16x16x32_bf16 v[136:139], v[44:47], a[12:15], 0
  ds_read_b64_tr_b16 v[58:59], v239 offset:36976
  v_mfma_f32_16x16x32_bf16 v[136:139], v[32:35], a[4:7], v[136:139]
  ds_read_b64_tr_b16 v[68:69], v239 offset:53280
  v_mfma_f32_16x16x32_bf16 v[140:143], v[32:35], v[24:27], 0
  ds_read_b64_tr_b16 v[70:71], v239 offset:53360
  v_mfma_f32_16x16x32_bf16 v[140:143], v[44:47], v[24:27], v[140:143]
  ds_read_b64_tr_b16 v[60:61], v240 offset:36864
  v_mfma_f32_16x16x32_bf16 v[132:135], v[44:47], a[8:11], 0
  ds_read_b64_tr_b16 v[62:63], v240 offset:36944
  v_mfma_f32_16x16x32_bf16 v[132:135], v[32:35], a[0:3], v[132:135]
  ds_read_b64_tr_b16 v[72:73], v240 offset:53248
  v_mfma_f32_16x16x32_bf16 v[144:147], v[36:39], a[0:3], 0
  ds_read_b64_tr_b16 v[74:75], v240 offset:53328
  v_mfma_f32_16x16x32_bf16 v[144:147], v[48:51], a[8:11], v[144:147]
  v_mfma_f32_16x16x32_bf16 v[152:155], v[48:51], v[24:27], 0
  v_mfma_f32_16x16x32_bf16 v[152:155], v[36:39], v[24:27], v[152:155]
  v_mfma_f32_16x16x32_bf16 v[148:151], v[36:39], a[4:7], 0
  v_mfma_f32_16x16x32_bf16 v[148:151], v[48:51], a[12:15], v[148:151]
  s_waitcnt lgkmcnt(8)
  v_mfma_f32_16x16x32_bf16 v[120:123], v[52:55], a[16:19], v[120:123]
  s_mov_b32 exec_hi, 0
  buffer_load_dwordx4 v8, s[16:19], s78 offen offset:2048  lds
  s_mov_b64 exec, -1
  v_mfma_f32_16x16x32_bf16 v[120:123], v[64:67], a[24:27], v[120:123]
  ds_read_b64_tr_b16 v[28:29], v239 offset:6656
  v_mfma_f32_16x16x32_bf16 v[128:131], v[64:67], v[24:27], v[128:131]
  ds_read_b64_tr_b16 v[30:31], v239 offset:6736
  v_mfma_f32_16x16x32_bf16 v[128:131], v[52:55], v[24:27], v[128:131]
  ds_read_b64_tr_b16 v[40:41], v239 offset:23040
  v_mfma_f32_16x16x32_bf16 v[124:127], v[52:55], a[20:23], v[124:127]
  ds_read_b64_tr_b16 v[42:43], v239 offset:23120
  v_mfma_f32_16x16x32_bf16 v[124:127], v[64:67], a[28:31], v[124:127]
  s_waitcnt lgkmcnt(4)
  ds_read_b64_tr_b16 v[32:33], v239 offset:6688
  v_mfma_f32_16x16x32_bf16 v[136:139], v[68:71], a[28:31], v[136:139]
  ds_read_b64_tr_b16 v[34:35], v239 offset:6768
  buffer_load_dword v99, off, s[32:35], 0 offset:128 sc1
  v_mfma_f32_16x16x32_bf16 v[136:139], v[56:59], a[20:23], v[136:139]
  s_lshr_b32 s67, s2, 5
  ds_read_b64_tr_b16 v[44:45], v239 offset:23072
  s_and_b32 s68, s2, 7
  v_mfma_f32_16x16x32_bf16 v[140:143], v[56:59], v[24:27], v[140:143]
  s_lshl_b32 s68, s68, 4
  ds_read_b64_tr_b16 v[46:47], v239 offset:23152
  s_bfe_u32 s69, s2, 0x20003
  v_mfma_f32_16x16x32_bf16 v[140:143], v[68:71], v[24:27], v[140:143]
  s_lshl_b32 s69, s69, 2
  ds_read_b64_tr_b16 v[36:37], v240 offset:6656
  s_add_u32 s68, s68, s69
  v_mfma_f32_16x16x32_bf16 v[132:135], v[68:71], a[24:27], v[132:135]
  s_add_u32 s72, s68, s3
  ds_read_b64_tr_b16 v[38:39], v240 offset:6736
  v_bfe_u32 v94, v1, 1, 2
  v_mfma_f32_16x16x32_bf16 v[132:135], v[56:59], a[16:19], v[132:135]
  ds_read_b64_tr_b16 v[48:49], v240 offset:23040
  v_xor_b32 v94, v94, v3
  v_mfma_f32_16x16x32_bf16 v[144:147], v[60:63], a[16:19], v[144:147]
  ds_read_b64_tr_b16 v[50:51], v240 offset:23120
  v_and_b32 v95, 1, v1
  v_mfma_f32_16x16x32_bf16 v[144:147], v[72:75], a[24:27], v[144:147]
  v_lshlrev_b32 v95, 4, v95
  v_lshl_add_u32 v94, v94, 5, v95
  v_mfma_f32_16x16x32_bf16 v[152:155], v[72:75], v[24:27], v[152:155]
  v_lshrrev_b32 v95, 3, v1
  v_mul_u32_u24 v96, 1152, v95
  v_mfma_f32_16x16x32_bf16 v[152:155], v[60:63], v[24:27], v[152:155]
  v_add_u32 v6, v96, v94
  s_and_b32 s68, s3, 1
  v_mfma_f32_16x16x32_bf16 v[148:151], v[60:63], a[20:23], v[148:151]
  s_lshr_b32 s69, s3, 1
  s_mul_i32 s70, s68, 18
  s_lshl_b32 s71, s69, 3
  v_mfma_f32_16x16x32_bf16 v[148:151], v[72:75], a[28:31], v[148:151]
  s_add_u32 s70, s70, s71
  s_mul_i32 s73, s70, 1152
  s_mul_i32 s68, s68, 144
  s_mul_i32 s69, s69, 36
  s_add_u32 s68, s68, s69
  s_add_u32 s68, s68, 16
  s_mul_i32 s74, s68, 1152
  s_lshl_b32 s68, s67, 7
  s_add_u32 s70, s73, s68
  s_add_u32 s71, s74, s68
  s_mul_i32 s75, s3, 18432
  s_add_u32 m0, s75, 0
  s_add_u32 s68, s70, 0
  buffer_load_dwordx4 v6, s[24:27], s68 offen offset:0 lds
  s_add_u32 s68, s70, 40448
  buffer_load_dwordx4 v6, s[24:27], s68 offen offset:1024 lds
  s_waitcnt lgkmcnt(8)
  v_mfma_f32_16x16x32_bf16 v[120:123], v[28:31], a[32:35], v[120:123]
  s_add_u32 s68, s70, 80896
  ds_read_b64_tr_b16 v[52:53], v239 offset:39424
  buffer_load_dwordx4 v6, s[24:27], s68 offen offset:2048 lds
  v_mfma_f32_16x16x32_bf16 v[120:123], v[40:43], a[40:43], v[120:123]
  s_add_u32 s68, s70, 121344
  ds_read_b64_tr_b16 v[54:55], v239 offset:39504
  v_mfma_f32_16x16x32_bf16 v[128:131], v[40:43], v[24:27], v[128:131]
  ds_read_b64_tr_b16 v[64:65], v239 offset:55808
  v_mfma_f32_16x16x32_bf16 v[128:131], v[28:31], v[24:27], v[128:131]
  ds_read_b64_tr_b16 v[66:67], v239 offset:55888
  v_mfma_f32_16x16x32_bf16 v[124:127], v[28:31], a[36:39], v[124:127]
  ds_read_b64_tr_b16 v[56:57], v239 offset:39456
  buffer_load_dwordx4 v6, s[24:27], s68 offen offset:3072 lds
  v_mfma_f32_16x16x32_bf16 v[124:127], v[40:43], a[44:47], v[124:127]
  s_waitcnt lgkmcnt(5)
  ds_read_b64_tr_b16 v[58:59], v239 offset:39536
  s_add_u32 m0, s75, 4096
  v_mfma_f32_16x16x32_bf16 v[136:139], v[44:47], a[44:47], v[136:139]
  s_add_u32 s68, s70, 165888
  ds_read_b64_tr_b16 v[68:69], v239 offset:55840
  v_mfma_f32_16x16x32_bf16 v[136:139], v[32:35], a[36:39], v[136:139]
  ds_read_b64_tr_b16 v[70:71], v239 offset:55920
  v_mfma_f32_16x16x32_bf16 v[140:143], v[32:35], v[24:27], v[140:143]
  ds_read_b64_tr_b16 v[60:61], v240 offset:39424
  buffer_load_dwordx4 v6, s[24:27], s68 offen offset:0 lds
  v_mfma_f32_16x16x32_bf16 v[140:143], v[44:47], v[24:27], v[140:143]
  s_add_u32 s68, s70, 206336
  ds_read_b64_tr_b16 v[62:63], v240 offset:39504
  v_mfma_f32_16x16x32_bf16 v[132:135], v[44:47], a[40:43], v[132:135]
  ds_read_b64_tr_b16 v[72:73], v240 offset:55808
  v_mfma_f32_16x16x32_bf16 v[132:135], v[32:35], a[32:35], v[132:135]
  ds_read_b64_tr_b16 v[74:75], v240 offset:55888
  v_mfma_f32_16x16x32_bf16 v[144:147], v[36:39], a[32:35], v[144:147]
  buffer_load_dwordx4 v6, s[24:27], s68 offen offset:1024 lds
  s_add_u32 s68, s70, 246784
  v_mfma_f32_16x16x32_bf16 v[144:147], v[48:51], a[40:43], v[144:147]
  v_mfma_f32_16x16x32_bf16 v[152:155], v[48:51], v[24:27], v[152:155]
  v_mfma_f32_16x16x32_bf16 v[152:155], v[36:39], v[24:27], v[152:155]
  v_mfma_f32_16x16x32_bf16 v[148:151], v[36:39], a[36:39], v[148:151]
  buffer_load_dwordx4 v6, s[24:27], s68 offen offset:2048 lds
  v_mfma_f32_16x16x32_bf16 v[148:151], v[48:51], a[44:47], v[148:151]
  s_waitcnt lgkmcnt(8)
  v_readfirstlane_b32 s50, v16
  s_nop 2
  s_cmp_ge_u32 s50, 10
  s_cbranch_scc0 Lp1_slow
Lp1_ok:
  s_waitcnt vmcnt(10)
  s_barrier
  buffer_atomic_add v17, v15, s[28:31], s52 offen sc1
  v_mfma_f32_16x16x32_bf16 v[120:123], v[52:55], a[48:51], v[120:123]
  s_add_u32 s68, s70, 287232
  ds_read_b64_tr_b16 v[28:29], v239 offset:9216
  v_mfma_f32_16x16x32_bf16 v[120:123], v[64:67], a[56:59], v[120:123]
  ds_read_b64_tr_b16 v[30:31], v239 offset:9296
  v_mfma_f32_16x16x32_bf16 v[128:131], v[64:67], v[24:27], v[128:131]
  ds_read_b64_tr_b16 v[40:41], v239 offset:25600
  buffer_load_dwordx4 v6, s[24:27], s68 offen offset:3072 lds
  v_mfma_f32_16x16x32_bf16 v[128:131], v[52:55], v[24:27], v[128:131]
  s_add_u32 m0, s75, 8192
  ds_read_b64_tr_b16 v[42:43], v239 offset:25680
  s_add_u32 s68, s70, 331776
  v_mfma_f32_16x16x32_bf16 v[124:127], v[52:55], a[52:55], v[124:127]
  ds_read_b64_tr_b16 v[32:33], v239 offset:9248
  v_mfma_f32_16x16x32_bf16 v[124:127], v[64:67], a[60:63], v[124:127]
  s_waitcnt lgkmcnt(5)
  ds_read_b64_tr_b16 v[34:35], v239 offset:9328
  v_mfma_f32_16x16x32_bf16 v[136:139], v[68:71], a[60:63], v[136:139]
  ds_read_b64_tr_b16 v[44:45], v239 offset:25632
  buffer_load_dwordx4 v6, s[24:27], s68 offen offset:0 lds
  v_mfma_f32_16x16x32_bf16 v[136:139], v[56:59], a[52:55], v[136:139]
  s_add_u32 s68, s70, 372224
  ds_read_b64_tr_b16 v[46:47], v239 offset:25712
  v_mfma_f32_16x16x32_bf16 v[140:143], v[56:59], v[24:27], v[140:143]
  ds_read_b64_tr_b16 v[36:37], v240 offset:9216
  v_mfma_f32_16x16x32_bf16 v[140:143], v[68:71], v[24:27], v[140:143]
  ds_read_b64_tr_b16 v[38:39], v240 offset:9296
  v_mfma_f32_16x16x32_bf16 v[132:135], v[68:71], a[56:59], v[132:135]
  ds_read_b64_tr_b16 v[48:49], v240 offset:25600
  buffer_load_dwordx4 v6, s[24:27], s68 offen offset:1024 lds
  v_mfma_f32_16x16x32_bf16 v[132:135], v[56:59], a[48:51], v[132:135]
  s_add_u32 s68, s70, 412672
  ds_read_b64_tr_b16 v[50:51], v240 offset:25680
  v_mfma_f32_16x16x32_bf16 v[144:147], v[60:63], a[48:51], v[144:147]
  v_mfma_f32_16x16x32_bf16 v[144:147], v[72:75], a[56:59], v[144:147]
  v_mfma_f32_16x16x32_bf16 v[152:155], v[72:75], v[24:27], v[152:155]
  buffer_load_dwordx4 v6, s[24:27], s68 offen offset:2048 lds
L_hop3:
  s_cbranch_execz L_hop7
  v_mfma_f32_16x16x32_bf16 v[152:155], v[60:63], v[24:27], v[152:155]
  v_mfma_f32_16x16x32_bf16 v[148:151], v[60:63], a[52:55], v[148:151]
  v_mfma_f32_16x16x32_bf16 v[148:151], v[72:75], a[60:63], v[148:151]
  s_waitcnt lgkmcnt(8)
  v_mfma_f32_16x16x32_bf16 v[120:123], v[28:31], a[64:67], v[120:123]
  s_add_u32 s68, s70, 453120
  ds_read_b64_tr_b16 v[52:53], v239 offset:41984
  buffer_load_dwordx4 v6, s[24:27], s68 offen offset:3072 lds
  v_mfma_f32_16x16x32_bf16 v[120:123], v[40:43], a[72:75], v[120:123]
  s_add_u32 m0, s75, 12288
  ds_read_b64_tr_b16 v[54:55], v239 offset:42064
  s_add_u32 s68, s70, 497664
  v_mfma_f32_16x16x32_bf16 v[128:131], v[40:43], v[24:27], v[128:131]
  ds_read_b64_tr_b16 v[64:65], v239 offset:58368
  v_mfma_f32_16x16x32_bf16 v[128:131], v[28:31], v[24:27], v[128:131]
  ds_read_b64_tr_b16 v[66:67], v239 offset:58448
  v_mfma_f32_16x16x32_bf16 v[124:127], v[28:31], a[68:71], v[124:127]
  ds_read_b64_tr_b16 v[56:57], v239 offset:42016
  buffer_load_dwordx4 v6, s[24:27], s68 offen offset:0 lds
  v_mfma_f32_16x16x32_bf16 v[124:127], v[40:43], a[76:79], v[124:127]
  s_waitcnt lgkmcnt(5)
  ds_read_b64_tr_b16 v[58:59], v239 offset:42096
  s_add_u32 s68, s70, 538112
  v_mfma_f32_16x16x32_bf16 v[136:139], v[44:47], a[76:79], v[136:139]
  ds_read_b64_tr_b16 v[68:69], v239 offset:58400
  v_mfma_f32_16x16x32_bf16 v[136:139], v[32:35], a[68:71], v[136:139]
  ds_read_b64_tr_b16 v[70:71], v239 offset:58480
  v_mfma_f32_16x16x32_bf16 v[140:143], v[32:35], v[24:27], v[140:143]
  ds_read_b64_tr_b16 v[60:61], v240 offset:41984
  buffer_load_dwordx4 v6, s[24:27], s68 offen offset:1024 lds
  v_mfma_f32_16x16x32_bf16 v[140:143], v[44:47], v[24:27], v[140:143]
  s_add_u32 s68, s70, 578560
  ds_read_b64_tr_b16 v[62:63], v240 offset:42064
  v_mfma_f32_16x16x32_bf16 v[132:135], v[44:47], a[72:75], v[132:135]
  ds_read_b64_tr_b16 v[72:73], v240 offset:58368
  v_mfma_f32_16x16x32_bf16 v[132:135], v[32:35], a[64:67], v[132:135]
  ds_read_b64_tr_b16 v[74:75], v240 offset:58448
  v_mfma_f32_16x16x32_bf16 v[144:147], v[36:39], a[64:67], v[144:147]
  buffer_load_dwordx4 v6, s[24:27], s68 offen offset:2048 lds
  s_add_u32 s68, s70, 619008
  v_mfma_f32_16x16x32_bf16 v[144:147], v[48:51], a[72:75], v[144:147]
  v_mfma_f32_16x16x32_bf16 v[152:155], v[48:51], v[24:27], v[152:155]
  v_mfma_f32_16x16x32_bf16 v[152:155], v[36:39], v[24:27], v[152:155]
  v_mfma_f32_16x16x32_bf16 v[148:151], v[36:39], a[68:71], v[148:151]
  buffer_load_dwordx4 v6, s[24:27], s68 offen offset:3072 lds
  v_mfma_f32_16x16x32_bf16 v[148:151], v[48:51], a[76:79], v[148:151]
  s_waitcnt lgkmcnt(8)
  v_mfma_f32_16x16x32_bf16 v[120:123], v[52:55], a[80:83], v[120:123]
  s_add_u32 m0, s75, 16384
  ds_read_b64_tr_b16 v[28:29], v239 offset:11776
  v_lshrrev_b32 v7, 2, v95
  v_mfma_f32_16x16x32_bf16 v[120:123], v[64:67], a[88:91], v[120:123]
  ds_read_b64_tr_b16 v[30:31], v239 offset:11856
  v_mul_u32_u24 v7, 72, v7
  v_mfma_f32_16x16x32_bf16 v[128:131], v[64:67], v[24:27], v[128:131]
  ds_read_b64_tr_b16 v[40:41], v239 offset:28160
  v_bfe_u32 v97, v95, 1, 1
  v_mfma_f32_16x16x32_bf16 v[128:131], v[52:55], v[24:27], v[128:131]
  ds_read_b64_tr_b16 v[42:43], v239 offset:28240
  v_mul_u32_u24 v97, 18, v97
  v_mfma_f32_16x16x32_bf16 v[124:127], v[52:55], a[84:87], v[124:127]
  ds_read_b64_tr_b16 v[32:33], v239 offset:11808
  v_add_u32 v7, v7, v97
  v_mfma_f32_16x16x32_bf16 v[124:127], v[64:67], a[92:95], v[124:127]
  s_waitcnt lgkmcnt(5)
  ds_read_b64_tr_b16 v[34:35], v239 offset:11888
  v_and_b32 v97, 1, v95
  v_mfma_f32_16x16x32_bf16 v[136:139], v[68:71], a[92:95], v[136:139]
  ds_read_b64_tr_b16 v[44:45], v239 offset:28192
  v_add_u32 v7, v7, v97
  v_mfma_f32_16x16x32_bf16 v[136:139], v[56:59], a[84:87], v[136:139]
  ds_read_b64_tr_b16 v[46:47], v239 offset:28272
  v_mul_u32_u24 v7, 1152, v7
  v_mfma_f32_16x16x32_bf16 v[140:143], v[56:59], v[24:27], v[140:143]
  ds_read_b64_tr_b16 v[36:37], v240 offset:11776
  v_add_u32 v7, v7, v94
  v_mfma_f32_16x16x32_bf16 v[140:143], v[68:71], v[24:27], v[140:143]
  s_add_u32 s68, s71, 0
  ds_read_b64_tr_b16 v[38:39], v240 offset:11856
  buffer_load_dwordx4 v7, s[24:27], s68 offen offset:0 lds
  v_mfma_f32_16x16x32_bf16 v[132:135], v[68:71], a[88:91], v[132:135]
  s_add_u32 s68, s71, 330752
  ds_read_b64_tr_b16 v[48:49], v240 offset:28160
  buffer_load_dwordx4 v7, s[24:27], s68 offen offset:1024 lds
  v_mfma_f32_16x16x32_bf16 v[132:135], v[56:59], a[80:83], v[132:135]
  ds_read_b64_tr_b16 v[50:51], v240 offset:28240
  v_and_b32 v94, 7, v1
  v_mfma_f32_16x16x32_bf16 v[144:147], v[60:63], a[80:83], v[144:147]
  s_lshl_b32 s68, s67, 4
  s_add_u32 s68, s68, 1024
  v_lshl_add_u32 v6, v94, 4, v96
  v_mfma_f32_16x16x32_bf16 v[144:147], v[72:75], a[88:91], v[144:147]
  v_mul_u32_u24 v7, 1152, v2
  v_lshl_add_u32 v7, v3, 28, v7
  v_mfma_f32_16x16x32_bf16 v[152:155], v[72:75], v[24:27], v[152:155]
  s_mul_i32 s69, s72, 18432
  s_add_u32 s71, s69, s68
  s_lshl_b32 s68, s67, 7
  v_mfma_f32_16x16x32_bf16 v[152:155], v[60:63], v[24:27], v[152:155]
  s_add_u32 s69, s69, s68
  s_add_u32 m0, s42, 14336
  s_add_u32 s70, s69, 8192
  v_mfma_f32_16x16x32_bf16 v[148:151], v[60:63], a[84:87], v[148:151]
  buffer_load_dwordx4 v6, s[12:15], s69 offen lds
  buffer_load_dwordx4 v6, s[12:15], s70 offen offset:1024 lds
  v_mfma_f32_16x16x32_bf16 v[148:151], v[72:75], a[92:95], v[148:151]
  s_waitcnt lgkmcnt(8)
  v_mov_b32 v248, 0
  buffer_atomic_add v248, v15, s[28:31], s52 offen offset:0 sc0 sc1
  v_mfma_f32_16x16x32_bf16 v[120:123], v[28:31], a[96:99], v[120:123]
  s_add_u32 m0, s42, 2560
  ds_read_b64_tr_b16 v[52:53], v239 offset:44544
  buffer_load_dwordx4 v7, s[12:15], s71 offen lds
  v_mfma_f32_16x16x32_bf16 v[120:123], v[40:43], a[104:107], v[120:123]
  s_waitcnt vmcnt(23)
  v_readfirstlane_b32 s70, v99
  ds_read_b64_tr_b16 v[54:55], v239 offset:44624
  v_mfma_f32_16x16x32_bf16 v[128:131], v[40:43], v[24:27], v[128:131]
  s_mul_i32 s68, s3, 5120
  ds_read_b64_tr_b16 v[64:65], v239 offset:60928
  s_min_u32 s68, s68, 13312
  v_mfma_f32_16x16x32_bf16 v[128:131], v[28:31], v[24:27], v[128:131]
  s_mul_i32 s69, s67, 18432
  ds_read_b64_tr_b16 v[66:67], v239 offset:61008
  v_mfma_f32_16x16x32_bf16 v[124:127], v[28:31], a[100:103], v[124:127]
  s_cmp_ge_u32 s70, 72
  s_cbranch_scc0 Lp2_slow
Lp2_ok:
  ds_read_b64_tr_b16 v[56:57], v239 offset:44576
  v_mfma_f32_16x16x32_bf16 v[124:127], v[40:43], a[108:111], v[124:127]
  s_waitcnt lgkmcnt(5)
  ds_read_b64_tr_b16 v[58:59], v239 offset:44656
  s_add_u32 m0, s68, 73728
  v_mfma_f32_16x16x32_bf16 v[136:139], v[44:47], a[108:111], v[136:139]
  s_add_u32 s69, s69, s68
  ds_read_b64_tr_b16 v[68:69], v239 offset:60960
  s_add_u32 s69, s69, 61865984
  v_mfma_f32_16x16x32_bf16 v[136:139], v[32:35], a[100:103], v[136:139]
  ds_read_b64_tr_b16 v[70:71], v239 offset:61040
  buffer_load_dwordx4 v253, s[28:31], s69 offen offset:0 sc1 lds
  v_mfma_f32_16x16x32_bf16 v[140:143], v[32:35], v[24:27], v[140:143]
  ds_read_b64_tr_b16 v[60:61], v240 offset:44544
  buffer_load_dwordx4 v253, s[28:31], s69 offen offset:1024 sc1 lds
  v_mfma_f32_16x16x32_bf16 v[140:143], v[44:47], v[24:27], v[140:143]
  ds_read_b64_tr_b16 v[62:63], v240 offset:44624
  v_mfma_f32_16x16x32_bf16 v[132:135], v[44:47], a[104:107], v[132:135]
  ds_read_b64_tr_b16 v[72:73], v240 offset:60928
  v_mfma_f32_16x16x32_bf16 v[132:135], v[32:35], a[96:99], v[132:135]
  ds_read_b64_tr_b16 v[74:75], v240 offset:61008
  v_mfma_f32_16x16x32_bf16 v[144:147], v[36:39], a[96:99], v[144:147]
  buffer_load_dwordx4 v253, s[28:31], s69 offen offset:2048 sc1 lds
  v_mfma_f32_16x16x32_bf16 v[144:147], v[48:51], a[104:107], v[144:147]
  v_mfma_f32_16x16x32_bf16 v[152:155], v[48:51], v[24:27], v[152:155]
  v_mfma_f32_16x16x32_bf16 v[152:155], v[36:39], v[24:27], v[152:155]
  v_mfma_f32_16x16x32_bf16 v[148:151], v[36:39], a[100:103], v[148:151]
  buffer_load_dwordx4 v253, s[28:31], s69 offen offset:3072 sc1 lds
  v_mfma_f32_16x16x32_bf16 v[148:151], v[48:51], a[108:111], v[148:151]
  s_waitcnt lgkmcnt(8)
  s_barrier
  v_mfma_f32_16x16x32_bf16 v[120:123], v[52:55], a[112:115], v[120:123]
  s_add_u32 m0, s68, 77824
  ds_read_b64_tr_b16 v[28:29], v239 offset:0
  s_add_u32 s69, s69, 4096
  v_mfma_f32_16x16x32_bf16 v[120:123], v[64:67], a[120:123], v[120:123]
  ds_read_b64_tr_b16 v[30:31], v239 offset:80
  v_mfma_f32_16x16x32_bf16 v[128:131], v[64:67], v[24:27], v[128:131]
  ds_read_b64_tr_b16 v[40:41], v239 offset:16384
  buffer_load_dwordx4 v253, s[28:31], s69 offen offset:0 sc1 lds
  v_mfma_f32_16x16x32_bf16 v[128:131], v[52:55], v[24:27], v[128:131]
  ds_read_b64_tr_b16 v[42:43], v239 offset:16464
  v_cndmask_b32 v168, v168, v172, s[62:63]
  v_mfma_f32_16x16x32_bf16 v[124:127], v[52:55], a[116:119], v[124:127]
  ds_read_b64_tr_b16 v[32:33], v239 offset:32
  v_mfma_f32_16x16x32_bf16 v[124:127], v[64:67], a[124:127], v[124:127]
  s_waitcnt lgkmcnt(5)
  ds_read_b64_tr_b16 v[34:35], v239 offset:112
  v_mfma_f32_16x16x32_bf16 v[136:139], v[68:71], a[124:127], v[136:139]
  ds_read_b64_tr_b16 v[44:45], v239 offset:16416
  buffer_store_dword v168, v237, s[28:31], s64 offen sc1
  v_mfma_f32_16x16x32_bf16 v[136:139], v[56:59], a[116:119], v[136:139]
  ds_read_b64_tr_b16 v[46:47], v239 offset:16496
  v_mfma_f32_16x16x32_bf16 v[140:143], v[56:59], v[24:27], v[140:143]
  ds_read_b64_tr_b16 v[36:37], v240 offset:0
  v_mfma_f32_16x16x32_bf16 v[140:143], v[68:71], v[24:27], v[140:143]
  ds_read_b64_tr_b16 v[38:39], v240 offset:80
  v_mfma_f32_16x16x32_bf16 v[132:135], v[68:71], a[120:123], v[132:135]
  ds_read_b64_tr_b16 v[48:49], v240 offset:16384
  v_mfma_f32_16x16x32_bf16 v[132:135], v[56:59], a[112:115], v[132:135]
  ds_read_b64_tr_b16 v[50:51], v240 offset:16464
  v_mfma_f32_16x16x32_bf16 v[144:147], v[60:63], a[112:115], v[144:147]
  v_mfma_f32_16x16x32_bf16 v[144:147], v[72:75], a[120:123], v[144:147]
  v_mfma_f32_16x16x32_bf16 v[152:155], v[72:75], v[24:27], v[152:155]
  v_mfma_f32_16x16x32_bf16 v[152:155], v[60:63], v[24:27], v[152:155]
  v_mfma_f32_16x16x32_bf16 v[148:151], v[60:63], a[116:119], v[148:151]
  v_mfma_f32_16x16x32_bf16 v[148:151], v[72:75], a[124:127], v[148:151]
  s_waitcnt lgkmcnt(8)
  s_cmp_eq_u32 s3, 0
  s_cselect_b32 s45, 16, 0
  s_mov_b32 s47, 0
  s_waitcnt vmcnt(7)
  v_readfirstlane_b32 s46, v248
  v_mov_b32 v248, 0
  s_nop 1
  s_cmp_ge_u32 s46, s45
  s_cbranch_scc1 Lw3_ok
Lw3:
  buffer_atomic_add v248, v15, s[28:31], s52 offen offset:0 sc0 sc1
  s_add_u32 s47, s47, 1
  s_cmp_gt_u32 s47, 100000
  s_waitcnt vmcnt(0)
  v_readfirstlane_b32 s46, v248
  v_mov_b32 v248, 0
  s_cbranch_scc1 Lw3_ok
  s_nop 0
  s_cmp_ge_u32 s46, s45
  s_cbranch_scc0 Lw3
Lw3_ok:
  s_barrier
  v_mfma_f32_16x16x32_bf16 v[120:123], v[28:31], a[128:131], v[120:123]
  buffer_load_dwordx4 a[176:179], v241, s[28:31], s53 offen offset:0 sc1
  v_mfma_f32_16x16x32_bf16 v[120:123], v[40:43], a[136:139], v[120:123]
  v_mfma_f32_16x16x32_bf16 v[128:131], v[40:43], v[24:27], v[128:131]
  v_mfma_f32_16x16x32_bf16 v[128:131], v[28:31], v[24:27], v[128:131]
  v_mfma_f32_16x16x32_bf16 v[124:127], v[28:31], a[132:135], v[124:127]
  buffer_load_dwordx4 a[192:195], v241, s[28:31], s53 offen offset:1024 sc1
  v_mfma_f32_16x16x32_bf16 v[124:127], v[40:43], a[140:143], v[124:127]
  s_waitcnt lgkmcnt(0)
  v_mfma_f32_16x16x32_bf16 v[136:139], v[44:47], a[140:143], v[136:139]
  v_mfma_f32_16x16x32_bf16 v[136:139], v[32:35], a[132:135], v[136:139]
  v_mfma_f32_16x16x32_bf16 v[140:143], v[32:35], v[24:27], v[140:143]
  buffer_load_dwordx4 a[208:211], v241, s[28:31], s53 offen offset:2048 sc1
  s_add_u32 s53, s53, 16384
  v_mfma_f32_16x16x32_bf16 v[140:143], v[44:47], v[24:27], v[140:143]
  v_mfma_f32_16x16x32_bf16 v[132:135], v[44:47], a[136:139], v[132:135]
  v_mfma_f32_16x16x32_bf16 v[132:135], v[32:35], a[128:131], v[132:135]
  v_mfma_f32_16x16x32_bf16 v[144:147], v[36:39], a[128:131], v[144:147]
  buffer_load_dwordx4 a[180:183], v241, s[28:31], s53 offen offset:0 sc1
  v_mfma_f32_16x16x32_bf16 v[144:147], v[48:51], a[136:139], v[144:147]
  v_mfma_f32_16x16x32_bf16 v[152:155], v[48:51], v[24:27], v[152:155]
  v_mfma_f32_16x16x32_bf16 v[152:155], v[36:39], v[24:27], v[152:155]
  v_mfma_f32_16x16x32_bf16 v[148:151], v[36:39], a[132:135], v[148:151]
  buffer_load_dwordx4 a[196:199], v241, s[28:31], s53 offen offset:1024 sc1
  v_mfma_f32_16x16x32_bf16 v[148:151], v[48:51], a[140:143], v[148:151]
  s_nop 2
  v_pk_mul_f32 v[144:145], v[144:145], v[184:185] op_sel:[0,0] op_sel_hi:[1,0]
  v_pk_mul_f32 v[146:147], v[146:147], v[184:185] op_sel:[0,0] op_sel_hi:[1,0]
  v_pk_fma_f32 v[144:145], v[152:153], v[186:187], v[144:145] op_sel:[0,0,0] op_sel_hi:[1,0,1]
  v_pk_fma_f32 v[146:147], v[154:155], v[186:187], v[146:147] op_sel:[0,0,0] op_sel_hi:[1,0,1]
  v_cvt_pk_bf16_f32 v192, v144, v145
  v_cvt_pk_bf16_f32 v193, v146, v147
  buffer_load_dwordx4 a[212:215], v241, s[28:31], s53 offen offset:2048 sc1
  v_pk_mul_f32 v[120:121], v[120:121], v[184:185] op_sel:[0,0] op_sel_hi:[1,0]
  v_pk_mul_f32 v[122:123], v[122:123], v[184:185] op_sel:[0,0] op_sel_hi:[1,0]
  v_pk_fma_f32 v[120:121], v[128:129], v[186:187], v[120:121] op_sel:[0,0,0] op_sel_hi:[1,0,1]
  v_pk_fma_f32 v[122:123], v[130:131], v[186:187], v[122:123] op_sel:[0,0,0] op_sel_hi:[1,0,1]
  v_cvt_pk_bf16_f32 v188, v120, v121
  v_cvt_pk_bf16_f32 v189, v122, v123
  v_pk_mul_f32 v[132:133], v[132:133], v[184:185] op_sel:[0,0] op_sel_hi:[1,0]
  v_pk_mul_f32 v[134:135], v[134:135], v[184:185] op_sel:[0,0] op_sel_hi:[1,0]
  v_pk_fma_f32 v[132:133], v[140:141], v[186:187], v[132:133] op_sel:[0,0,0] op_sel_hi:[1,0,1]
  v_pk_fma_f32 v[134:135], v[142:143], v[186:187], v[134:135] op_sel:[0,0,0] op_sel_hi:[1,0,1]
  v_cvt_pk_bf16_f32 v190, v132, v133
  v_cvt_pk_bf16_f32 v191, v134, v135
  v_pk_mul_f32 v[148:149], v[148:149], v[184:185] op_sel:[0,1] op_sel_hi:[1,1]
  s_add_u32 s53, s53, 16384
  buffer_load_dwordx4 a[184:187], v241, s[28:31], s53 offen offset:0 sc1
  v_pk_mul_f32 v[150:151], v[150:151], v[184:185] op_sel:[0,1] op_sel_hi:[1,1]
  v_pk_fma_f32 v[148:149], v[152:153], v[186:187], v[148:149] op_sel:[0,1,0] op_sel_hi:[1,1,1]
  v_pk_fma_f32 v[150:151], v[154:155], v[186:187], v[150:151] op_sel:[0,1,0] op_sel_hi:[1,1,1]
  v_cvt_pk_bf16_f32 v202, v148, v149
  v_cvt_pk_bf16_f32 v203, v150, v151
  v_mfma_f32_16x16x16_bf16 v[28:31], a[148:149], v[192:193], 0
  v_mul_f32 v124, v124, v185
  v_fmac_f32 v124, v128, v187
  v_mfma_f32_16x16x16_bf16 v[32:35], a[154:155], v[192:193], 0
  v_mul_f32 v125, v125, v185
  v_fmac_f32 v125, v129, v187
  v_mfma_f32_16x16x16_bf16 v[36:39], a[160:161], v[192:193], 0
  buffer_load_dwordx4 a[200:203], v241, s[28:31], s53 offen offset:1024 sc1
  v_mul_f32 v126, v126, v185
  v_mfma_f32_16x16x16_bf16 v[40:43], a[166:167], v[192:193], 0
  v_fmac_f32 v126, v130, v187
  v_mul_f32 v127, v127, v185
  v_mfma_f32_16x16x16_bf16 v[44:47], a[172:173], v[192:193], 0
  v_fmac_f32 v127, v131, v187
  v_cvt_pk_bf16_f32 v198, v124, v125
  v_mfma_f32_16x16x16_bf16 v[48:51], a[148:149], v[202:203], 0
  v_cvt_pk_bf16_f32 v199, v126, v127
  v_mul_f32 v136, v136, v185
  v_mfma_f32_16x16x16_bf16 v[52:55], a[154:155], v[202:203], 0
  buffer_load_dwordx4 a[216:219], v241, s[28:31], s53 offen offset:2048 sc1
  s_add_u32 s53, s53, 16384
  v_mfma_f32_16x16x16_bf16 v[56:59], a[160:161], v[202:203], 0
  v_fmac_f32 v136, v140, v187
  v_mul_f32 v137, v137, v185
  v_mfma_f32_16x16x16_bf16 v[60:63], a[166:167], v[202:203], 0
  v_fmac_f32 v137, v141, v187
  v_mul_f32 v138, v138, v185
  v_mfma_f32_16x16x16_bf16 v[64:67], a[172:173], v[202:203], 0
  v_fmac_f32 v138, v142, v187
  v_mul_f32 v139, v139, v185
  v_mfma_f32_16x16x32_bf16 v[28:31], a[144:147], v[188:191], v[28:31]
  buffer_load_dwordx4 a[188:191], v241, s[28:31], s53 offen offset:0 sc1
  v_fmac_f32 v139, v143, v187
  v_mfma_f32_16x16x32_bf16 v[32:35], a[150:153], v[188:191], v[32:35]
  v_cvt_pk_bf16_f32 v200, v136, v137
  v_cvt_pk_bf16_f32 v201, v138, v139
  v_mfma_f32_16x16x32_bf16 v[36:39], a[156:159], v[188:191], v[36:39]
  v_mfma_f32_16x16x32_bf16 v[40:43], a[162:165], v[188:191], v[40:43]
  v_mfma_f32_16x16x32_bf16 v[44:47], a[168:171], v[188:191], v[44:47]
  v_mfma_f32_16x16x32_bf16 v[48:51], a[144:147], v[198:201], v[48:51]
  v_max3_f32 v18, v28, v29, v30
  s_nop 0
  v_max3_f32 v19, v31, v32, v33
  v_mfma_f32_16x16x32_bf16 v[52:55], a[150:153], v[198:201], v[52:55]
  v_max3_f32 v18, v18, v34, v35
  v_max3_f32 v19, v19, v36, v37
  v_mfma_f32_16x16x32_bf16 v[56:59], a[156:159], v[198:201], v[56:59]
  v_max3_f32 v18, v18, v38, v39
  v_max3_f32 v19, v19, v40, v41
  v_mfma_f32_16x16x32_bf16 v[60:63], a[162:165], v[198:201], v[60:63]
  v_max3_f32 v18, v18, v42, v43
  v_max3_f32 v19, v19, v44, v45
  v_mfma_f32_16x16x32_bf16 v[64:67], a[168:171], v[198:201], v[64:67]
  buffer_load_dwordx4 a[204:207], v241, s[28:31], s53 offen offset:1024 sc1
  v_max_f32 v18, v18, v19
  v_mov_b32 v19, 0x3fb8aa3b
  v_mul_f32 v18, 0xbfb8aa3b, v18
  v_pk_fma_f32 v[28:29], v[28:29], v[18:19], v[18:19] op_sel:[0,1,0] op_sel_hi:[1,1,0]
  v_pk_fma_f32 v[30:31], v[30:31], v[18:19], v[18:19] op_sel:[0,1,0] op_sel_hi:[1,1,0]
  v_pk_fma_f32 v[32:33], v[32:33], v[18:19], v[18:19] op_sel:[0,1,0] op_sel_hi:[1,1,0]
  v_pk_fma_f32 v[34:35], v[34:35], v[18:19], v[18:19] op_sel:[0,1,0] op_sel_hi:[1,1,0]
  v_pk_fma_f32 v[36:37], v[36:37], v[18:19], v[18:19] op_sel:[0,1,0] op_sel_hi:[1,1,0]
  v_pk_fma_f32 v[38:39], v[38:39], v[18:19], v[18:19] op_sel:[0,1,0] op_sel_hi:[1,1,0]
  v_pk_fma_f32 v[40:41], v[40:41], v[18:19], v[18:19] op_sel:[0,1,0] op_sel_hi:[1,1,0]
  v_pk_fma_f32 v[42:43], v[42:43], v[18:19], v[18:19] op_sel:[0,1,0] op_sel_hi:[1,1,0]
  v_pk_fma_f32 v[44:45], v[44:45], v[18:19], v[18:19] op_sel:[0,1,0] op_sel_hi:[1,1,0]
  v_exp_f32 v28, v28
  buffer_load_dwordx4 a[220:223], v241, s[28:31], s53 offen offset:2048 sc1
  v_exp_f32 v29, v29
  v_exp_f32 v30, v30
  v_exp_f32 v31, v31
  v_exp_f32 v32, v32
  v_exp_f32 v33, v33
  v_exp_f32 v34, v34
  v_exp_f32 v35, v35
  global_load_dword v247, v244, s[6:7]
  global_load_dword v247, v245, s[6:7]
  v_exp_f32 v36, v36
  v_exp_f32 v37, v37
  v_exp_f32 v38, v38
  v_exp_f32 v39, v39
  v_exp_f32 v40, v40
  v_exp_f32 v41, v41
  v_exp_f32 v42, v42
  v_exp_f32 v43, v43
  v_exp_f32 v44, v44
  v_exp_f32 v45, v45
  v_pk_add_f32 v[18:19], v[28:29], v[30:31]
  v_pk_add_f32 v[20:21], v[32:33], v[34:35]
  v_pk_add_f32 v[18:19], v[18:19], v[36:37]
  v_pk_add_f32 v[20:21], v[20:21], v[38:39]
  v_pk_add_f32 v[18:19], v[18:19], v[40:41]
  v_pk_add_f32 v[20:21], v[20:21], v[42:43]
  v_pk_add_f32 v[18:19], v[18:19], v[44:45]
  v_pk_add_f32 v[18:19], v[18:19], v[20:21]
  v_add_f32 v18, v18, v19
  v_rcp_f32 v18, v18
  s_nop 0
  v_pk_mul_f32 v[28:29], v[28:29], v[18:19] op_sel_hi:[1,0]
  v_cvt_pk_bf16_f32 v208, v28, v29
  v_pk_mul_f32 v[30:31], v[30:31], v[18:19] op_sel_hi:[1,0]
  v_cvt_pk_bf16_f32 v209, v30, v31
  v_pk_mul_f32 v[32:33], v[32:33], v[18:19] op_sel_hi:[1,0]
  v_cvt_pk_bf16_f32 v210, v32, v33
  v_pk_mul_f32 v[34:35], v[34:35], v[18:19] op_sel_hi:[1,0]
  v_cvt_pk_bf16_f32 v211, v34, v35
  v_pk_mul_f32 v[36:37], v[36:37], v[18:19] op_sel_hi:[1,0]
  v_cvt_pk_bf16_f32 v212, v36, v37
  v_pk_mul_f32 v[38:39], v[38:39], v[18:19] op_sel_hi:[1,0]
  v_cvt_pk_bf16_f32 v213, v38, v39
  v_pk_mul_f32 v[40:41], v[40:41], v[18:19] op_sel_hi:[1,0]
  v_cvt_pk_bf16_f32 v214, v40, v41
  v_pk_mul_f32 v[42:43], v[42:43], v[18:19] op_sel_hi:[1,0]
  v_cvt_pk_bf16_f32 v215, v42, v43
  v_pk_mul_f32 v[44:45], v[44:45], v[18:19] op_sel_hi:[1,0]
  v_cvt_pk_bf16_f32 v216, v44, v45
  v_max3_f32 v248, v48, v49, v50
  v_max3_f32 v249, v51, v52, v53
  v_max3_f32 v248, v248, v54, v55
  v_max3_f32 v249, v249, v56, v57
  v_max3_f32 v248, v248, v58, v59
  v_max3_f32 v249, v249, v60, v61
  v_max3_f32 v248, v248, v62, v63
  v_max3_f32 v249, v249, v64, v65
  v_max_f32 v248, v248, v249
  v_mov_b32 v249, 0x3fb8aa3b
  v_mul_f32 v248, 0xbfb8aa3b, v248
  v_pk_fma_f32 v[48:49], v[48:49], v[248:249], v[248:249] op_sel:[0,1,0] op_sel_hi:[1,1,0]
  v_pk_fma_f32 v[50:51], v[50:51], v[248:249], v[248:249] op_sel:[0,1,0] op_sel_hi:[1,1,0]
  v_pk_fma_f32 v[52:53], v[52:53], v[248:249], v[248:249] op_sel:[0,1,0] op_sel_hi:[1,1,0]
  v_pk_fma_f32 v[54:55], v[54:55], v[248:249], v[248:249] op_sel:[0,1,0] op_sel_hi:[1,1,0]
  v_pk_fma_f32 v[56:57], v[56:57], v[248:249], v[248:249] op_sel:[0,1,0] op_sel_hi:[1,1,0]
  v_pk_fma_f32 v[58:59], v[58:59], v[248:249], v[248:249] op_sel:[0,1,0] op_sel_hi:[1,1,0]
  v_pk_fma_f32 v[60:61], v[60:61], v[248:249], v[248:249] op_sel:[0,1,0] op_sel_hi:[1,1,0]
  v_pk_fma_f32 v[62:63], v[62:63], v[248:249], v[248:249] op_sel:[0,1,0] op_sel_hi:[1,1,0]
  v_pk_fma_f32 v[64:65], v[64:65], v[248:249], v[248:249] op_sel:[0,1,0] op_sel_hi:[1,1,0]
  v_exp_f32 v48, v48
  v_exp_f32 v49, v49
  v_exp_f32 v50, v50
  v_exp_f32 v51, v51
  v_exp_f32 v52, v52
  v_exp_f32 v53, v53
  v_exp_f32 v54, v54
  v_exp_f32 v55, v55
  v_exp_f32 v56, v56
  v_exp_f32 v57, v57
  v_exp_f32 v58, v58
  v_exp_f32 v59, v59
  v_exp_f32 v60, v60
  v_exp_f32 v61, v61
  v_exp_f32 v62, v62
  v_exp_f32 v63, v63
  v_exp_f32 v64, v64
  v_exp_f32 v65, v65
  v_pk_add_f32 v[248:249], v[48:49], v[50:51]
  v_pk_add_f32 v[250:251], v[52:53], v[54:55]
  v_pk_add_f32 v[248:249], v[248:249], v[56:57]
  v_pk_add_f32 v[250:251], v[250:251], v[58:59]
  v_pk_add_f32 v[248:249], v[248:249], v[60:61]
  v_pk_add_f32 v[250:251], v[250:251], v[62:63]
  v_pk_add_f32 v[248:249], v[248:249], v[64:65]
  v_pk_add_f32 v[248:249], v[248:249], v[250:251]
  v_add_f32 v248, v248, v249
  v_rcp_f32 v248, v248
  s_nop 0
  v_pk_mul_f32 v[48:49], v[48:49], v[248:249] op_sel_hi:[1,0]
  v_cvt_pk_bf16_f32 v218, v48, v49
  v_pk_mul_f32 v[50:51], v[50:51], v[248:249] op_sel_hi:[1,0]
  v_cvt_pk_bf16_f32 v219, v50, v51
  v_pk_mul_f32 v[52:53], v[52:53], v[248:249] op_sel_hi:[1,0]
  v_cvt_pk_bf16_f32 v220, v52, v53
  v_pk_mul_f32 v[54:55], v[54:55], v[248:249] op_sel_hi:[1,0]
  v_cvt_pk_bf16_f32 v221, v54, v55
  v_pk_mul_f32 v[56:57], v[56:57], v[248:249] op_sel_hi:[1,0]
  v_cvt_pk_bf16_f32 v222, v56, v57
  v_pk_mul_f32 v[58:59], v[58:59], v[248:249] op_sel_hi:[1,0]
  v_cvt_pk_bf16_f32 v223, v58, v59
  v_pk_mul_f32 v[60:61], v[60:61], v[248:249] op_sel_hi:[1,0]
  v_cvt_pk_bf16_f32 v224, v60, v61
  v_pk_mul_f32 v[62:63], v[62:63], v[248:249] op_sel_hi:[1,0]
  v_cvt_pk_bf16_f32 v225, v62, v63
  v_pk_mul_f32 v[64:65], v[64:65], v[248:249] op_sel_hi:[1,0]
  v_cvt_pk_bf16_f32 v226, v64, v65
  s_waitcnt vmcnt(11)
  v_mfma_f32_16x16x32_bf16 v[108:111], a[240:243], a[176:179], 0
  v_lshlrev_b32 v94, 7, v2
  v_lshl_add_u32 v94, v3, 3, v94
  v_mfma_f32_16x16x32_bf16 v[112:115], a[240:243], a[192:195], 0
  v_add_u32 v6, s42, v94
  v_and_b32 v96, 1, v3
  v_mfma_f32_16x16x32_bf16 v[116:119], a[240:243], a[208:211], 0
  v_lshlrev_b32 v95, 4, v2
  v_lshl_add_u32 v95, v96, 3, v95
  s_waitcnt vmcnt(8)
  v_mfma_f32_16x16x32_bf16 v[108:111], a[240:243], a[180:183], v[108:111]
  v_add_u32 v7, s42, v95
  v_bfe_u32 v94, v1, 2, 3
  v_mfma_f32_16x16x32_bf16 v[112:115], a[240:243], a[196:199], v[112:115]
  v_and_b32 v95, 3, v1
  v_lshlrev_b32 v95, 3, v95
  v_mfma_f32_16x16x32_bf16 v[116:119], a[240:243], a[212:215], v[116:119]
  v_lshl_add_u32 v95, v94, 7, v95
  v_lshrrev_b32 v96, 5, v1
  s_waitcnt vmcnt(5)
  v_mfma_f32_16x16x32_bf16 v[108:111], a[240:243], a[184:187], v[108:111]
  v_mul_u32_u24 v97, 18432, v96
  v_add_u32 v95, v95, v97
  v_mfma_f32_16x16x32_bf16 v[112:115], a[240:243], a[200:203], v[112:115]
  v_lshrrev_b32 v97, 1, v94
  v_xor_b32 v98, 0, v97
  v_mfma_f32_16x16x32_bf16 v[116:119], a[240:243], a[216:219], v[116:119]
  v_lshl_add_u32 v11, v98, 5, v95
  v_xor_b32 v98, 1, v97
  s_waitcnt vmcnt(2)
  v_mfma_f32_16x16x32_bf16 v[108:111], a[240:243], a[188:191], v[108:111]
  v_lshl_add_u32 v12, v98, 5, v95
  v_xor_b32 v98, 2, v97
  v_mfma_f32_16x16x32_bf16 v[112:115], a[240:243], a[204:207], v[112:115]
  v_lshl_add_u32 v13, v98, 5, v95
  v_xor_b32 v98, 3, v97
  v_mfma_f32_16x16x32_bf16 v[116:119], a[240:243], a[220:223], v[116:119]
  v_lshl_add_u32 v14, v98, 5, v95
  v_lshlrev_b32 v4, 3, v1
  v_add_u32 v4, 73728, v4
  v_cvt_pk_bf16_f32 v108, v108, v109
  v_cvt_pk_bf16_f32 v109, v110, v111
  ds_write_b64 v242, v[108:109] offset:0
  v_cvt_pk_bf16_f32 v112, v112, v113
  v_cvt_pk_bf16_f32 v113, v114, v115
  ds_write_b64 v242, v[112:113] offset:1024
  v_cvt_pk_bf16_f32 v116, v116, v117
  v_cvt_pk_bf16_f32 v117, v118, v119
  ds_write_b64 v242, v[116:117] offset:2048
  s_waitcnt lgkmcnt(0)
  s_barrier
  ds_read_b64 v[56:57], v252 offset:736
  ds_read_b64 v[36:37], v243 offset:608
  ds_read_b64 v[46:47], v243 offset:672
  ds_read_b64 v[48:49], v252 offset:128
  ds_read_b64 v[50:51], v252 offset:280
  ds_read_b64 v[52:53], v252 offset:432
  ds_read_b64 v[54:55], v252 offset:584
  ds_read_b64 v[28:29], v243 offset:0
  ds_read_b64 v[30:31], v243 offset:152
  ds_read_b64 v[32:33], v243 offset:304
  ds_read_b64 v[34:35], v243 offset:456
  s_waitcnt lgkmcnt(8)
  v_mfma_f32_16x16x16_bf16 v[68:71], v[56:57], v[216:217], 0
  ds_read_b64 v[38:39], v243 offset:64
  v_mfma_f32_16x16x16_bf16 v[80:83], v[56:57], v[226:227], 0
  ds_read_b64 v[40:41], v243 offset:216
  v_mfma_f32_16x16x16_bf16 v[60:63], v[36:37], v[216:217], 0
  ds_read_b64 v[42:43], v243 offset:368
  v_mfma_f32_16x16x16_bf16 v[72:75], v[36:37], v[226:227], 0
  ds_read_b64 v[44:45], v243 offset:520
  v_mfma_f32_16x16x16_bf16 v[64:67], v[46:47], v[216:217], 0
  v_mfma_f32_16x16x16_bf16 v[76:79], v[46:47], v[226:227], 0
  s_waitcnt lgkmcnt(8)
  v_mfma_f32_16x16x32_bf16 v[68:71], v[48:51], v[208:211], v[68:71]
  ds_read_b64_tr_b16 a[0:1], v11 offset:0
  v_mfma_f32_16x16x32_bf16 v[68:71], v[52:55], v[212:215], v[68:71]
  ds_read_b64_tr_b16 a[2:3], v11 offset:36864
  v_mfma_f32_16x16x32_bf16 v[80:83], v[48:51], v[218:221], v[80:83]
  ds_read_b64_tr_b16 a[4:5], v12 offset:0
  v_mfma_f32_16x16x32_bf16 v[80:83], v[52:55], v[222:225], v[80:83]
  s_waitcnt lgkmcnt(7)
  ds_read_b64_tr_b16 a[6:7], v12 offset:36864
  v_mfma_f32_16x16x32_bf16 v[60:63], v[28:31], v[208:211], v[60:63]
  ds_read_b64_tr_b16 a[8:9], v13 offset:0
  v_mfma_f32_16x16x32_bf16 v[60:63], v[32:35], v[212:215], v[60:63]
  ds_read_b64_tr_b16 a[10:11], v13 offset:36864
  v_mfma_f32_16x16x32_bf16 v[72:75], v[28:31], v[218:221], v[72:75]
  v_add_f32 v70, 0x358637bd, v70
  ds_read_b64_tr_b16 a[12:13], v14 offset:0
  v_mfma_f32_16x16x32_bf16 v[72:75], v[32:35], v[222:225], v[72:75]
  s_waitcnt lgkmcnt(7)
  v_rcp_f32 v70, v70
  v_mfma_f32_16x16x32_bf16 v[64:67], v[38:41], v[208:211], v[64:67]
  v_add_f32 v82, 0x358637bd, v82
  v_mul_f32 v68, v68, v70
  v_mfma_f32_16x16x32_bf16 v[64:67], v[42:45], v[212:215], v[64:67]
  v_rcp_f32 v82, v82
  v_mfma_f32_16x16x32_bf16 v[76:79], v[38:41], v[218:221], v[76:79]
  v_mul_f32 v69, v69, v70
  v_mul_f32 v80, v80, v82
  v_mfma_f32_16x16x32_bf16 v[76:79], v[42:45], v[222:225], v[76:79]
  v_mul_f32 v81, v81, v82
  v_cvt_pk_bf16_f32 v68, v68, v69
  v_cvt_pk_bf16_f32 v69, v80, v81
  v_pk_mul_f32 v[60:61], v[60:61], v[70:71] op_sel_hi:[1,0]
  v_pk_mul_f32 v[62:63], v[62:63], v[70:71] op_sel_hi:[1,0]
  v_permlane32_swap_b32 v68, v69
  buffer_store_dwordx2 v[68:69], v254, s[28:31], s66 offen sc1
  v_cvt_pk_bf16_f32 v60, v60, v61
  v_cvt_pk_bf16_f32 v61, v62, v63
  v_pk_mul_f32 v[72:73], v[72:73], v[82:83] op_sel_hi:[1,0]
  v_pk_mul_f32 v[74:75], v[74:75], v[82:83] op_sel_hi:[1,0]
  v_cvt_pk_bf16_f32 v72, v72, v73
  v_cvt_pk_bf16_f32 v73, v74, v75
  v_pk_mul_f32 v[64:65], v[64:65], v[70:71] op_sel_hi:[1,0]
  v_pk_mul_f32 v[66:67], v[66:67], v[70:71] op_sel_hi:[1,0]
  v_cvt_pk_bf16_f32 v62, v64, v65
  v_cvt_pk_bf16_f32 v63, v66, v67
  buffer_store_dwordx4 v[60:63], v253, s[28:31], s65 offen sc1
  s_add_u32 s65, s65, 18432
  v_pk_mul_f32 v[76:77], v[76:77], v[82:83] op_sel_hi:[1,0]
  v_pk_mul_f32 v[78:79], v[78:79], v[82:83] op_sel_hi:[1,0]
  v_cvt_pk_bf16_f32 v74, v76, v77
  v_cvt_pk_bf16_f32 v75, v78, v79
  buffer_store_dwordx4 v[72:75], v253, s[28:31], s65 offen sc1
  ds_read_b64 v[220:221], v6 offset:14336
  ds_read_b64 v[222:223], v6 offset:14368
  ds_read_b64 v[224:225], v6 offset:14400
  ds_read_b64 v[226:227], v6 offset:14432
L_hop4:
  s_cbranch_execz L_hop8
  ds_read_b64 v[228:229], v7 offset:2560
  ds_read_b64_tr_b16 a[14:15], v14 offset:36864
  s_lshl_b32 s68, s37, 2
  ds_read_b64_tr_b16 a[16:17], v4 offset:0
  s_add_u32 s68, s68, s3
  ds_read_b64_tr_b16 a[18:19], v4 offset:512
  s_lshl_b32 s68, s68, 7
  ds_read_b64_tr_b16 a[20:21], v11 offset:1024
  s_add_u32 s76, s68, 58722304
  ds_read_b64_tr_b16 a[22:23], v11 offset:37888
  v_bfe_u32 v18, v1, 1, 2
  ds_read_b64_tr_b16 a[24:25], v12 offset:1024
  v_bfe_u32 v19, v1, 4, 2
  ds_read_b64_tr_b16 a[26:27], v12 offset:37888
  v_xor_b32 v18, v18, v19
  ds_read_b64_tr_b16 a[28:29], v13 offset:1024
  v_and_b32 v19, 1, v1
  ds_read_b64_tr_b16 a[30:31], v13 offset:37888
  v_lshlrev_b32 v19, 4, v19
  ds_read_b64_tr_b16 a[32:33], v14 offset:1024
  v_lshl_add_u32 v18, v18, 5, v19
  ds_read_b64_tr_b16 a[34:35], v14 offset:37888
  v_lshrrev_b32 v255, 3, v1
  ds_read_b64_tr_b16 a[36:37], v4 offset:1024
  v_mul_u32_u24 v249, 9216, v255
  ds_read_b64_tr_b16 a[38:39], v4 offset:1536
  v_add_u32 v249, v249, v18
  ds_read_b64_tr_b16 a[40:41], v11 offset:2048
  v_mul_u32_u24 v250, 1152, v255
  ds_read_b64_tr_b16 a[42:43], v11 offset:38912
  v_add_u32 v250, v250, v18
  ds_read_b64_tr_b16 a[44:45], v12 offset:2048
  s_and_b32 s64, s2, 7
  ds_read_b64_tr_b16 a[46:47], v12 offset:38912
  s_bfe_u32 s65, s2, 0x20003
  ds_read_b64_tr_b16 a[48:49], v13 offset:2048
  s_lshr_b32 s66, s2, 5
  ds_read_b64_tr_b16 a[50:51], v13 offset:38912
  s_mul_i32 s57, s64, 1152
  ds_read_b64_tr_b16 a[52:53], v14 offset:2048
  s_lshl_b32 s58, s65, 8
  ds_read_b64_tr_b16 a[54:55], v14 offset:38912
  s_add_u32 s32, s57, s58
  ds_read_b64_tr_b16 a[56:57], v4 offset:2048
  s_mul_i32 s59, s3, 73728
  ds_read_b64_tr_b16 a[58:59], v4 offset:2560
  s_add_u32 s32, s32, s59
  ds_read_b64_tr_b16 a[60:61], v11 offset:3072
  s_mul_i32 s35, s3, 3072
  ds_read_b64_tr_b16 a[62:63], v11 offset:39936
  s_mov_b32 s12, s4
  ds_read_b64_tr_b16 a[64:65], v12 offset:3072
  s_and_b32 s13, s5, 0xffff
  ds_read_b64_tr_b16 a[66:67], v12 offset:39936
  s_mov_b32 s14, 5308416
  ds_read_b64_tr_b16 a[68:69], v13 offset:3072
  s_mov_b32 s15, 0x20000
  ds_read_b64_tr_b16 a[70:71], v13 offset:39936
  s_mov_b32 s16, s6
  ds_read_b64_tr_b16 a[72:73], v14 offset:3072
  s_and_b32 s17, s7, 0xffff
  ds_read_b64_tr_b16 a[74:75], v14 offset:39936
  s_mov_b32 s18, 5308416
  ds_read_b64_tr_b16 a[76:77], v4 offset:3072
  s_mov_b32 s19, 0x20000
  ds_read_b64_tr_b16 a[78:79], v4 offset:3584
  s_mov_b32 s20, s8
  ds_read_b64_tr_b16 a[80:81], v11 offset:4096
  s_and_b32 s21, s9, 0xffff
  ds_read_b64_tr_b16 a[82:83], v11 offset:40960
  s_mov_b32 s22, 5308416
  ds_read_b64_tr_b16 a[84:85], v12 offset:4096
  s_mov_b32 s23, 0x20000
  ds_read_b64_tr_b16 a[86:87], v12 offset:40960
  s_waitcnt lgkmcnt(15)
  s_barrier
  ds_read_b64_tr_b16 a[88:89], v13 offset:4096
  s_add_u32 s57, s32, 0
  ds_read_b64_tr_b16 a[90:91], v13 offset:40960
  s_add_u32 s58, s32, 293888
  ds_read_b64_tr_b16 a[92:93], v14 offset:4096
  s_add_u32 s59, s32, 587776
  ds_read_b64_tr_b16 a[94:95], v14 offset:40960
  s_waitcnt vmcnt(0)
  buffer_atomic_add v17, v15, s[28:31], s76 offen sc1
  s_add_u32 m0, s35, 110592
  ds_read_b64_tr_b16 a[96:97], v4 offset:4096
  buffer_load_dwordx4 v249, s[12:15], s57 offen offset:0  lds
  ds_read_b64_tr_b16 a[98:99], v4 offset:4608
  s_lshr_b32 s68, s72, 1
  ds_read_b64_tr_b16 a[100:101], v11 offset:5120
  s_lshl_b32 s68, s68, 7
  ds_read_b64_tr_b16 a[102:103], v11 offset:41984
  s_add_u32 s77, s68, 58722304
  ds_read_b64_tr_b16 a[104:105], v12 offset:5120
  buffer_load_dwordx4 v249, s[12:15], s58 offen offset:1024  lds
  ds_read_b64_tr_b16 a[106:107], v12 offset:41984
  s_mul_i32 s68, s72, 18432
  ds_read_b64_tr_b16 a[108:109], v13 offset:5120
  s_add_u32 s78, s68, 50331648
  ds_read_b64_tr_b16 a[110:111], v13 offset:41984
  s_lshl_b32 s68, s72, 6
  ds_read_b64_tr_b16 a[112:113], v14 offset:5120
  buffer_load_dwordx4 v249, s[12:15], s59 offen offset:2048  lds
  ds_read_b64_tr_b16 a[114:115], v14 offset:41984
  s_add_u32 s68, s68, 53542912
  ds_read_b64_tr_b16 a[116:117], v4 offset:5120
  v_lshlrev_b32 v200, 16, v220
  ds_read_b64_tr_b16 a[118:119], v4 offset:5632
  v_and_b32 v201, 0xffff0000, v220
  ds_read_b64_tr_b16 a[120:121], v11 offset:6144
  s_add_u32 m0, s35, 122880
  ds_read_b64_tr_b16 a[122:123], v11 offset:43008
  buffer_load_dwordx4 v249, s[16:19], s57 offen offset:0  lds
  ds_read_b64_tr_b16 a[124:125], v12 offset:6144
  v_lshlrev_b32 v202, 16, v221
  ds_read_b64_tr_b16 a[126:127], v12 offset:43008
  v_and_b32 v203, 0xffff0000, v221
  ds_read_b64_tr_b16 a[128:129], v13 offset:6144
  v_lshlrev_b32 v204, 16, v222
  ds_read_b64_tr_b16 a[130:131], v13 offset:43008
  buffer_load_dwordx4 v249, s[16:19], s58 offen offset:1024  lds
  ds_read_b64_tr_b16 a[132:133], v14 offset:6144
  v_and_b32 v205, 0xffff0000, v222
  ds_read_b64_tr_b16 a[134:135], v14 offset:43008
  v_lshlrev_b32 v206, 16, v223
  ds_read_b64_tr_b16 a[136:137], v4 offset:6144
  v_and_b32 v207, 0xffff0000, v223
  ds_read_b64_tr_b16 a[138:139], v4 offset:6656
  buffer_load_dwordx4 v249, s[16:19], s59 offen offset:2048  lds
  ds_read_b64_tr_b16 a[140:141], v11 offset:7168
  v_lshlrev_b32 v208, 16, v224
  ds_read_b64_tr_b16 a[142:143], v11 offset:44032
  v_and_b32 v209, 0xffff0000, v224
  ds_read_b64_tr_b16 a[144:145], v12 offset:7168
  v_lshlrev_b32 v210, 16, v225
  ds_read_b64_tr_b16 a[146:147], v12 offset:44032
  s_add_u32 s57, s32, 884736
  ds_read_b64_tr_b16 a[148:149], v13 offset:7168
  s_add_u32 s58, s32, 1178624
  ds_read_b64_tr_b16 a[150:151], v13 offset:44032
  s_add_u32 s59, s32, 1472512
  ds_read_b64_tr_b16 a[152:153], v14 offset:7168
  s_add_u32 m0, s35, 135168
  ds_read_b64_tr_b16 a[154:155], v14 offset:44032
  v_mov_b32 v16, 0
  buffer_atomic_add v16, v15, s[28:31], s77 offen offset:0 sc0 sc1
  buffer_load_dwordx4 v249, s[12:15], s57 offen offset:0  lds
  ds_read_b64_tr_b16 a[156:157], v4 offset:7168
  v_and_b32 v211, 0xffff0000, v225
  ds_read_b64_tr_b16 a[158:159], v4 offset:7680
  v_lshlrev_b32 v212, 16, v226
  ds_read_b64_tr_b16 a[160:161], v11 offset:8192
  v_and_b32 v213, 0xffff0000, v226
  ds_read_b64_tr_b16 a[162:163], v11 offset:45056
  buffer_load_dwordx4 v249, s[12:15], s58 offen offset:1024  lds
  ds_read_b64_tr_b16 a[164:165], v12 offset:8192
  v_lshlrev_b32 v214, 16, v227
  ds_read_b64_tr_b16 a[166:167], v12 offset:45056
  v_and_b32 v215, 0xffff0000, v227
  ds_read_b64_tr_b16 a[168:169], v13 offset:8192
  v_lshlrev_b32 v216, 16, v228
  ds_read_b64_tr_b16 a[170:171], v13 offset:45056
  buffer_load_dwordx4 v249, s[12:15], s59 offen offset:2048  lds
  ds_read_b64_tr_b16 a[172:173], v14 offset:8192
  v_and_b32 v217, 0xffff0000, v228
  v_lshlrev_b32 v218, 16, v229
  v_and_b32 v219, 0xffff0000, v229
  s_add_u32 m0, s35, 147456
  s_nop 0
  buffer_load_dwordx4 v249, s[16:19], s57 offen offset:0  lds
  buffer_load_dwordx4 v249, s[16:19], s58 offen offset:1024  lds
  buffer_load_dwordx4 v249, s[16:19], s59 offen offset:2048  lds
  v_lshlrev_b32 v252, 4, v1
  v_lshlrev_b32 v253, 3, v1
  v_cmp_eq_u32 vcc, 0, v1
  v_lshrrev_b32 v20, 2, v1
  v_and_b32 v21, 3, v1
  v_lshlrev_b32 v21, 3, v21
  v_mov_b32 v255, 0x40000000
  v_cndmask_b32 v254, v255, 0, vcc
  v_lshl_add_u32 v248, v20, 5, v21
  v_and_b32 v255, 7, v20
  v_lshl_add_u32 v21, v255, 7, v21
  v_lshrrev_b32 v255, 3, v20
  v_mul_u32_u24 v255, 3072, v255
  v_add_u32 v21, v21, v255
  v_add_u32 v21, 36864, v21
  v_bfe_u32 v20, v20, 1, 2
  v_xor_b32 v255, 0, v20
  v_lshl_add_u32 v236, v255, 5, v21
  v_add_u32 v240, 61440, v236
  v_xor_b32 v255, 1, v20
  v_lshl_add_u32 v237, v255, 5, v21
  v_add_u32 v241, 61440, v237
  v_xor_b32 v255, 2, v20
  v_lshl_add_u32 v238, v255, 5, v21
  v_add_u32 v242, 61440, v238
  v_xor_b32 v255, 3, v20
  v_lshl_add_u32 v239, v255, 5, v21
  v_add_u32 v243, 61440, v239
  s_lshl_b32 s58, s65, 8
  s_lshl_b32 s60, s64, 2
  s_add_u32 s60, s60, s65
  s_mul_i32 s60, s60, 55296
  s_add_u32 s60, s60, 59768832
  s_add_u32 s41, s60, 36864
  s_mul_i32 s34, s3, 9216
  s_add_u32 s33, s60, s34
  s_mul_i32 s57, s64, 663552
  s_mul_i32 s59, s3, 9216
  s_add_u32 s40, s57, s58
  s_add_u32 s40, s40, s59
  s_lshl_b32 s61, s66, 2
  s_add_u32 s61, s61, s3
  s_mul_i32 s62, s61, 73728
  s_add_u32 s36, s62, 0
  s_mul_i32 s57, s64, 2359296
  v_lshlrev_b32 v18, 2, v2
  s_mov_b32 s71, 0
  s_waitcnt vmcnt(6)
  v_readfirstlane_b32 s70, v16
  v_mov_b32 v16, 0
  s_nop 1
  s_cmp_ge_u32 s70, 16
  s_cbranch_scc1 Lw4_ok
Lw4:
  buffer_atomic_add v16, v15, s[28:31], s77 offen offset:0 sc0 sc1
  s_add_u32 s71, s71, 1
  s_cmp_gt_u32 s71, 100000
  s_waitcnt vmcnt(0)
  v_readfirstlane_b32 s70, v16
  v_mov_b32 v16, 0
  s_cbranch_scc1 Lw4_ok
  s_nop 0
  s_cmp_ge_u32 s70, 16
  s_cbranch_scc0 Lw4
Lw4_ok:
  s_mov_b32 exec_lo, 0
  buffer_load_dword v216, v18, s[28:31], s68 offen sc1
  s_mov_b64 exec, -1
  buffer_load_dwordx4 v[128:131], v252, s[28:31], s78 offen offset:0 sc1
  buffer_load_dwordx4 v[132:135], v252, s[28:31], s78 offen offset:1024 sc1
  buffer_load_dwordx4 v[136:139], v252, s[28:31], s78 offen offset:2048 sc1
  buffer_load_dwordx4 v[140:143], v252, s[28:31], s78 offen offset:3072 sc1
  s_add_u32 s78, s78, 4096
  buffer_load_dwordx4 v[144:147], v252, s[28:31], s78 offen offset:0 sc1
  buffer_load_dwordx4 v[148:151], v252, s[28:31], s78 offen offset:1024 sc1
  buffer_load_dwordx4 v[152:155], v252, s[28:31], s78 offen offset:2048 sc1
  buffer_load_dwordx4 v[156:159], v252, s[28:31], s78 offen offset:3072 sc1
  s_add_u32 s78, s78, 4096
  buffer_load_dwordx4 v[160:163], v252, s[28:31], s78 offen offset:0 sc1
  buffer_load_dwordx4 v[164:167], v252, s[28:31], s78 offen offset:1024 sc1
  ds_read_b64_tr_b16 a[174:175], v14 offset:45056
  s_add_u32 s57, s57, s62
  ds_read_b64_tr_b16 a[176:177], v4 offset:8192
  s_add_u32 s39, s57, 4194304
  ds_read_b64_tr_b16 a[178:179], v4 offset:8704
  s_lshl_b32 s58, s65, 14
  ds_read_b64_tr_b16 a[180:181], v11 offset:9216
  s_add_u32 s37, s39, s58
  ds_read_b64_tr_b16 a[182:183], v11 offset:46080
  s_lshr_b32 s58, s65, 1
  ds_read_b64_tr_b16 a[184:185], v12 offset:9216
  s_lshl_b32 s58, s58, 12
  ds_read_b64_tr_b16 a[186:187], v12 offset:46080
  s_and_b32 s59, s65, 1
  ds_read_b64_tr_b16 a[188:189], v13 offset:9216
  s_lshl_b32 s59, s59, 9
  ds_read_b64_tr_b16 a[190:191], v13 offset:46080
  s_add_u32 s58, s58, s59
  ds_read_b64_tr_b16 a[192:193], v14 offset:9216
  s_add_u32 s58, s58, 65536
  ds_read_b64_tr_b16 a[194:195], v14 offset:46080
  s_add_u32 s38, s39, s58
  ds_read_b64_tr_b16 a[196:197], v4 offset:9216
  s_lshl_b32 s57, s64, 5
  ds_read_b64_tr_b16 a[198:199], v4 offset:9728
  s_add_u32 s57, s57, s61
  ds_read_b64_tr_b16 a[200:201], v11 offset:10240
  s_mul_i32 s57, s57, 384
  ds_read_b64_tr_b16 a[202:203], v11 offset:47104
  s_add_u32 s42, s57, 58746880
  ds_read_b64_tr_b16 a[204:205], v12 offset:10240
  s_lshl_b32 s57, s66, 2
  ds_read_b64_tr_b16 a[206:207], v12 offset:47104
  s_add_u32 s57, s57, s65
  ds_read_b64_tr_b16 a[208:209], v13 offset:10240
  s_lshl_b32 s58, s57, 2
  ds_read_b64_tr_b16 a[210:211], v13 offset:47104
  s_add_u32 s58, s58, s3
  ds_read_b64_tr_b16 a[212:213], v14 offset:10240
  s_mul_i32 s58, s58, 384
  ds_read_b64_tr_b16 a[214:215], v14 offset:47104
  s_add_u32 s43, s58, 58845184
  ds_read_b64_tr_b16 a[216:217], v4 offset:10240
  s_lshr_b32 s57, s64, 2
  ds_read_b64_tr_b16 a[218:219], v4 offset:10752
  s_lshl_b32 s57, s57, 7
  ds_read_b64_tr_b16 a[220:221], v11 offset:11264
  v_add_u32 v251, s57, v250
  ds_read_b64_tr_b16 a[222:223], v11 offset:48128
  s_xor_b32 s57, s57, 128
  ds_read_b64_tr_b16 a[224:225], v12 offset:11264
  v_add_u32 v250, s57, v250
  ds_read_b64_tr_b16 a[226:227], v12 offset:48128
  s_and_b32 s58, s64, 3
  ds_read_b64_tr_b16 a[228:229], v13 offset:11264
  s_xor_b32 s57, s58, 3
  ds_read_b64_tr_b16 a[230:231], v13 offset:48128
  s_lshl_b32 s57, s57, 10
  ds_read_b64_tr_b16 a[232:233], v14 offset:11264
  s_add_u32 s24, s57, s36
  s_waitcnt vmcnt(9)
  v_mfma_f32_16x16x32_bf16 v[200:203], a[0:3], v[128:131], v[200:203]
  s_xor_b32 s57, s58, 2
  ds_read_b64_tr_b16 a[234:235], v14 offset:48128
  buffer_load_dwordx4 v[168:171], v252, s[28:31], s78 offen offset:2048 sc1
  v_mfma_f32_16x16x32_bf16 v[204:207], a[4:7], v[128:131], v[204:207]
  s_lshl_b32 s57, s57, 10
  ds_read_b64_tr_b16 a[236:237], v4 offset:11264
  s_add_u32 s25, s57, s36
  v_mfma_f32_16x16x32_bf16 v[208:211], a[8:11], v[128:131], v[208:211]
  s_xor_b32 s57, s58, 1
  ds_read_b64_tr_b16 a[238:239], v4 offset:11776
  s_lshl_b32 s57, s57, 10
  v_mfma_f32_16x16x32_bf16 v[212:215], a[12:15], v[128:131], v[212:215]
  ds_read_b64_tr_b16 a[240:241], v11 offset:12288
  v_mfma_f32_16x16x32_bf16 v[216:219], a[16:19], v[128:131], v[216:219]
  ds_read_b64_tr_b16 a[242:243], v11 offset:49152
  s_waitcnt vmcnt(9)
  v_mfma_f32_16x16x32_bf16 v[216:219], a[36:39], v[132:135], v[216:219]
  s_add_u32 s26, s57, s36
  ds_read_b64_tr_b16 a[244:245], v12 offset:12288
  buffer_load_dwordx4 v[172:175], v252, s[28:31], s78 offen offset:3072 sc1
  v_mfma_f32_16x16x32_bf16 v[212:215], a[32:35], v[132:135], v[212:215]
  s_xor_b32 s57, s58, 0
  ds_read_b64_tr_b16 a[246:247], v12 offset:49152
  s_lshl_b32 s57, s57, 10
  v_mfma_f32_16x16x32_bf16 v[208:211], a[28:31], v[132:135], v[208:211]
  s_add_u32 s27, s57, s36
  ds_read_b64_tr_b16 a[248:249], v13 offset:12288
  s_add_u32 s57, s65, 0
  v_mfma_f32_16x16x32_bf16 v[204:207], a[24:27], v[132:135], v[204:207]
  ds_read_b64_tr_b16 a[250:251], v13 offset:49152
  v_mfma_f32_16x16x32_bf16 v[200:203], a[20:23], v[132:135], v[200:203]
  ds_read_b64_tr_b16 a[252:253], v14 offset:12288
  s_waitcnt vmcnt(9) lgkmcnt(15)
  v_mfma_f32_16x16x32_bf16 v[200:203], a[40:43], v[136:139], v[200:203]
  s_add_u32 s78, s78, 4096
  ds_read_b64_tr_b16 a[254:255], v14 offset:49152
  buffer_load_dwordx4 v[176:179], v252, s[28:31], s78 offen offset:0 sc1
  v_mfma_f32_16x16x32_bf16 v[204:207], a[44:47], v[136:139], v[204:207]
  s_and_b32 s57, s57, 3
  ds_read_b64_tr_b16 v[24:25], v4 offset:12288
  s_mul_i32 s45, s57, 147456
  v_mfma_f32_16x16x32_bf16 v[208:211], a[48:51], v[136:139], v[208:211]
  s_add_u32 s45, s45, s40
  ds_read_b64_tr_b16 v[26:27], v4 offset:12800
  s_lshl_b32 s49, s57, 14
  v_mfma_f32_16x16x32_bf16 v[212:215], a[52:55], v[136:139], v[212:215]
  s_add_u32 s49, s49, s39
  ds_read_b64_tr_b16 v[28:29], v11 offset:13312
  v_mfma_f32_16x16x32_bf16 v[216:219], a[56:59], v[136:139], v[216:219]
  ds_read_b64_tr_b16 v[30:31], v11 offset:50176
  s_waitcnt vmcnt(9)
  v_mfma_f32_16x16x32_bf16 v[216:219], a[76:79], v[140:143], v[216:219]
  s_lshl_b32 s53, s57, 12
  ds_read_b64_tr_b16 v[32:33], v12 offset:13312
  buffer_load_dwordx4 v[180:183], v252, s[28:31], s78 offen offset:1024 sc1
  v_mfma_f32_16x16x32_bf16 v[212:215], a[72:75], v[140:143], v[212:215]
  s_add_u32 s57, s65, 1
  ds_read_b64_tr_b16 v[34:35], v12 offset:50176
  s_and_b32 s57, s57, 3
  v_mfma_f32_16x16x32_bf16 v[208:211], a[68:71], v[140:143], v[208:211]
  s_mul_i32 s46, s57, 147456
  ds_read_b64_tr_b16 v[36:37], v13 offset:13312
  s_add_u32 s46, s46, s40
  v_mfma_f32_16x16x32_bf16 v[204:207], a[64:67], v[140:143], v[204:207]
  ds_read_b64_tr_b16 v[38:39], v13 offset:50176
  v_mfma_f32_16x16x32_bf16 v[200:203], a[60:63], v[140:143], v[200:203]
  ds_read_b64_tr_b16 v[40:41], v14 offset:13312
  s_waitcnt vmcnt(9)
  v_mfma_f32_16x16x32_bf16 v[200:203], a[80:83], v[144:147], v[200:203]
  s_lshl_b32 s50, s57, 14
  ds_read_b64_tr_b16 v[42:43], v14 offset:50176
  buffer_load_dwordx4 v[184:187], v252, s[28:31], s78 offen offset:2048 sc1
  v_mfma_f32_16x16x32_bf16 v[204:207], a[84:87], v[144:147], v[204:207]
  s_add_u32 s50, s50, s39
  ds_read_b64_tr_b16 v[44:45], v4 offset:13312
  s_lshl_b32 s54, s57, 12
  v_mfma_f32_16x16x32_bf16 v[208:211], a[88:91], v[144:147], v[208:211]
  s_add_u32 s57, s65, 2
  ds_read_b64_tr_b16 v[46:47], v4 offset:13824
  s_and_b32 s57, s57, 3
  v_mfma_f32_16x16x32_bf16 v[212:215], a[92:95], v[144:147], v[212:215]
  ds_read_b64_tr_b16 v[48:49], v11 offset:14336
  v_mfma_f32_16x16x32_bf16 v[216:219], a[96:99], v[144:147], v[216:219]
  ds_read_b64_tr_b16 v[50:51], v11 offset:51200
  s_waitcnt vmcnt(9)
  v_mfma_f32_16x16x32_bf16 v[216:219], a[116:119], v[148:151], v[216:219]
  s_mul_i32 s47, s57, 147456
  ds_read_b64_tr_b16 v[52:53], v12 offset:14336
  buffer_load_dwordx4 v[188:191], v252, s[28:31], s78 offen offset:3072 sc1
  v_mfma_f32_16x16x32_bf16 v[212:215], a[112:115], v[148:151], v[212:215]
  s_add_u32 s47, s47, s40
  ds_read_b64_tr_b16 v[54:55], v12 offset:51200
  s_lshl_b32 s51, s57, 14
  v_mfma_f32_16x16x32_bf16 v[208:211], a[108:111], v[148:151], v[208:211]
  s_add_u32 s51, s51, s39
  ds_read_b64_tr_b16 v[56:57], v13 offset:14336
  s_lshl_b32 s55, s57, 12
  v_mfma_f32_16x16x32_bf16 v[204:207], a[104:107], v[148:151], v[204:207]
  ds_read_b64_tr_b16 v[58:59], v13 offset:51200
  v_mfma_f32_16x16x32_bf16 v[200:203], a[100:103], v[148:151], v[200:203]
  ds_read_b64_tr_b16 v[60:61], v14 offset:14336
  s_waitcnt vmcnt(9)
  v_mfma_f32_16x16x32_bf16 v[200:203], a[120:123], v[152:155], v[200:203]
  s_add_u32 s78, s78, 4096
  ds_read_b64_tr_b16 v[62:63], v14 offset:51200
  buffer_load_dwordx2 v[192:193], v253, s[28:31], s78 offen offset:0 sc1
  v_mfma_f32_16x16x32_bf16 v[204:207], a[124:127], v[152:155], v[204:207]
  s_add_u32 s57, s65, 3
  ds_read_b64_tr_b16 v[64:65], v4 offset:14336
  buffer_load_dwordx2 v[194:195], v253, s[28:31], s78 offen offset:512 sc1
  v_mfma_f32_16x16x32_bf16 v[208:211], a[128:131], v[152:155], v[208:211]
  s_and_b32 s57, s57, 3
  ds_read_b64_tr_b16 v[66:67], v4 offset:14848
  s_mul_i32 s48, s57, 147456
  v_mfma_f32_16x16x32_bf16 v[212:215], a[132:135], v[152:155], v[212:215]
  s_add_u32 s48, s48, s40
  ds_read_b64_tr_b16 v[68:69], v11 offset:15360
  s_lshl_b32 s52, s57, 14
  v_mfma_f32_16x16x32_bf16 v[216:219], a[136:139], v[152:155], v[216:219]
  ds_read_b64_tr_b16 v[70:71], v11 offset:52224
  s_waitcnt vmcnt(10)
  v_mfma_f32_16x16x32_bf16 v[216:219], a[156:159], v[156:159], v[216:219]
  s_add_u32 s52, s52, s39
  ds_read_b64_tr_b16 v[72:73], v12 offset:15360
  buffer_load_dwordx2 v[196:197], v253, s[28:31], s78 offen offset:1024 sc1
  v_mfma_f32_16x16x32_bf16 v[212:215], a[152:155], v[156:159], v[212:215]
  s_lshl_b32 s56, s57, 12
  ds_read_b64_tr_b16 v[74:75], v12 offset:52224
  buffer_load_dwordx2 v[198:199], v253, s[28:31], s78 offen offset:1536 sc1
  v_mfma_f32_16x16x32_bf16 v[208:211], a[148:151], v[156:159], v[208:211]
  ds_read_b64_tr_b16 v[76:77], v13 offset:15360
  v_mov_b32 v0, 1
  v_mfma_f32_16x16x32_bf16 v[204:207], a[144:147], v[156:159], v[204:207]
  s_lshr_b32 s68, s72, 2
  ds_read_b64_tr_b16 v[78:79], v13 offset:52224
  s_mul_i32 s68, s68, 73728
  v_mfma_f32_16x16x32_bf16 v[200:203], a[140:143], v[156:159], v[200:203]
  ds_read_b64_tr_b16 v[80:81], v14 offset:15360
  s_waitcnt vmcnt(11)
  v_mfma_f32_16x16x32_bf16 v[200:203], a[160:163], v[160:163], v[200:203]
  s_lshl_b32 s69, s3, 10
  ds_read_b64_tr_b16 v[82:83], v14 offset:52224
  s_add_u32 s68, s68, s69
  v_mfma_f32_16x16x32_bf16 v[204:207], a[164:167], v[160:163], v[204:207]
  s_add_u32 s68, s68, 0
  ds_read_b64_tr_b16 v[84:85], v4 offset:15360
  s_lshl_b32 s69, s67, 13
  v_mfma_f32_16x16x32_bf16 v[208:211], a[168:171], v[160:163], v[208:211]
  s_add_u32 s76, s68, s69
  ds_read_b64_tr_b16 v[86:87], v4 offset:15872
  v_mfma_f32_16x16x32_bf16 v[212:215], a[172:175], v[160:163], v[212:215]
  ds_read_b64_tr_b16 v[88:89], v11 offset:16384
  v_mfma_f32_16x16x32_bf16 v[216:219], a[176:179], v[160:163], v[216:219]
  ds_read_b64_tr_b16 v[90:91], v11 offset:53248
  s_waitcnt vmcnt(10)
  v_mfma_f32_16x16x32_bf16 v[216:219], a[196:199], v[164:167], v[216:219]
  s_lshr_b32 s69, s67, 2
  ds_read_b64_tr_b16 v[92:93], v12 offset:16384
  s_lshl_b32 s69, s69, 12
  v_mfma_f32_16x16x32_bf16 v[212:215], a[192:195], v[164:167], v[212:215]
  s_add_u32 s68, s68, s69
  ds_read_b64_tr_b16 v[94:95], v12 offset:53248
  s_and_b32 s69, s67, 3
  v_mfma_f32_16x16x32_bf16 v[208:211], a[188:191], v[164:167], v[208:211]
  ds_read_b64_tr_b16 v[96:97], v13 offset:16384
  v_mfma_f32_16x16x32_bf16 v[204:207], a[184:187], v[164:167], v[204:207]
  ds_read_b64_tr_b16 v[98:99], v13 offset:53248
  v_mfma_f32_16x16x32_bf16 v[200:203], a[180:183], v[164:167], v[200:203]
  ds_read_b64_tr_b16 v[100:101], v14 offset:16384
  s_waitcnt vmcnt(9)
  v_mfma_f32_16x16x32_bf16 v[200:203], a[200:203], v[168:171], v[200:203]
  s_lshl_b32 s69, s69, 8
  ds_read_b64_tr_b16 v[102:103], v14 offset:53248
  s_add_u32 s68, s68, s69
  v_mfma_f32_16x16x32_bf16 v[204:207], a[204:207], v[168:171], v[204:207]
  s_add_u32 s77, s68, 65536
  ds_read_b64_tr_b16 v[104:105], v4 offset:16384
  s_lshl_b32 s68, s72, 10
  v_mfma_f32_16x16x32_bf16 v[208:211], a[208:211], v[168:171], v[208:211]
  ds_read_b64_tr_b16 v[106:107], v4 offset:16896
  v_mfma_f32_16x16x32_bf16 v[212:215], a[212:215], v[168:171], v[212:215]
  ds_read_b64_tr_b16 v[108:109], v11 offset:17408
  v_mfma_f32_16x16x32_bf16 v[216:219], a[216:219], v[168:171], v[216:219]
  ds_read_b64_tr_b16 v[110:111], v11 offset:54272
  s_waitcnt vmcnt(8) lgkmcnt(15)
  v_mfma_f32_16x16x32_bf16 v[216:219], a[236:239], v[172:175], v[216:219]
  s_lshl_b32 s69, s67, 7
  ds_read_b64_tr_b16 v[112:113], v12 offset:17408
  s_add_u32 s68, s68, s69
  v_mfma_f32_16x16x32_bf16 v[212:215], a[232:235], v[172:175], v[212:215]
  s_add_u32 s79, s68, 49283072
  ds_read_b64_tr_b16 v[114:115], v12 offset:54272
  s_lshl_b32 s68, s72, 6
  v_mfma_f32_16x16x32_bf16 v[208:211], a[228:231], v[172:175], v[208:211]
  ds_read_b64_tr_b16 v[116:117], v13 offset:17408
  v_mfma_f32_16x16x32_bf16 v[204:207], a[224:227], v[172:175], v[204:207]
  ds_read_b64_tr_b16 v[118:119], v13 offset:54272
  v_mfma_f32_16x16x32_bf16 v[200:203], a[220:223], v[172:175], v[200:203]
  ds_read_b64_tr_b16 v[120:121], v14 offset:17408
  s_waitcnt vmcnt(7)
  v_mfma_f32_16x16x32_bf16 v[200:203], a[240:243], v[176:179], v[200:203]
  s_add_u32 s68, s68, 53477376
  ds_read_b64_tr_b16 v[122:123], v14 offset:54272
  v_mfma_f32_16x16x32_bf16 v[204:207], a[244:247], v[176:179], v[204:207]
  s_cmp_eq_u32 s67, 0
  s_cselect_b32 s68, s68, 1073741824
  ds_read_b64_tr_b16 v[124:125], v4 offset:17408
  v_mfma_f32_16x16x32_bf16 v[208:211], a[248:251], v[176:179], v[208:211]
  s_lshl_b32 s69, s72, 7
  ds_read_b64_tr_b16 v[126:127], v4 offset:17920
  s_add_u32 s69, s69, 58730496
  v_mfma_f32_16x16x32_bf16 v[212:215], a[252:255], v[176:179], v[212:215]
  v_mfma_f32_16x16x32_bf16 v[216:219], v[24:27], v[176:179], v[216:219]
  s_waitcnt vmcnt(6)
  v_mfma_f32_16x16x32_bf16 v[216:219], v[44:47], v[180:183], v[216:219]
  s_add_u32 s70, s76, 4096
  v_lshl_add_u32 v18, v3, 28, v18
  v_cmp_gt_u32 vcc, 32, v1
  v_mfma_f32_16x16x32_bf16 v[212:215], v[40:43], v[180:183], v[212:215]
  s_mov_b32 s73, 0
  v_mfma_f32_16x16x32_bf16 v[208:211], v[36:39], v[180:183], v[208:211]
  v_mfma_f32_16x16x32_bf16 v[204:207], v[32:35], v[180:183], v[204:207]
  v_mfma_f32_16x16x32_bf16 v[200:203], v[28:31], v[180:183], v[200:203]
  s_waitcnt vmcnt(5)
  v_mfma_f32_16x16x32_bf16 v[200:203], v[48:51], v[184:187], v[200:203]
  v_lshrrev_b32 v10, 1, v1
  v_add_u32 v9, 1, v1
  v_mfma_f32_16x16x32_bf16 v[204:207], v[52:55], v[184:187], v[204:207]
  v_lshlrev_b32 v9, 14, v9
  v_lshl_add_u32 v9, v10, 26, v9
  v_mfma_f32_16x16x32_bf16 v[208:211], v[56:59], v[184:187], v[208:211]
  v_mfma_f32_16x16x32_bf16 v[212:215], v[60:63], v[184:187], v[212:215]
  v_mfma_f32_16x16x32_bf16 v[216:219], v[64:67], v[184:187], v[216:219]
  s_waitcnt vmcnt(4) lgkmcnt(15)
  v_mfma_f32_16x16x32_bf16 v[216:219], v[84:87], v[188:191], v[216:219]
  s_and_b32 s44, s64, 1
  s_lshl3_add_u32 s44, s44, s66
  s_lshl2_add_u32 s44, s44, s3
  v_mfma_f32_16x16x32_bf16 v[212:215], v[80:83], v[188:191], v[212:215]
  s_lshl_b32 s44, s44, 9
  v_mfma_f32_16x16x32_bf16 v[208:211], v[76:79], v[188:191], v[208:211]
  v_mfma_f32_16x16x32_bf16 v[204:207], v[72:75], v[188:191], v[204:207]
  v_mfma_f32_16x16x32_bf16 v[200:203], v[68:71], v[188:191], v[200:203]
  s_waitcnt vmcnt(2) lgkmcnt(10)
  v_mfma_f32_16x16x32_bf16 v[200:203], v[88:91], v[192:195], v[200:203]
  s_add_u32 s44, s44, 58746880
  v_lshlrev_b32 v5, 7, v1
  v_mov_b32 v6, 0
  v_mfma_f32_16x16x32_bf16 v[204:207], v[92:95], v[192:195], v[204:207]
  v_mov_b32 v7, 0
  v_mfma_f32_16x16x32_bf16 v[208:211], v[96:99], v[192:195], v[208:211]
  v_mfma_f32_16x16x32_bf16 v[212:215], v[100:103], v[192:195], v[212:215]
  v_mfma_f32_16x16x32_bf16 v[216:219], v[104:107], v[192:195], v[216:219]
  s_waitcnt vmcnt(0) lgkmcnt(0)
  v_mfma_f32_16x16x32_bf16 v[216:219], v[124:127], v[196:199], v[216:219]
  v_mfma_f32_16x16x32_bf16 v[200:203], v[108:111], v[196:199], v[200:203]
  v_mfma_f32_16x16x32_bf16 v[204:207], v[112:115], v[196:199], v[204:207]
  v_mfma_f32_16x16x32_bf16 v[208:211], v[116:119], v[196:199], v[208:211]
  v_mfma_f32_16x16x32_bf16 v[212:215], v[120:123], v[196:199], v[212:215]
  s_nop 3
  v_mov_b32 v21, v216
  v_mov_b32 v20, v216
  s_nop 1
  v_permlane32_swap_b32 v21, v20
  v_pk_add_f32 v[216:217], v[216:217], v[20:21] op_sel_hi:[1,0] neg_lo:[0,1] neg_hi:[0,1]
  v_pk_add_f32 v[218:219], v[218:219], v[20:21] op_sel_hi:[1,0] neg_lo:[0,1] neg_hi:[0,1]
  v_pk_add_f32 v[200:201], v[200:201], v[20:21] op_sel_hi:[1,0] neg_lo:[0,1] neg_hi:[0,1]
  v_pk_add_f32 v[202:203], v[202:203], v[20:21] op_sel_hi:[1,0] neg_lo:[0,1] neg_hi:[0,1]
  v_pk_add_f32 v[204:205], v[204:205], v[20:21] op_sel_hi:[1,0] neg_lo:[0,1] neg_hi:[0,1]
  v_pk_add_f32 v[206:207], v[206:207], v[20:21] op_sel_hi:[1,0] neg_lo:[0,1] neg_hi:[0,1]
  v_pk_add_f32 v[208:209], v[208:209], v[20:21] op_sel_hi:[1,0] neg_lo:[0,1] neg_hi:[0,1]
  v_pk_add_f32 v[210:211], v[210:211], v[20:21] op_sel_hi:[1,0] neg_lo:[0,1] neg_hi:[0,1]
  v_pk_add_f32 v[212:213], v[212:213], v[20:21] op_sel_hi:[1,0] neg_lo:[0,1] neg_hi:[0,1]
  v_pk_add_f32 v[214:215], v[214:215], v[20:21] op_sel_hi:[1,0] neg_lo:[0,1] neg_hi:[0,1]
  v_cvt_pk_bf16_f32 v220, v200, v201
  v_cvt_pk_bf16_f32 v221, v202, v203
  v_cvt_pk_bf16_f32 v222, v204, v205
  v_cvt_pk_bf16_f32 v223, v206, v207
  v_cvt_pk_bf16_f32 v224, v208, v209
  v_cvt_pk_bf16_f32 v225, v210, v211
  v_cvt_pk_bf16_f32 v226, v212, v213
  v_cvt_pk_bf16_f32 v227, v214, v215
  v_cvt_pk_bf16_f32 v228, v216, v217
  v_cvt_pk_bf16_f32 v229, v218, v219
  buffer_store_dwordx4 v[220:223], v252, s[28:31], s76 offen sc1
  buffer_store_dwordx4 v[224:227], v252, s[28:31], s70 offen sc1
  s_mov_b32 exec_hi, 0
  buffer_store_dwordx2 v[228:229], v253, s[28:31], s77 offen sc1
  s_mov_b64 exec, -1
  v_pk_mul_f32 v[22:23], v[216:217], v[216:217]
  v_pk_fma_f32 v[22:23], v[218:219], v[218:219], v[22:23]
  v_cndmask_b32 v22, 0, v22, vcc
  v_cndmask_b32 v23, 0, v23, vcc
  v_pk_fma_f32 v[22:23], v[200:201], v[200:201], v[22:23]
L_hop5:
  s_cbranch_execz L_main
  v_pk_fma_f32 v[22:23], v[202:203], v[202:203], v[22:23]
  v_pk_fma_f32 v[22:23], v[204:205], v[204:205], v[22:23]
  v_pk_fma_f32 v[22:23], v[206:207], v[206:207], v[22:23]
  v_pk_fma_f32 v[22:23], v[208:209], v[208:209], v[22:23]
  v_pk_fma_f32 v[22:23], v[210:211], v[210:211], v[22:23]
  v_pk_fma_f32 v[22:23], v[212:213], v[212:213], v[22:23]
  v_pk_fma_f32 v[22:23], v[214:215], v[214:215], v[22:23]
  v_add_f32 v22, v22, v23
  v_mov_b32 v23, v22
  s_nop 1
  v_permlane32_swap_b32 v22, v23
  v_add_f32 v22, v22, v23
  v_mov_b32 v23, v22
  s_nop 1
  v_permlane16_swap_b32 v22, v23
  v_add_f32 v22, v22, v23
  buffer_store_dword v20, v18, s[28:31], s68 offen sc1
  v_lshrrev_b32 v19, 1, v253
  s_mov_b32 exec_hi, 0
  buffer_store_dword v22, v19, s[28:31], s79 offen sc1
  s_mov_b64 exec, -1
  s_waitcnt vmcnt(2)
  buffer_atomic_add v17, v9, s[28:31], s69 offen offset:4 sc1
  s_barrier
  s_add_u32 s57, s32, 1769472
  s_add_u32 s58, s32, 2063360
  s_add_u32 s59, s32, 2357248
  s_add_u32 m0, s35, 36864
  s_nop 0
  buffer_load_dwordx4 v249, s[12:15], s57 offen offset:0  lds
  buffer_load_dwordx4 v249, s[12:15], s58 offen offset:1024  lds
  buffer_load_dwordx4 v249, s[12:15], s59 offen offset:2048  lds
  s_add_u32 m0, s35, 49152
  s_nop 0
  buffer_load_dwordx4 v249, s[16:19], s57 offen offset:0  lds
  buffer_load_dwordx4 v249, s[16:19], s58 offen offset:1024  lds
  buffer_load_dwordx4 v249, s[16:19], s59 offen offset:2048  lds
  ds_read_b64_tr_b16 v[164:165], v240 offset:12288
  ds_read_b64_tr_b16 v[166:167], v240 offset:18432
  ds_read_b64_tr_b16 v[168:169], v240 offset:24576
  ds_read_b64_tr_b16 v[170:171], v240 offset:30720
  ds_read_b64_tr_b16 v[172:173], v241 offset:12288
  ds_read_b64_tr_b16 v[174:175], v241 offset:18432
  s_mov_b32 s58, 0
  s_mov_b64 exec, 15
L_e3:
  buffer_atomic_add v6, v5, s[28:31], s44 offen offset:4 sc0 sc1
  s_add_u32 s58, s58, 1
  s_waitcnt vmcnt(0)
  v_cmp_gt_u32 vcc, 8, v6
  v_mov_b32 v6, 0
  s_cmp_gt_u32 s58, 100000
  s_cbranch_scc1 L_e3ok
  s_cbranch_vccnz L_e3
L_e3ok:
  s_mov_b64 exec, -1
  buffer_load_dwordx4 v[188:191], v252, s[28:31], s24 offen sc1
  buffer_load_dwordx4 v[192:195], v252, s[28:31], s25 offen sc1
  buffer_load_dwordx4 v[196:199], v252, s[28:31], s26 offen sc1
  buffer_load_dwordx4 v[200:203], v252, s[28:31], s27 offen sc1
  s_add_u32 s60, s24, 4096
  buffer_load_dwordx4 v[204:207], v252, s[28:31], s60 offen sc1
  s_add_u32 s60, s25, 4096
  buffer_load_dwordx4 v[208:211], v252, s[28:31], s60 offen sc1
  s_add_u32 s60, s26, 4096
  buffer_load_dwordx4 v[212:215], v252, s[28:31], s60 offen sc1
  s_add_u32 s60, s27, 4096
  buffer_load_dwordx4 v[216:219], v252, s[28:31], s60 offen sc1
  s_add_u32 s60, s24, 8192
  buffer_load_dwordx4 a[0:3], v252, s[28:31], s60 offen sc1
  s_add_u32 s60, s25, 8192
  buffer_load_dwordx4 a[4:7], v252, s[28:31], s60 offen sc1
  s_add_u32 s60, s26, 8192
  buffer_load_dwordx4 a[8:11], v252, s[28:31], s60 offen sc1
  s_add_u32 s60, s27, 8192
  buffer_load_dwordx4 a[12:15], v252, s[28:31], s60 offen sc1
  s_waitcnt lgkmcnt(0) vmcnt(8)
  s_add_u32 s60, s24, 12288
  v_mfma_f32_16x16x32_bf16 v[4:7], v[164:167], v[188:191], 0
  buffer_load_dwordx4 a[16:19], v252, s[28:31], s60 offen sc1
  v_mfma_f32_16x16x32_bf16 v[8:11], v[164:167], v[192:195], 0
  s_add_u32 s60, s25, 12288
  ds_read_b64_tr_b16 v[176:177], v241 offset:24576
  v_mfma_f32_16x16x32_bf16 v[12:15], v[164:167], v[196:199], 0
  ds_read_b64_tr_b16 v[178:179], v241 offset:30720
  v_mfma_f32_16x16x32_bf16 v[16:19], v[164:167], v[200:203], 0
  ds_read_b64_tr_b16 v[180:181], v242 offset:12288
  v_mfma_f32_16x16x32_bf16 v[32:35], v[168:171], v[200:203], 0
  buffer_load_dwordx4 a[20:23], v252, s[28:31], s60 offen sc1
  v_mfma_f32_16x16x32_bf16 v[28:31], v[168:171], v[196:199], 0
  s_add_u32 s60, s26, 12288
  ds_read_b64_tr_b16 v[182:183], v242 offset:18432
  v_mfma_f32_16x16x32_bf16 v[24:27], v[168:171], v[192:195], 0
  ds_read_b64_tr_b16 v[184:185], v242 offset:24576
  v_mfma_f32_16x16x32_bf16 v[20:23], v[168:171], v[188:191], 0
  ds_read_b64_tr_b16 v[186:187], v242 offset:30720
  v_mfma_f32_16x16x32_bf16 v[36:39], v[172:175], v[188:191], 0
  v_mfma_f32_16x16x32_bf16 v[40:43], v[172:175], v[192:195], 0
  buffer_load_dwordx4 a[24:27], v252, s[28:31], s60 offen sc1
  v_mfma_f32_16x16x32_bf16 v[44:47], v[172:175], v[196:199], 0
  s_add_u32 s60, s27, 12288
  v_mfma_f32_16x16x32_bf16 v[48:51], v[172:175], v[200:203], 0
  s_waitcnt lgkmcnt(0)
  v_mfma_f32_16x16x32_bf16 v[64:67], v[176:179], v[200:203], 0
  ds_read_b64_tr_b16 v[164:165], v243 offset:12288
  v_mfma_f32_16x16x32_bf16 v[60:63], v[176:179], v[196:199], 0
  ds_read_b64_tr_b16 v[166:167], v243 offset:18432
  v_mfma_f32_16x16x32_bf16 v[56:59], v[176:179], v[192:195], 0
  buffer_load_dwordx4 a[28:31], v252, s[28:31], s60 offen sc1
  v_mfma_f32_16x16x32_bf16 v[52:55], v[176:179], v[188:191], 0
  s_add_u32 s60, s24, 16384
  ds_read_b64_tr_b16 v[168:169], v243 offset:24576
  v_mfma_f32_16x16x32_bf16 v[68:71], v[180:183], v[188:191], 0
  ds_read_b64_tr_b16 v[170:171], v243 offset:30720
  v_mfma_f32_16x16x32_bf16 v[72:75], v[180:183], v[192:195], 0
  ds_read_b64_tr_b16 v[172:173], v240 offset:13312
  v_mfma_f32_16x16x32_bf16 v[76:79], v[180:183], v[196:199], 0
  ds_read_b64_tr_b16 v[174:175], v240 offset:19456
  v_mfma_f32_16x16x32_bf16 v[80:83], v[180:183], v[200:203], 0
  buffer_load_dwordx4 a[32:35], v252, s[28:31], s60 offen sc1
  v_mfma_f32_16x16x32_bf16 v[96:99], v[184:187], v[200:203], 0
  s_add_u32 s60, s25, 16384
  v_mfma_f32_16x16x32_bf16 v[92:95], v[184:187], v[196:199], 0
  v_mfma_f32_16x16x32_bf16 v[88:91], v[184:187], v[192:195], 0
  v_mfma_f32_16x16x32_bf16 v[84:87], v[184:187], v[188:191], 0
  s_waitcnt lgkmcnt(0) vmcnt(9)
  v_mfma_f32_16x16x32_bf16 v[100:103], v[164:167], v[188:191], 0
  buffer_load_dwordx4 a[36:39], v252, s[28:31], s60 offen sc1
  v_mfma_f32_16x16x32_bf16 v[104:107], v[164:167], v[192:195], 0
  s_add_u32 s60, s26, 16384
  ds_read_b64_tr_b16 v[176:177], v240 offset:25600
  v_mfma_f32_16x16x32_bf16 v[108:111], v[164:167], v[196:199], 0
  ds_read_b64_tr_b16 v[178:179], v240 offset:31744
  v_mfma_f32_16x16x32_bf16 v[112:115], v[164:167], v[200:203], 0
  ds_read_b64_tr_b16 v[180:181], v241 offset:13312
  v_mfma_f32_16x16x32_bf16 v[128:131], v[168:171], v[200:203], 0
  ds_read_b64_tr_b16 v[182:183], v241 offset:19456
  v_mfma_f32_16x16x32_bf16 v[124:127], v[168:171], v[196:199], 0
  buffer_load_dwordx4 a[40:43], v252, s[28:31], s60 offen sc1
  v_mfma_f32_16x16x32_bf16 v[120:123], v[168:171], v[192:195], 0
  s_add_u32 s60, s27, 16384
  ds_read_b64_tr_b16 v[184:185], v241 offset:25600
  v_mfma_f32_16x16x32_bf16 v[116:119], v[168:171], v[188:191], 0
  ds_read_b64_tr_b16 v[186:187], v241 offset:31744
  v_mfma_f32_16x16x32_bf16 v[4:7], v[172:175], v[204:207], v[4:7]
  v_mfma_f32_16x16x32_bf16 v[8:11], v[172:175], v[208:211], v[8:11]
  v_mfma_f32_16x16x32_bf16 v[12:15], v[172:175], v[212:215], v[12:15]
  buffer_load_dwordx4 a[44:47], v252, s[28:31], s60 offen sc1
  v_mfma_f32_16x16x32_bf16 v[16:19], v[172:175], v[216:219], v[16:19]
  s_waitcnt lgkmcnt(0)
  s_add_u32 s60, s24, 20480
  v_mfma_f32_16x16x32_bf16 v[32:35], v[176:179], v[216:219], v[32:35]
  ds_read_b64_tr_b16 v[164:165], v242 offset:13312
  v_mfma_f32_16x16x32_bf16 v[28:31], v[176:179], v[212:215], v[28:31]
  ds_read_b64_tr_b16 v[166:167], v242 offset:19456
  v_mfma_f32_16x16x32_bf16 v[24:27], v[176:179], v[208:211], v[24:27]
  ds_read_b64_tr_b16 v[168:169], v242 offset:25600
  v_mfma_f32_16x16x32_bf16 v[20:23], v[176:179], v[204:207], v[20:23]
  buffer_load_dwordx4 a[48:51], v252, s[28:31], s60 offen sc1
  v_mfma_f32_16x16x32_bf16 v[36:39], v[180:183], v[204:207], v[36:39]
  s_add_u32 s60, s25, 20480
  ds_read_b64_tr_b16 v[170:171], v242 offset:31744
  v_mfma_f32_16x16x32_bf16 v[40:43], v[180:183], v[208:211], v[40:43]
  ds_read_b64_tr_b16 v[172:173], v243 offset:13312
  v_mfma_f32_16x16x32_bf16 v[44:47], v[180:183], v[212:215], v[44:47]
  ds_read_b64_tr_b16 v[174:175], v243 offset:19456
  v_mfma_f32_16x16x32_bf16 v[48:51], v[180:183], v[216:219], v[48:51]
  v_mfma_f32_16x16x32_bf16 v[64:67], v[184:187], v[216:219], v[64:67]
  buffer_load_dwordx4 a[52:55], v252, s[28:31], s60 offen sc1
  v_mfma_f32_16x16x32_bf16 v[60:63], v[184:187], v[212:215], v[60:63]
  s_add_u32 s60, s26, 20480
  v_mfma_f32_16x16x32_bf16 v[56:59], v[184:187], v[208:211], v[56:59]
  v_mfma_f32_16x16x32_bf16 v[52:55], v[184:187], v[204:207], v[52:55]
  s_waitcnt lgkmcnt(0)
  v_mfma_f32_16x16x32_bf16 v[68:71], v[164:167], v[204:207], v[68:71]
  ds_read_b64_tr_b16 v[176:177], v243 offset:25600
  v_mfma_f32_16x16x32_bf16 v[72:75], v[164:167], v[208:211], v[72:75]
  buffer_load_dwordx4 a[56:59], v252, s[28:31], s60 offen sc1
  v_mfma_f32_16x16x32_bf16 v[76:79], v[164:167], v[212:215], v[76:79]
  s_add_u32 s60, s27, 20480
  ds_read_b64_tr_b16 v[178:179], v243 offset:31744
  v_mfma_f32_16x16x32_bf16 v[80:83], v[164:167], v[216:219], v[80:83]
  ds_read_b64_tr_b16 v[180:181], v240 offset:14336
  v_mfma_f32_16x16x32_bf16 v[96:99], v[168:171], v[216:219], v[96:99]
  ds_read_b64_tr_b16 v[182:183], v240 offset:20480
  v_mfma_f32_16x16x32_bf16 v[92:95], v[168:171], v[212:215], v[92:95]
  ds_read_b64_tr_b16 v[184:185], v240 offset:26624
  v_mfma_f32_16x16x32_bf16 v[88:91], v[168:171], v[208:211], v[88:91]
  buffer_load_dwordx4 a[60:63], v252, s[28:31], s60 offen sc1
  v_mfma_f32_16x16x32_bf16 v[84:87], v[168:171], v[204:207], v[84:87]
  s_add_u32 s57, s32, 2654208
  ds_read_b64_tr_b16 v[186:187], v240 offset:32768
  s_add_u32 s58, s32, 2948096
  v_mfma_f32_16x16x32_bf16 v[100:103], v[172:175], v[204:207], v[100:103]
  s_add_u32 s59, s32, 3241984
  s_add_u32 m0, s35, 61440
  v_mfma_f32_16x16x32_bf16 v[104:107], v[172:175], v[208:211], v[104:107]
  v_mfma_f32_16x16x32_bf16 v[108:111], v[172:175], v[212:215], v[108:111]
  v_mfma_f32_16x16x32_bf16 v[112:115], v[172:175], v[216:219], v[112:115]
  s_waitcnt lgkmcnt(0) vmcnt(12)
  v_mfma_f32_16x16x32_bf16 v[128:131], v[176:179], v[216:219], v[128:131]
  buffer_load_dwordx4 v249, s[12:15], s57 offen offset:0  lds
  v_mfma_f32_16x16x32_bf16 v[124:127], v[176:179], v[212:215], v[124:127]
  ds_read_b64_tr_b16 v[164:165], v241 offset:14336
  v_mfma_f32_16x16x32_bf16 v[120:123], v[176:179], v[208:211], v[120:123]
  ds_read_b64_tr_b16 v[166:167], v241 offset:20480
  v_mfma_f32_16x16x32_bf16 v[116:119], v[176:179], v[204:207], v[116:119]
  ds_read_b64_tr_b16 v[168:169], v241 offset:26624
  v_mfma_f32_16x16x32_bf16 v[4:7], v[180:183], a[0:3], v[4:7]
  buffer_load_dwordx4 v249, s[12:15], s58 offen offset:1024  lds
  v_mfma_f32_16x16x32_bf16 v[8:11], v[180:183], a[4:7], v[8:11]
  ds_read_b64_tr_b16 v[170:171], v241 offset:32768
  v_mfma_f32_16x16x32_bf16 v[12:15], v[180:183], a[8:11], v[12:15]
  ds_read_b64_tr_b16 v[172:173], v242 offset:14336
  v_mfma_f32_16x16x32_bf16 v[16:19], v[180:183], a[12:15], v[16:19]
  ds_read_b64_tr_b16 v[174:175], v242 offset:20480
  v_mfma_f32_16x16x32_bf16 v[32:35], v[184:187], a[12:15], v[32:35]
  v_mfma_f32_16x16x32_bf16 v[28:31], v[184:187], a[8:11], v[28:31]
  buffer_load_dwordx4 v249, s[12:15], s59 offen offset:2048  lds
  v_mfma_f32_16x16x32_bf16 v[24:27], v[184:187], a[4:7], v[24:27]
  s_add_u32 m0, s35, 73728
  v_mfma_f32_16x16x32_bf16 v[20:23], v[184:187], a[0:3], v[20:23]
  s_waitcnt lgkmcnt(0)
  v_mfma_f32_16x16x32_bf16 v[36:39], v[164:167], a[0:3], v[36:39]
  ds_read_b64_tr_b16 v[176:177], v242 offset:26624
  v_mfma_f32_16x16x32_bf16 v[40:43], v[164:167], a[4:7], v[40:43]
  ds_read_b64_tr_b16 v[178:179], v242 offset:32768
  v_mfma_f32_16x16x32_bf16 v[44:47], v[164:167], a[8:11], v[44:47]
  buffer_load_dwordx4 v249, s[16:19], s57 offen offset:0  lds
  v_mfma_f32_16x16x32_bf16 v[48:51], v[164:167], a[12:15], v[48:51]
  ds_read_b64_tr_b16 v[180:181], v243 offset:14336
  v_mfma_f32_16x16x32_bf16 v[64:67], v[168:171], a[12:15], v[64:67]
  ds_read_b64_tr_b16 v[182:183], v243 offset:20480
  v_mfma_f32_16x16x32_bf16 v[60:63], v[168:171], a[8:11], v[60:63]
  ds_read_b64_tr_b16 v[184:185], v243 offset:26624
  v_mfma_f32_16x16x32_bf16 v[56:59], v[168:171], a[4:7], v[56:59]
  ds_read_b64_tr_b16 v[186:187], v243 offset:32768
  v_mfma_f32_16x16x32_bf16 v[52:55], v[168:171], a[0:3], v[52:55]
  buffer_load_dwordx4 v249, s[16:19], s58 offen offset:1024  lds
  v_mfma_f32_16x16x32_bf16 v[68:71], v[172:175], a[0:3], v[68:71]
  v_mfma_f32_16x16x32_bf16 v[72:75], v[172:175], a[4:7], v[72:75]
  v_mfma_f32_16x16x32_bf16 v[76:79], v[172:175], a[8:11], v[76:79]
  v_mfma_f32_16x16x32_bf16 v[80:83], v[172:175], a[12:15], v[80:83]
  s_waitcnt lgkmcnt(0)
  v_mfma_f32_16x16x32_bf16 v[96:99], v[176:179], a[12:15], v[96:99]
  buffer_load_dwordx4 v249, s[16:19], s59 offen offset:2048  lds
  v_mfma_f32_16x16x32_bf16 v[92:95], v[176:179], a[8:11], v[92:95]
  s_add_u32 s60, s24, 24576
  ds_read_b64_tr_b16 v[164:165], v240 offset:36864
  v_mfma_f32_16x16x32_bf16 v[88:91], v[176:179], a[4:7], v[88:91]
  ds_read_b64_tr_b16 v[166:167], v240 offset:43008
  v_mfma_f32_16x16x32_bf16 v[84:87], v[176:179], a[0:3], v[84:87]
  ds_read_b64_tr_b16 v[168:169], v240 offset:37888
  v_mfma_f32_16x16x32_bf16 v[100:103], v[180:183], a[0:3], v[100:103]
  ds_read_b64_tr_b16 v[170:171], v240 offset:44032
  v_mfma_f32_16x16x32_bf16 v[104:107], v[180:183], a[4:7], v[104:107]
  buffer_load_dwordx4 a[64:67], v252, s[28:31], s60 offen sc1
  v_mfma_f32_16x16x32_bf16 v[108:111], v[180:183], a[8:11], v[108:111]
  s_add_u32 s60, s25, 24576
  ds_read_b64_tr_b16 v[172:173], v240 offset:38912
  v_mfma_f32_16x16x32_bf16 v[112:115], v[180:183], a[12:15], v[112:115]
  ds_read_b64_tr_b16 v[174:175], v240 offset:45056
  v_mfma_f32_16x16x32_bf16 v[128:131], v[184:187], a[12:15], v[128:131]
  v_mfma_f32_16x16x32_bf16 v[124:127], v[184:187], a[8:11], v[124:127]
  v_mfma_f32_16x16x32_bf16 v[120:123], v[184:187], a[4:7], v[120:123]
  buffer_load_dwordx4 a[68:71], v252, s[28:31], s60 offen sc1
  v_mfma_f32_16x16x32_bf16 v[116:119], v[184:187], a[0:3], v[116:119]
  s_waitcnt lgkmcnt(0) vmcnt(8)
  s_add_u32 s60, s26, 24576
  v_mfma_f32_16x16x32_bf16 v[4:7], v[164:167], a[16:19], v[4:7]
  ds_read_b64_tr_b16 v[176:177], v240 offset:49152
  v_mfma_f32_16x16x32_bf16 v[4:7], v[168:171], a[32:35], v[4:7]
  ds_read_b64_tr_b16 v[178:179], v240 offset:55296
  v_mfma_f32_16x16x32_bf16 v[4:7], v[172:175], a[48:51], v[4:7]
  ds_read_b64_tr_b16 v[180:181], v240 offset:50176
  v_mfma_f32_16x16x32_bf16 v[8:11], v[172:175], a[52:55], v[8:11]
  buffer_load_dwordx4 a[72:75], v252, s[28:31], s60 offen sc1
  v_mfma_f32_16x16x32_bf16 v[8:11], v[168:171], a[36:39], v[8:11]
  s_add_u32 s60, s27, 24576
  ds_read_b64_tr_b16 v[182:183], v240 offset:56320
  v_mfma_f32_16x16x32_bf16 v[8:11], v[164:167], a[20:23], v[8:11]
  ds_read_b64_tr_b16 v[184:185], v240 offset:51200
  v_mfma_f32_16x16x32_bf16 v[12:15], v[164:167], a[24:27], v[12:15]
  ds_read_b64_tr_b16 v[186:187], v240 offset:57344
  v_mfma_f32_16x16x32_bf16 v[12:15], v[168:171], a[40:43], v[12:15]
  v_mfma_f32_16x16x32_bf16 v[12:15], v[172:175], a[56:59], v[12:15]
  buffer_load_dwordx4 a[76:79], v252, s[28:31], s60 offen sc1
  v_mfma_f32_16x16x32_bf16 v[16:19], v[172:175], a[60:63], v[16:19]
  s_add_u32 s60, s24, 28672
  v_mfma_f32_16x16x32_bf16 v[16:19], v[168:171], a[44:47], v[16:19]
  v_mfma_f32_16x16x32_bf16 v[16:19], v[164:167], a[28:31], v[16:19]
  s_waitcnt lgkmcnt(0)
  v_mfma_f32_16x16x32_bf16 v[32:35], v[176:179], a[28:31], v[32:35]
  ds_read_b64_tr_b16 v[164:165], v241 offset:36864
  v_mfma_f32_16x16x32_bf16 v[32:35], v[180:183], a[44:47], v[32:35]
  buffer_load_dwordx4 a[80:83], v252, s[28:31], s60 offen sc1
  v_mfma_f32_16x16x32_bf16 v[32:35], v[184:187], a[60:63], v[32:35]
  s_add_u32 s60, s25, 28672
  ds_read_b64_tr_b16 v[166:167], v241 offset:43008
  v_mfma_f32_16x16x32_bf16 v[28:31], v[184:187], a[56:59], v[28:31]
  ds_read_b64_tr_b16 v[168:169], v241 offset:37888
  v_mfma_f32_16x16x32_bf16 v[28:31], v[180:183], a[40:43], v[28:31]
  ds_read_b64_tr_b16 v[170:171], v241 offset:44032
  v_mfma_f32_16x16x32_bf16 v[28:31], v[176:179], a[24:27], v[28:31]
  ds_read_b64_tr_b16 v[172:173], v241 offset:38912
  v_mfma_f32_16x16x32_bf16 v[24:27], v[176:179], a[20:23], v[24:27]
  buffer_load_dwordx4 a[84:87], v252, s[28:31], s60 offen sc1
  v_mfma_f32_16x16x32_bf16 v[24:27], v[180:183], a[36:39], v[24:27]
  s_add_u32 s60, s26, 28672
  ds_read_b64_tr_b16 v[174:175], v241 offset:45056
  v_mfma_f32_16x16x32_bf16 v[24:27], v[184:187], a[52:55], v[24:27]
  v_mfma_f32_16x16x32_bf16 v[20:23], v[184:187], a[48:51], v[20:23]
  v_mfma_f32_16x16x32_bf16 v[20:23], v[180:183], a[32:35], v[20:23]
  v_mfma_f32_16x16x32_bf16 v[20:23], v[176:179], a[16:19], v[20:23]
  s_waitcnt lgkmcnt(0)
  v_mfma_f32_16x16x32_bf16 v[36:39], v[164:167], a[16:19], v[36:39]
  buffer_load_dwordx4 a[88:91], v252, s[28:31], s60 offen sc1
  v_mfma_f32_16x16x32_bf16 v[36:39], v[168:171], a[32:35], v[36:39]
  s_add_u32 s60, s27, 28672
  ds_read_b64_tr_b16 v[176:177], v241 offset:49152
  v_mfma_f32_16x16x32_bf16 v[36:39], v[172:175], a[48:51], v[36:39]
  ds_read_b64_tr_b16 v[178:179], v241 offset:55296
  v_mfma_f32_16x16x32_bf16 v[40:43], v[172:175], a[52:55], v[40:43]
  ds_read_b64_tr_b16 v[180:181], v241 offset:50176
  v_mfma_f32_16x16x32_bf16 v[40:43], v[168:171], a[36:39], v[40:43]
  buffer_load_dwordx4 a[92:95], v252, s[28:31], s60 offen sc1
  v_mfma_f32_16x16x32_bf16 v[40:43], v[164:167], a[20:23], v[40:43]
  s_add_u32 s60, s24, 32768
  ds_read_b64_tr_b16 v[182:183], v241 offset:56320
  v_mfma_f32_16x16x32_bf16 v[44:47], v[164:167], a[24:27], v[44:47]
  ds_read_b64_tr_b16 v[184:185], v241 offset:51200
  v_mfma_f32_16x16x32_bf16 v[44:47], v[168:171], a[40:43], v[44:47]
  ds_read_b64_tr_b16 v[186:187], v241 offset:57344
  v_mfma_f32_16x16x32_bf16 v[44:47], v[172:175], a[56:59], v[44:47]
  v_mfma_f32_16x16x32_bf16 v[48:51], v[172:175], a[60:63], v[48:51]
  buffer_load_dwordx4 a[96:99], v252, s[28:31], s60 offen sc1
  v_mfma_f32_16x16x32_bf16 v[48:51], v[168:171], a[44:47], v[48:51]
  s_add_u32 s60, s25, 32768
  v_mfma_f32_16x16x32_bf16 v[48:51], v[164:167], a[28:31], v[48:51]
  s_waitcnt lgkmcnt(0)
  v_mfma_f32_16x16x32_bf16 v[64:67], v[176:179], a[28:31], v[64:67]
  ds_read_b64_tr_b16 v[164:165], v242 offset:36864
  v_mfma_f32_16x16x32_bf16 v[64:67], v[180:183], a[44:47], v[64:67]
  ds_read_b64_tr_b16 v[166:167], v242 offset:43008
  v_mfma_f32_16x16x32_bf16 v[64:67], v[184:187], a[60:63], v[64:67]
  buffer_load_dwordx4 a[100:103], v252, s[28:31], s60 offen sc1
  v_mfma_f32_16x16x32_bf16 v[60:63], v[184:187], a[56:59], v[60:63]
  s_add_u32 s60, s26, 32768
  ds_read_b64_tr_b16 v[168:169], v242 offset:37888
  v_mfma_f32_16x16x32_bf16 v[60:63], v[180:183], a[40:43], v[60:63]
  ds_read_b64_tr_b16 v[170:171], v242 offset:44032
  v_mfma_f32_16x16x32_bf16 v[60:63], v[176:179], a[24:27], v[60:63]
  ds_read_b64_tr_b16 v[172:173], v242 offset:38912
  v_mfma_f32_16x16x32_bf16 v[56:59], v[176:179], a[20:23], v[56:59]
  ds_read_b64_tr_b16 v[174:175], v242 offset:45056
  v_mfma_f32_16x16x32_bf16 v[56:59], v[180:183], a[36:39], v[56:59]
  buffer_load_dwordx4 a[104:107], v252, s[28:31], s60 offen sc1
  v_mfma_f32_16x16x32_bf16 v[56:59], v[184:187], a[52:55], v[56:59]
  s_add_u32 s60, s27, 32768
  v_mfma_f32_16x16x32_bf16 v[52:55], v[184:187], a[48:51], v[52:55]
  v_mfma_f32_16x16x32_bf16 v[52:55], v[180:183], a[32:35], v[52:55]
  v_mfma_f32_16x16x32_bf16 v[52:55], v[176:179], a[16:19], v[52:55]
  s_waitcnt lgkmcnt(0)
  v_mfma_f32_16x16x32_bf16 v[68:71], v[164:167], a[16:19], v[68:71]
  buffer_load_dwordx4 a[108:111], v252, s[28:31], s60 offen sc1
  v_mfma_f32_16x16x32_bf16 v[68:71], v[168:171], a[32:35], v[68:71]
  s_add_u32 s57, s32, 3538944
  ds_read_b64_tr_b16 v[176:177], v242 offset:49152
  s_add_u32 s58, s32, 3832832
  v_mfma_f32_16x16x32_bf16 v[68:71], v[172:175], a[48:51], v[68:71]
  s_add_u32 s59, s32, 4126720
  ds_read_b64_tr_b16 v[178:179], v242 offset:55296
  s_add_u32 m0, s35, 86016
  v_mfma_f32_16x16x32_bf16 v[72:75], v[172:175], a[52:55], v[72:75]
  ds_read_b64_tr_b16 v[180:181], v242 offset:50176
  v_mfma_f32_16x16x32_bf16 v[72:75], v[168:171], a[36:39], v[72:75]
  ds_read_b64_tr_b16 v[182:183], v242 offset:56320
  v_mfma_f32_16x16x32_bf16 v[72:75], v[164:167], a[20:23], v[72:75]
  buffer_load_dwordx4 v249, s[12:15], s57 offen offset:0  lds
  v_mfma_f32_16x16x32_bf16 v[76:79], v[164:167], a[24:27], v[76:79]
  ds_read_b64_tr_b16 v[184:185], v242 offset:51200
  v_mfma_f32_16x16x32_bf16 v[76:79], v[168:171], a[40:43], v[76:79]
  ds_read_b64_tr_b16 v[186:187], v242 offset:57344
  v_mfma_f32_16x16x32_bf16 v[76:79], v[172:175], a[56:59], v[76:79]
  v_mfma_f32_16x16x32_bf16 v[80:83], v[172:175], a[60:63], v[80:83]
  v_mfma_f32_16x16x32_bf16 v[80:83], v[168:171], a[44:47], v[80:83]
  buffer_load_dwordx4 v249, s[12:15], s58 offen offset:1024  lds
  v_mfma_f32_16x16x32_bf16 v[80:83], v[164:167], a[28:31], v[80:83]
  s_waitcnt lgkmcnt(0)
  v_mfma_f32_16x16x32_bf16 v[96:99], v[176:179], a[28:31], v[96:99]
  ds_read_b64_tr_b16 v[164:165], v243 offset:36864
  v_mfma_f32_16x16x32_bf16 v[96:99], v[180:183], a[44:47], v[96:99]
  ds_read_b64_tr_b16 v[166:167], v243 offset:43008
  v_mfma_f32_16x16x32_bf16 v[96:99], v[184:187], a[60:63], v[96:99]
  ds_read_b64_tr_b16 v[168:169], v243 offset:37888
  v_mfma_f32_16x16x32_bf16 v[92:95], v[184:187], a[56:59], v[92:95]
  buffer_load_dwordx4 v249, s[12:15], s59 offen offset:2048  lds
  v_mfma_f32_16x16x32_bf16 v[92:95], v[180:183], a[40:43], v[92:95]
  s_add_u32 m0, s35, 98304
  ds_read_b64_tr_b16 v[170:171], v243 offset:44032
  v_mfma_f32_16x16x32_bf16 v[92:95], v[176:179], a[24:27], v[92:95]
  ds_read_b64_tr_b16 v[172:173], v243 offset:38912
  v_mfma_f32_16x16x32_bf16 v[88:91], v[176:179], a[20:23], v[88:91]
  ds_read_b64_tr_b16 v[174:175], v243 offset:45056
  v_mfma_f32_16x16x32_bf16 v[88:91], v[180:183], a[36:39], v[88:91]
  v_mfma_f32_16x16x32_bf16 v[88:91], v[184:187], a[52:55], v[88:91]
  buffer_load_dwordx4 v249, s[16:19], s57 offen offset:0  lds
  v_mfma_f32_16x16x32_bf16 v[84:87], v[184:187], a[48:51], v[84:87]
  v_mfma_f32_16x16x32_bf16 v[84:87], v[180:183], a[32:35], v[84:87]
  v_mfma_f32_16x16x32_bf16 v[84:87], v[176:179], a[16:19], v[84:87]
  s_waitcnt lgkmcnt(0)
  v_mfma_f32_16x16x32_bf16 v[100:103], v[164:167], a[16:19], v[100:103]
  ds_read_b64_tr_b16 v[176:177], v243 offset:49152
  v_mfma_f32_16x16x32_bf16 v[100:103], v[168:171], a[32:35], v[100:103]
  buffer_load_dwordx4 v249, s[16:19], s58 offen offset:1024  lds
  v_mfma_f32_16x16x32_bf16 v[100:103], v[172:175], a[48:51], v[100:103]
  ds_read_b64_tr_b16 v[178:179], v243 offset:55296
  v_mfma_f32_16x16x32_bf16 v[104:107], v[172:175], a[52:55], v[104:107]
  ds_read_b64_tr_b16 v[180:181], v243 offset:50176
  v_mfma_f32_16x16x32_bf16 v[104:107], v[168:171], a[36:39], v[104:107]
  ds_read_b64_tr_b16 v[182:183], v243 offset:56320
  v_mfma_f32_16x16x32_bf16 v[104:107], v[164:167], a[20:23], v[104:107]
  ds_read_b64_tr_b16 v[184:185], v243 offset:51200
  v_mfma_f32_16x16x32_bf16 v[108:111], v[164:167], a[24:27], v[108:111]
  buffer_load_dwordx4 v249, s[16:19], s59 offen offset:2048  lds
  v_mfma_f32_16x16x32_bf16 v[108:111], v[168:171], a[40:43], v[108:111]
  s_add_u32 s60, s24, 36864
  ds_read_b64_tr_b16 v[186:187], v243 offset:57344
  v_mfma_f32_16x16x32_bf16 v[108:111], v[172:175], a[56:59], v[108:111]
  v_mfma_f32_16x16x32_bf16 v[112:115], v[172:175], a[60:63], v[112:115]
  v_mfma_f32_16x16x32_bf16 v[112:115], v[168:171], a[44:47], v[112:115]
  v_mfma_f32_16x16x32_bf16 v[112:115], v[164:167], a[28:31], v[112:115]
  s_waitcnt lgkmcnt(0) vmcnt(18)
  s_barrier
  v_mfma_f32_16x16x32_bf16 v[128:131], v[176:179], a[28:31], v[128:131]
  buffer_load_dwordx4 a[112:115], v252, s[28:31], s60 offen sc1
  v_mfma_f32_16x16x32_bf16 v[128:131], v[180:183], a[44:47], v[128:131]
  s_add_u32 s60, s25, 36864
  ds_read_b64_tr_b16 v[164:165], v236 offset:0
  v_mfma_f32_16x16x32_bf16 v[128:131], v[184:187], a[60:63], v[128:131]
  ds_read_b64_tr_b16 v[166:167], v236 offset:6144
  v_mfma_f32_16x16x32_bf16 v[124:127], v[184:187], a[56:59], v[124:127]
  ds_read_b64_tr_b16 v[168:169], v236 offset:1024
  v_mfma_f32_16x16x32_bf16 v[124:127], v[180:183], a[40:43], v[124:127]
  buffer_load_dwordx4 a[116:119], v252, s[28:31], s60 offen sc1
  v_mfma_f32_16x16x32_bf16 v[124:127], v[176:179], a[24:27], v[124:127]
  s_add_u32 s60, s26, 36864
  ds_read_b64_tr_b16 v[170:171], v236 offset:7168
  v_mfma_f32_16x16x32_bf16 v[120:123], v[176:179], a[20:23], v[120:123]
  ds_read_b64_tr_b16 v[172:173], v236 offset:2048
  v_mfma_f32_16x16x32_bf16 v[120:123], v[180:183], a[36:39], v[120:123]
  ds_read_b64_tr_b16 v[174:175], v236 offset:8192
  v_mfma_f32_16x16x32_bf16 v[120:123], v[184:187], a[52:55], v[120:123]
  v_mfma_f32_16x16x32_bf16 v[116:119], v[184:187], a[48:51], v[116:119]
  buffer_load_dwordx4 a[120:123], v252, s[28:31], s60 offen sc1
  v_mfma_f32_16x16x32_bf16 v[116:119], v[180:183], a[32:35], v[116:119]
  s_add_u32 s60, s27, 36864
  v_mfma_f32_16x16x32_bf16 v[116:119], v[176:179], a[16:19], v[116:119]
  s_waitcnt lgkmcnt(0) vmcnt(9)
  v_mfma_f32_16x16x32_bf16 v[4:7], v[164:167], a[64:67], v[4:7]
  ds_read_b64_tr_b16 v[176:177], v236 offset:12288
  v_mfma_f32_16x16x32_bf16 v[4:7], v[168:171], a[80:83], v[4:7]
  ds_read_b64_tr_b16 v[178:179], v236 offset:18432
  v_mfma_f32_16x16x32_bf16 v[4:7], v[172:175], a[96:99], v[4:7]
  buffer_load_dwordx4 a[124:127], v252, s[28:31], s60 offen sc1
  v_mfma_f32_16x16x32_bf16 v[8:11], v[172:175], a[100:103], v[8:11]
  s_add_u32 s60, s24, 40960
  ds_read_b64_tr_b16 v[180:181], v236 offset:13312
  v_mfma_f32_16x16x32_bf16 v[8:11], v[168:171], a[84:87], v[8:11]
  ds_read_b64_tr_b16 v[182:183], v236 offset:19456
  v_mfma_f32_16x16x32_bf16 v[8:11], v[164:167], a[68:71], v[8:11]
  ds_read_b64_tr_b16 v[184:185], v236 offset:14336
  v_mfma_f32_16x16x32_bf16 v[12:15], v[164:167], a[72:75], v[12:15]
  ds_read_b64_tr_b16 v[186:187], v236 offset:20480
  v_mfma_f32_16x16x32_bf16 v[12:15], v[168:171], a[88:91], v[12:15]
  buffer_load_dwordx4 a[128:131], v252, s[28:31], s60 offen sc1
  v_mfma_f32_16x16x32_bf16 v[12:15], v[172:175], a[104:107], v[12:15]
  s_add_u32 s60, s25, 40960
  v_mfma_f32_16x16x32_bf16 v[16:19], v[172:175], a[108:111], v[16:19]
  v_mfma_f32_16x16x32_bf16 v[16:19], v[168:171], a[92:95], v[16:19]
  v_mfma_f32_16x16x32_bf16 v[16:19], v[164:167], a[76:79], v[16:19]
  s_waitcnt lgkmcnt(0)
  v_mfma_f32_16x16x32_bf16 v[32:35], v[176:179], a[76:79], v[32:35]
  buffer_load_dwordx4 a[132:135], v252, s[28:31], s60 offen sc1
  v_mfma_f32_16x16x32_bf16 v[32:35], v[180:183], a[92:95], v[32:35]
  s_add_u32 s60, s26, 40960
  ds_read_b64_tr_b16 v[164:165], v237 offset:0
  v_mfma_f32_16x16x32_bf16 v[32:35], v[184:187], a[108:111], v[32:35]
  ds_read_b64_tr_b16 v[166:167], v237 offset:6144
  v_mfma_f32_16x16x32_bf16 v[28:31], v[184:187], a[104:107], v[28:31]
  ds_read_b64_tr_b16 v[168:169], v237 offset:1024
  v_mfma_f32_16x16x32_bf16 v[28:31], v[180:183], a[88:91], v[28:31]
  ds_read_b64_tr_b16 v[170:171], v237 offset:7168
  v_mfma_f32_16x16x32_bf16 v[28:31], v[176:179], a[72:75], v[28:31]
  buffer_load_dwordx4 a[136:139], v252, s[28:31], s60 offen sc1
  v_mfma_f32_16x16x32_bf16 v[24:27], v[176:179], a[68:71], v[24:27]
  s_add_u32 s60, s27, 40960
  ds_read_b64_tr_b16 v[172:173], v237 offset:2048
  v_mfma_f32_16x16x32_bf16 v[24:27], v[180:183], a[84:87], v[24:27]
  ds_read_b64_tr_b16 v[174:175], v237 offset:8192
  v_mfma_f32_16x16x32_bf16 v[24:27], v[184:187], a[100:103], v[24:27]
  v_mfma_f32_16x16x32_bf16 v[20:23], v[184:187], a[96:99], v[20:23]
  v_mfma_f32_16x16x32_bf16 v[20:23], v[180:183], a[80:83], v[20:23]
  buffer_load_dwordx4 a[140:143], v252, s[28:31], s60 offen sc1
  v_mfma_f32_16x16x32_bf16 v[20:23], v[176:179], a[64:67], v[20:23]
  s_waitcnt lgkmcnt(0)
  s_add_u32 s60, s24, 45056
  v_mfma_f32_16x16x32_bf16 v[36:39], v[164:167], a[64:67], v[36:39]
  ds_read_b64_tr_b16 v[176:177], v237 offset:12288
  v_mfma_f32_16x16x32_bf16 v[36:39], v[168:171], a[80:83], v[36:39]
  ds_read_b64_tr_b16 v[178:179], v237 offset:18432
  v_mfma_f32_16x16x32_bf16 v[36:39], v[172:175], a[96:99], v[36:39]
  ds_read_b64_tr_b16 v[180:181], v237 offset:13312
  v_mfma_f32_16x16x32_bf16 v[40:43], v[172:175], a[100:103], v[40:43]
  buffer_load_dwordx4 a[144:147], v252, s[28:31], s60 offen sc1
  v_mfma_f32_16x16x32_bf16 v[40:43], v[168:171], a[84:87], v[40:43]
  s_add_u32 s60, s25, 45056
  ds_read_b64_tr_b16 v[182:183], v237 offset:19456
  v_mfma_f32_16x16x32_bf16 v[40:43], v[164:167], a[68:71], v[40:43]
  ds_read_b64_tr_b16 v[184:185], v237 offset:14336
  v_mfma_f32_16x16x32_bf16 v[44:47], v[164:167], a[72:75], v[44:47]
  ds_read_b64_tr_b16 v[186:187], v237 offset:20480
  v_mfma_f32_16x16x32_bf16 v[44:47], v[168:171], a[88:91], v[44:47]
  v_mfma_f32_16x16x32_bf16 v[44:47], v[172:175], a[104:107], v[44:47]
  buffer_load_dwordx4 a[148:151], v252, s[28:31], s60 offen sc1
  v_mfma_f32_16x16x32_bf16 v[48:51], v[172:175], a[108:111], v[48:51]
  s_add_u32 s60, s26, 45056
  v_mfma_f32_16x16x32_bf16 v[48:51], v[168:171], a[92:95], v[48:51]
  v_mfma_f32_16x16x32_bf16 v[48:51], v[164:167], a[76:79], v[48:51]
  s_waitcnt lgkmcnt(0)
  v_mfma_f32_16x16x32_bf16 v[64:67], v[176:179], a[76:79], v[64:67]
  ds_read_b64_tr_b16 v[164:165], v238 offset:0
  v_mfma_f32_16x16x32_bf16 v[64:67], v[180:183], a[92:95], v[64:67]
  buffer_load_dwordx4 a[152:155], v252, s[28:31], s60 offen sc1
  v_mfma_f32_16x16x32_bf16 v[64:67], v[184:187], a[108:111], v[64:67]
  s_add_u32 s60, s27, 45056
  ds_read_b64_tr_b16 v[166:167], v238 offset:6144
L_hop6:
  s_cbranch_execz L_main
  v_mfma_f32_16x16x32_bf16 v[60:63], v[184:187], a[104:107], v[60:63]
  ds_read_b64_tr_b16 v[168:169], v238 offset:1024
  v_mfma_f32_16x16x32_bf16 v[60:63], v[180:183], a[88:91], v[60:63]
  ds_read_b64_tr_b16 v[170:171], v238 offset:7168
  v_mfma_f32_16x16x32_bf16 v[60:63], v[176:179], a[72:75], v[60:63]
  ds_read_b64_tr_b16 v[172:173], v238 offset:2048
  v_mfma_f32_16x16x32_bf16 v[56:59], v[176:179], a[68:71], v[56:59]
  buffer_load_dwordx4 a[156:159], v252, s[28:31], s60 offen sc1
  v_mfma_f32_16x16x32_bf16 v[56:59], v[180:183], a[84:87], v[56:59]
  s_add_u32 s57, s32, 4423680
  ds_read_b64_tr_b16 v[174:175], v238 offset:8192
  s_add_u32 s58, s32, 4717568
  v_mfma_f32_16x16x32_bf16 v[56:59], v[184:187], a[100:103], v[56:59]
  s_add_u32 s59, s32, 5011456
  s_add_u32 m0, s35, 110592
  v_mfma_f32_16x16x32_bf16 v[52:55], v[184:187], a[96:99], v[52:55]
  v_mfma_f32_16x16x32_bf16 v[52:55], v[180:183], a[80:83], v[52:55]
  v_mfma_f32_16x16x32_bf16 v[52:55], v[176:179], a[64:67], v[52:55]
  s_waitcnt lgkmcnt(0)
  v_mfma_f32_16x16x32_bf16 v[68:71], v[164:167], a[64:67], v[68:71]
  buffer_load_dwordx4 v249, s[12:15], s57 offen offset:0  lds
  v_mfma_f32_16x16x32_bf16 v[68:71], v[168:171], a[80:83], v[68:71]
  ds_read_b64_tr_b16 v[176:177], v238 offset:12288
  v_mfma_f32_16x16x32_bf16 v[68:71], v[172:175], a[96:99], v[68:71]
  ds_read_b64_tr_b16 v[178:179], v238 offset:18432
  v_mfma_f32_16x16x32_bf16 v[72:75], v[172:175], a[100:103], v[72:75]
  ds_read_b64_tr_b16 v[180:181], v238 offset:13312
  v_mfma_f32_16x16x32_bf16 v[72:75], v[168:171], a[84:87], v[72:75]
  buffer_load_dwordx4 v249, s[12:15], s58 offen offset:1024  lds
  v_mfma_f32_16x16x32_bf16 v[72:75], v[164:167], a[68:71], v[72:75]
  ds_read_b64_tr_b16 v[182:183], v238 offset:19456
  v_mfma_f32_16x16x32_bf16 v[76:79], v[164:167], a[72:75], v[76:79]
  ds_read_b64_tr_b16 v[184:185], v238 offset:14336
  v_mfma_f32_16x16x32_bf16 v[76:79], v[168:171], a[88:91], v[76:79]
  ds_read_b64_tr_b16 v[186:187], v238 offset:20480
  v_mfma_f32_16x16x32_bf16 v[76:79], v[172:175], a[104:107], v[76:79]
  v_mfma_f32_16x16x32_bf16 v[80:83], v[172:175], a[108:111], v[80:83]
  buffer_load_dwordx4 v249, s[12:15], s59 offen offset:2048  lds
  v_mfma_f32_16x16x32_bf16 v[80:83], v[168:171], a[92:95], v[80:83]
  s_add_u32 m0, s35, 122880
  v_mfma_f32_16x16x32_bf16 v[80:83], v[164:167], a[76:79], v[80:83]
  s_waitcnt lgkmcnt(0)
  v_mfma_f32_16x16x32_bf16 v[96:99], v[176:179], a[76:79], v[96:99]
  ds_read_b64_tr_b16 v[164:165], v239 offset:0
  v_mfma_f32_16x16x32_bf16 v[96:99], v[180:183], a[92:95], v[96:99]
  ds_read_b64_tr_b16 v[166:167], v239 offset:6144
  v_mfma_f32_16x16x32_bf16 v[96:99], v[184:187], a[108:111], v[96:99]
  buffer_load_dwordx4 v249, s[16:19], s57 offen offset:0  lds
  v_mfma_f32_16x16x32_bf16 v[92:95], v[184:187], a[104:107], v[92:95]
  ds_read_b64_tr_b16 v[168:169], v239 offset:1024
  v_mfma_f32_16x16x32_bf16 v[92:95], v[180:183], a[88:91], v[92:95]
  ds_read_b64_tr_b16 v[170:171], v239 offset:7168
  v_mfma_f32_16x16x32_bf16 v[92:95], v[176:179], a[72:75], v[92:95]
  ds_read_b64_tr_b16 v[172:173], v239 offset:2048
  v_mfma_f32_16x16x32_bf16 v[88:91], v[176:179], a[68:71], v[88:91]
  ds_read_b64_tr_b16 v[174:175], v239 offset:8192
  v_mfma_f32_16x16x32_bf16 v[88:91], v[180:183], a[84:87], v[88:91]
  buffer_load_dwordx4 v249, s[16:19], s58 offen offset:1024  lds
  v_mfma_f32_16x16x32_bf16 v[88:91], v[184:187], a[100:103], v[88:91]
  v_mfma_f32_16x16x32_bf16 v[84:87], v[184:187], a[96:99], v[84:87]
  v_mfma_f32_16x16x32_bf16 v[84:87], v[180:183], a[80:83], v[84:87]
  v_mfma_f32_16x16x32_bf16 v[84:87], v[176:179], a[64:67], v[84:87]
  s_waitcnt lgkmcnt(0)
  v_mfma_f32_16x16x32_bf16 v[100:103], v[164:167], a[64:67], v[100:103]
  buffer_load_dwordx4 v249, s[16:19], s59 offen offset:2048  lds
  v_mfma_f32_16x16x32_bf16 v[100:103], v[168:171], a[80:83], v[100:103]
  s_add_u32 s60, s24, 49152
  ds_read_b64_tr_b16 v[176:177], v239 offset:12288
  v_mfma_f32_16x16x32_bf16 v[100:103], v[172:175], a[96:99], v[100:103]
  ds_read_b64_tr_b16 v[178:179], v239 offset:18432
  v_mfma_f32_16x16x32_bf16 v[104:107], v[172:175], a[100:103], v[104:107]
  ds_read_b64_tr_b16 v[180:181], v239 offset:13312
  v_mfma_f32_16x16x32_bf16 v[104:107], v[168:171], a[84:87], v[104:107]
  ds_read_b64_tr_b16 v[182:183], v239 offset:19456
  v_mfma_f32_16x16x32_bf16 v[104:107], v[164:167], a[68:71], v[104:107]
  buffer_load_dwordx4 a[160:163], v252, s[28:31], s60 offen sc1
  v_mfma_f32_16x16x32_bf16 v[108:111], v[164:167], a[72:75], v[108:111]
  s_add_u32 s60, s25, 49152
  ds_read_b64_tr_b16 v[184:185], v239 offset:14336
  v_mfma_f32_16x16x32_bf16 v[108:111], v[168:171], a[88:91], v[108:111]
  ds_read_b64_tr_b16 v[186:187], v239 offset:20480
  v_mfma_f32_16x16x32_bf16 v[108:111], v[172:175], a[104:107], v[108:111]
  v_mfma_f32_16x16x32_bf16 v[112:115], v[172:175], a[108:111], v[112:115]
  v_mfma_f32_16x16x32_bf16 v[112:115], v[168:171], a[92:95], v[112:115]
  buffer_load_dwordx4 a[164:167], v252, s[28:31], s60 offen sc1
  v_mfma_f32_16x16x32_bf16 v[112:115], v[164:167], a[76:79], v[112:115]
  s_waitcnt lgkmcnt(0)
  s_add_u32 s60, s26, 49152
  v_mfma_f32_16x16x32_bf16 v[128:131], v[176:179], a[76:79], v[128:131]
  ds_read_b64_tr_b16 v[164:165], v236 offset:24576
  v_mfma_f32_16x16x32_bf16 v[128:131], v[180:183], a[92:95], v[128:131]
  ds_read_b64_tr_b16 v[166:167], v236 offset:30720
  v_mfma_f32_16x16x32_bf16 v[128:131], v[184:187], a[108:111], v[128:131]
  ds_read_b64_tr_b16 v[168:169], v236 offset:25600
  v_mfma_f32_16x16x32_bf16 v[124:127], v[184:187], a[104:107], v[124:127]
  buffer_load_dwordx4 a[168:171], v252, s[28:31], s60 offen sc1
  v_mfma_f32_16x16x32_bf16 v[124:127], v[180:183], a[88:91], v[124:127]
  s_add_u32 s60, s27, 49152
  ds_read_b64_tr_b16 v[170:171], v236 offset:31744
  v_mfma_f32_16x16x32_bf16 v[124:127], v[176:179], a[72:75], v[124:127]
  ds_read_b64_tr_b16 v[172:173], v236 offset:26624
  v_mfma_f32_16x16x32_bf16 v[120:123], v[176:179], a[68:71], v[120:123]
  ds_read_b64_tr_b16 v[174:175], v236 offset:32768
  v_mfma_f32_16x16x32_bf16 v[120:123], v[180:183], a[84:87], v[120:123]
  v_mfma_f32_16x16x32_bf16 v[120:123], v[184:187], a[100:103], v[120:123]
  buffer_load_dwordx4 a[172:175], v252, s[28:31], s60 offen sc1
  v_mfma_f32_16x16x32_bf16 v[116:119], v[184:187], a[96:99], v[116:119]
  s_add_u32 s60, s24, 53248
  v_mfma_f32_16x16x32_bf16 v[116:119], v[180:183], a[80:83], v[116:119]
  v_mfma_f32_16x16x32_bf16 v[116:119], v[176:179], a[64:67], v[116:119]
  s_waitcnt lgkmcnt(0) vmcnt(10)
  v_mfma_f32_16x16x32_bf16 v[4:7], v[164:167], a[112:115], v[4:7]
  ds_read_b64_tr_b16 v[176:177], v236 offset:36864
  v_mfma_f32_16x16x32_bf16 v[4:7], v[168:171], a[128:131], v[4:7]
  buffer_load_dwordx4 a[176:179], v252, s[28:31], s60 offen sc1
  v_mfma_f32_16x16x32_bf16 v[4:7], v[172:175], a[144:147], v[4:7]
  s_add_u32 s60, s25, 53248
  ds_read_b64_tr_b16 v[178:179], v236 offset:43008
  v_mfma_f32_16x16x32_bf16 v[8:11], v[172:175], a[148:151], v[8:11]
  ds_read_b64_tr_b16 v[180:181], v236 offset:37888
  v_mfma_f32_16x16x32_bf16 v[8:11], v[168:171], a[132:135], v[8:11]
  ds_read_b64_tr_b16 v[182:183], v236 offset:44032
  v_mfma_f32_16x16x32_bf16 v[8:11], v[164:167], a[116:119], v[8:11]
  ds_read_b64_tr_b16 v[184:185], v236 offset:38912
  v_mfma_f32_16x16x32_bf16 v[12:15], v[164:167], a[120:123], v[12:15]
  buffer_load_dwordx4 a[180:183], v252, s[28:31], s60 offen sc1
  v_mfma_f32_16x16x32_bf16 v[12:15], v[168:171], a[136:139], v[12:15]
  s_add_u32 s60, s26, 53248
  ds_read_b64_tr_b16 v[186:187], v236 offset:45056
  v_mfma_f32_16x16x32_bf16 v[12:15], v[172:175], a[152:155], v[12:15]
  v_mfma_f32_16x16x32_bf16 v[16:19], v[172:175], a[156:159], v[16:19]
  v_mfma_f32_16x16x32_bf16 v[16:19], v[168:171], a[140:143], v[16:19]
  v_mfma_f32_16x16x32_bf16 v[16:19], v[164:167], a[124:127], v[16:19]
  s_waitcnt lgkmcnt(0)
  v_mfma_f32_16x16x32_bf16 v[32:35], v[176:179], a[124:127], v[32:35]
  buffer_load_dwordx4 a[184:187], v252, s[28:31], s60 offen sc1
  v_mfma_f32_16x16x32_bf16 v[32:35], v[180:183], a[140:143], v[32:35]
  s_add_u32 s60, s27, 53248
  ds_read_b64_tr_b16 v[164:165], v237 offset:24576
  v_mfma_f32_16x16x32_bf16 v[32:35], v[184:187], a[156:159], v[32:35]
  ds_read_b64_tr_b16 v[166:167], v237 offset:30720
  v_mfma_f32_16x16x32_bf16 v[28:31], v[184:187], a[152:155], v[28:31]
  ds_read_b64_tr_b16 v[168:169], v237 offset:25600
  v_mfma_f32_16x16x32_bf16 v[28:31], v[180:183], a[136:139], v[28:31]
  buffer_load_dwordx4 a[188:191], v252, s[28:31], s60 offen sc1
  v_mfma_f32_16x16x32_bf16 v[28:31], v[176:179], a[120:123], v[28:31]
  s_add_u32 s60, s24, 57344
  ds_read_b64_tr_b16 v[170:171], v237 offset:31744
  v_mfma_f32_16x16x32_bf16 v[24:27], v[176:179], a[116:119], v[24:27]
  ds_read_b64_tr_b16 v[172:173], v237 offset:26624
  v_mfma_f32_16x16x32_bf16 v[24:27], v[180:183], a[132:135], v[24:27]
  ds_read_b64_tr_b16 v[174:175], v237 offset:32768
  v_mfma_f32_16x16x32_bf16 v[24:27], v[184:187], a[148:151], v[24:27]
  v_mfma_f32_16x16x32_bf16 v[20:23], v[184:187], a[144:147], v[20:23]
  buffer_load_dwordx4 a[192:195], v252, s[28:31], s60 offen sc1
  v_mfma_f32_16x16x32_bf16 v[20:23], v[180:183], a[128:131], v[20:23]
  s_add_u32 s60, s25, 57344
  v_mfma_f32_16x16x32_bf16 v[20:23], v[176:179], a[112:115], v[20:23]
  s_waitcnt lgkmcnt(0)
  v_mfma_f32_16x16x32_bf16 v[36:39], v[164:167], a[112:115], v[36:39]
  ds_read_b64_tr_b16 v[176:177], v237 offset:36864
  v_mfma_f32_16x16x32_bf16 v[36:39], v[168:171], a[128:131], v[36:39]
  ds_read_b64_tr_b16 v[178:179], v237 offset:43008
  v_mfma_f32_16x16x32_bf16 v[36:39], v[172:175], a[144:147], v[36:39]
  buffer_load_dwordx4 a[196:199], v252, s[28:31], s60 offen sc1
  v_mfma_f32_16x16x32_bf16 v[40:43], v[172:175], a[148:151], v[40:43]
  s_add_u32 s60, s26, 57344
  ds_read_b64_tr_b16 v[180:181], v237 offset:37888
  v_mfma_f32_16x16x32_bf16 v[40:43], v[168:171], a[132:135], v[40:43]
  ds_read_b64_tr_b16 v[182:183], v237 offset:44032
  v_mfma_f32_16x16x32_bf16 v[40:43], v[164:167], a[116:119], v[40:43]
  ds_read_b64_tr_b16 v[184:185], v237 offset:38912
  v_mfma_f32_16x16x32_bf16 v[44:47], v[164:167], a[120:123], v[44:47]
  ds_read_b64_tr_b16 v[186:187], v237 offset:45056
  v_mfma_f32_16x16x32_bf16 v[44:47], v[168:171], a[136:139], v[44:47]
  buffer_load_dwordx4 a[200:203], v252, s[28:31], s60 offen sc1
  v_mfma_f32_16x16x32_bf16 v[44:47], v[172:175], a[152:155], v[44:47]
  s_add_u32 s60, s27, 57344
  v_mfma_f32_16x16x32_bf16 v[48:51], v[172:175], a[156:159], v[48:51]
  v_mfma_f32_16x16x32_bf16 v[48:51], v[168:171], a[140:143], v[48:51]
  v_mfma_f32_16x16x32_bf16 v[48:51], v[164:167], a[124:127], v[48:51]
  s_waitcnt lgkmcnt(0)
  v_mfma_f32_16x16x32_bf16 v[64:67], v[176:179], a[124:127], v[64:67]
  buffer_load_dwordx4 a[204:207], v252, s[28:31], s60 offen sc1
  v_mfma_f32_16x16x32_bf16 v[64:67], v[180:183], a[140:143], v[64:67]
  s_add_u32 s60, s24, 61440
  ds_read_b64_tr_b16 v[164:165], v238 offset:24576
  v_mfma_f32_16x16x32_bf16 v[64:67], v[184:187], a[156:159], v[64:67]
  ds_read_b64_tr_b16 v[166:167], v238 offset:30720
  v_mfma_f32_16x16x32_bf16 v[60:63], v[184:187], a[152:155], v[60:63]
  ds_read_b64_tr_b16 v[168:169], v238 offset:25600
  v_mfma_f32_16x16x32_bf16 v[60:63], v[180:183], a[136:139], v[60:63]
  ds_read_b64_tr_b16 v[170:171], v238 offset:31744
  v_mfma_f32_16x16x32_bf16 v[60:63], v[176:179], a[120:123], v[60:63]
  buffer_load_dwordx4 a[208:211], v252, s[28:31], s60 offen sc1
  v_mfma_f32_16x16x32_bf16 v[56:59], v[176:179], a[116:119], v[56:59]
  s_add_u32 s60, s25, 61440
  ds_read_b64_tr_b16 v[172:173], v238 offset:26624
  v_mfma_f32_16x16x32_bf16 v[56:59], v[180:183], a[132:135], v[56:59]
  ds_read_b64_tr_b16 v[174:175], v238 offset:32768
  v_mfma_f32_16x16x32_bf16 v[56:59], v[184:187], a[148:151], v[56:59]
  v_mfma_f32_16x16x32_bf16 v[52:55], v[184:187], a[144:147], v[52:55]
  v_mfma_f32_16x16x32_bf16 v[52:55], v[180:183], a[128:131], v[52:55]
  buffer_load_dwordx4 a[212:215], v252, s[28:31], s60 offen sc1
  v_mfma_f32_16x16x32_bf16 v[52:55], v[176:179], a[112:115], v[52:55]
  s_waitcnt lgkmcnt(0)
  s_add_u32 s60, s26, 61440
  v_mfma_f32_16x16x32_bf16 v[68:71], v[164:167], a[112:115], v[68:71]
  ds_read_b64_tr_b16 v[176:177], v238 offset:36864
  v_mfma_f32_16x16x32_bf16 v[68:71], v[168:171], a[128:131], v[68:71]
  ds_read_b64_tr_b16 v[178:179], v238 offset:43008
  v_mfma_f32_16x16x32_bf16 v[68:71], v[172:175], a[144:147], v[68:71]
  ds_read_b64_tr_b16 v[180:181], v238 offset:37888
  v_mfma_f32_16x16x32_bf16 v[72:75], v[172:175], a[148:151], v[72:75]
  buffer_load_dwordx4 a[216:219], v252, s[28:31], s60 offen sc1
  v_mfma_f32_16x16x32_bf16 v[72:75], v[168:171], a[132:135], v[72:75]
  s_add_u32 s60, s27, 61440
  ds_read_b64_tr_b16 v[182:183], v238 offset:44032
  v_mfma_f32_16x16x32_bf16 v[72:75], v[164:167], a[116:119], v[72:75]
  ds_read_b64_tr_b16 v[184:185], v238 offset:38912
  v_mfma_f32_16x16x32_bf16 v[76:79], v[164:167], a[120:123], v[76:79]
  ds_read_b64_tr_b16 v[186:187], v238 offset:45056
  v_mfma_f32_16x16x32_bf16 v[76:79], v[168:171], a[136:139], v[76:79]
  v_mfma_f32_16x16x32_bf16 v[76:79], v[172:175], a[152:155], v[76:79]
  buffer_load_dwordx4 a[220:223], v252, s[28:31], s60 offen sc1
  v_mfma_f32_16x16x32_bf16 v[80:83], v[172:175], a[156:159], v[80:83]
  s_add_u32 s60, s24, 65536
  v_mfma_f32_16x16x32_bf16 v[80:83], v[168:171], a[140:143], v[80:83]
  v_mfma_f32_16x16x32_bf16 v[80:83], v[164:167], a[124:127], v[80:83]
  s_waitcnt lgkmcnt(0)
  v_mfma_f32_16x16x32_bf16 v[96:99], v[176:179], a[124:127], v[96:99]
  ds_read_b64_tr_b16 v[164:165], v239 offset:24576
  v_mfma_f32_16x16x32_bf16 v[96:99], v[180:183], a[140:143], v[96:99]
  buffer_load_dwordx2 a[224:225], v253, s[28:31], s60 offen offset:0 sc1
  v_mfma_f32_16x16x32_bf16 v[96:99], v[184:187], a[156:159], v[96:99]
  ds_read_b64_tr_b16 v[166:167], v239 offset:30720
  v_mfma_f32_16x16x32_bf16 v[92:95], v[184:187], a[152:155], v[92:95]
  ds_read_b64_tr_b16 v[168:169], v239 offset:25600
  v_mfma_f32_16x16x32_bf16 v[92:95], v[180:183], a[136:139], v[92:95]
  ds_read_b64_tr_b16 v[170:171], v239 offset:31744
  v_mfma_f32_16x16x32_bf16 v[92:95], v[176:179], a[120:123], v[92:95]
  buffer_load_dwordx2 a[226:227], v253, s[28:31], s60 offen offset:512 sc1
  v_mfma_f32_16x16x32_bf16 v[88:91], v[176:179], a[116:119], v[88:91]
  s_add_u32 s60, s25, 65536
  ds_read_b64_tr_b16 v[172:173], v239 offset:26624
  v_mfma_f32_16x16x32_bf16 v[88:91], v[180:183], a[132:135], v[88:91]
  ds_read_b64_tr_b16 v[174:175], v239 offset:32768
  v_mfma_f32_16x16x32_bf16 v[88:91], v[184:187], a[148:151], v[88:91]
  v_mfma_f32_16x16x32_bf16 v[84:87], v[184:187], a[144:147], v[84:87]
  buffer_load_dwordx2 a[228:229], v253, s[28:31], s60 offen offset:0 sc1
  v_mfma_f32_16x16x32_bf16 v[84:87], v[180:183], a[128:131], v[84:87]
  v_mfma_f32_16x16x32_bf16 v[84:87], v[176:179], a[112:115], v[84:87]
  s_waitcnt lgkmcnt(0)
  v_mfma_f32_16x16x32_bf16 v[100:103], v[164:167], a[112:115], v[100:103]
  ds_read_b64_tr_b16 v[176:177], v239 offset:36864
  v_mfma_f32_16x16x32_bf16 v[100:103], v[168:171], a[128:131], v[100:103]
  buffer_load_dwordx2 a[230:231], v253, s[28:31], s60 offen offset:512 sc1
  v_mfma_f32_16x16x32_bf16 v[100:103], v[172:175], a[144:147], v[100:103]
  s_add_u32 s60, s26, 65536
  ds_read_b64_tr_b16 v[178:179], v239 offset:43008
  v_mfma_f32_16x16x32_bf16 v[104:107], v[172:175], a[148:151], v[104:107]
  ds_read_b64_tr_b16 v[180:181], v239 offset:37888
  v_mfma_f32_16x16x32_bf16 v[104:107], v[168:171], a[132:135], v[104:107]
  ds_read_b64_tr_b16 v[182:183], v239 offset:44032
  v_mfma_f32_16x16x32_bf16 v[104:107], v[164:167], a[116:119], v[104:107]
  buffer_load_dwordx2 a[232:233], v253, s[28:31], s60 offen offset:0 sc1
  v_mfma_f32_16x16x32_bf16 v[108:111], v[164:167], a[120:123], v[108:111]
  ds_read_b64_tr_b16 v[184:185], v239 offset:38912
  v_mfma_f32_16x16x32_bf16 v[108:111], v[168:171], a[136:139], v[108:111]
  ds_read_b64_tr_b16 v[186:187], v239 offset:45056
  v_mfma_f32_16x16x32_bf16 v[108:111], v[172:175], a[152:155], v[108:111]
  v_mfma_f32_16x16x32_bf16 v[112:115], v[172:175], a[156:159], v[112:115]
  buffer_load_dwordx2 a[234:235], v253, s[28:31], s60 offen offset:512 sc1
  v_mfma_f32_16x16x32_bf16 v[112:115], v[168:171], a[140:143], v[112:115]
  s_add_u32 s60, s27, 65536
  v_mfma_f32_16x16x32_bf16 v[112:115], v[164:167], a[124:127], v[112:115]
  s_waitcnt lgkmcnt(0) vmcnt(22)
  s_barrier
  v_mfma_f32_16x16x32_bf16 v[128:131], v[176:179], a[124:127], v[128:131]
  ds_read_b64_tr_b16 v[164:165], v236 offset:49152
  v_mfma_f32_16x16x32_bf16 v[128:131], v[180:183], a[140:143], v[128:131]
  buffer_load_dwordx2 a[236:237], v253, s[28:31], s60 offen offset:0 sc1
  v_mfma_f32_16x16x32_bf16 v[128:131], v[184:187], a[156:159], v[128:131]
  ds_read_b64_tr_b16 v[166:167], v236 offset:55296
  v_mfma_f32_16x16x32_bf16 v[124:127], v[184:187], a[152:155], v[124:127]
  ds_read_b64_tr_b16 v[168:169], v236 offset:50176
  v_mfma_f32_16x16x32_bf16 v[124:127], v[180:183], a[136:139], v[124:127]
  ds_read_b64_tr_b16 v[170:171], v236 offset:56320
  v_mfma_f32_16x16x32_bf16 v[124:127], v[176:179], a[120:123], v[124:127]
  buffer_load_dwordx2 a[238:239], v253, s[28:31], s60 offen offset:512 sc1
  v_mfma_f32_16x16x32_bf16 v[120:123], v[176:179], a[116:119], v[120:123]
  s_add_u32 s60, s24, 69632
  ds_read_b64_tr_b16 v[172:173], v236 offset:51200
  v_mfma_f32_16x16x32_bf16 v[120:123], v[180:183], a[132:135], v[120:123]
  ds_read_b64_tr_b16 v[174:175], v236 offset:57344
  v_mfma_f32_16x16x32_bf16 v[120:123], v[184:187], a[148:151], v[120:123]
  v_mfma_f32_16x16x32_bf16 v[116:119], v[184:187], a[144:147], v[116:119]
  buffer_load_dwordx2 a[240:241], v253, s[28:31], s60 offen offset:0 sc1
  v_mfma_f32_16x16x32_bf16 v[116:119], v[180:183], a[128:131], v[116:119]
  v_mfma_f32_16x16x32_bf16 v[116:119], v[176:179], a[112:115], v[116:119]
  s_waitcnt lgkmcnt(0) vmcnt(13)
  v_mfma_f32_16x16x32_bf16 v[4:7], v[164:167], a[160:163], v[4:7]
  ds_read_b64_tr_b16 v[176:177], v240 offset:0
  v_mfma_f32_16x16x32_bf16 v[4:7], v[168:171], a[176:179], v[4:7]
  buffer_load_dwordx2 a[242:243], v253, s[28:31], s60 offen offset:512 sc1
  v_mfma_f32_16x16x32_bf16 v[4:7], v[172:175], a[192:195], v[4:7]
  s_add_u32 s60, s25, 69632
  ds_read_b64_tr_b16 v[178:179], v240 offset:6144
  v_mfma_f32_16x16x32_bf16 v[8:11], v[172:175], a[196:199], v[8:11]
  ds_read_b64_tr_b16 v[180:181], v240 offset:1024
  v_mfma_f32_16x16x32_bf16 v[8:11], v[168:171], a[180:183], v[8:11]
  ds_read_b64_tr_b16 v[182:183], v240 offset:7168
  v_mfma_f32_16x16x32_bf16 v[8:11], v[164:167], a[164:167], v[8:11]
  buffer_load_dwordx2 a[244:245], v253, s[28:31], s60 offen offset:0 sc1
  v_mfma_f32_16x16x32_bf16 v[12:15], v[164:167], a[168:171], v[12:15]
  ds_read_b64_tr_b16 v[184:185], v240 offset:2048
  v_mfma_f32_16x16x32_bf16 v[12:15], v[168:171], a[184:187], v[12:15]
  ds_read_b64_tr_b16 v[186:187], v240 offset:8192
  v_mfma_f32_16x16x32_bf16 v[12:15], v[172:175], a[200:203], v[12:15]
  v_mfma_f32_16x16x32_bf16 v[16:19], v[172:175], a[204:207], v[16:19]
  buffer_load_dwordx2 a[246:247], v253, s[28:31], s60 offen offset:512 sc1
  v_mfma_f32_16x16x32_bf16 v[16:19], v[168:171], a[188:191], v[16:19]
  s_add_u32 s60, s26, 69632
  v_mfma_f32_16x16x32_bf16 v[16:19], v[164:167], a[172:175], v[16:19]
  s_waitcnt lgkmcnt(0)
  v_mfma_f32_16x16x32_bf16 v[32:35], v[176:179], a[172:175], v[32:35]
  ds_read_b64_tr_b16 v[164:165], v237 offset:49152
  v_mfma_f32_16x16x32_bf16 v[32:35], v[180:183], a[188:191], v[32:35]
  buffer_load_dwordx2 a[248:249], v253, s[28:31], s60 offen offset:0 sc1
  v_mfma_f32_16x16x32_bf16 v[32:35], v[184:187], a[204:207], v[32:35]
  ds_read_b64_tr_b16 v[166:167], v237 offset:55296
  v_mfma_f32_16x16x32_bf16 v[28:31], v[184:187], a[200:203], v[28:31]
  ds_read_b64_tr_b16 v[168:169], v237 offset:50176
  v_mfma_f32_16x16x32_bf16 v[28:31], v[180:183], a[184:187], v[28:31]
  ds_read_b64_tr_b16 v[170:171], v237 offset:56320
  v_mfma_f32_16x16x32_bf16 v[28:31], v[176:179], a[168:171], v[28:31]
  buffer_load_dwordx2 a[250:251], v253, s[28:31], s60 offen offset:512 sc1
  v_mfma_f32_16x16x32_bf16 v[24:27], v[176:179], a[164:167], v[24:27]
  s_add_u32 s60, s27, 69632
  ds_read_b64_tr_b16 v[172:173], v237 offset:51200
  v_mfma_f32_16x16x32_bf16 v[24:27], v[180:183], a[180:183], v[24:27]
  ds_read_b64_tr_b16 v[174:175], v237 offset:57344
  v_mfma_f32_16x16x32_bf16 v[24:27], v[184:187], a[196:199], v[24:27]
  v_mfma_f32_16x16x32_bf16 v[20:23], v[184:187], a[192:195], v[20:23]
  buffer_load_dwordx2 a[252:253], v253, s[28:31], s60 offen offset:0 sc1
  v_mfma_f32_16x16x32_bf16 v[20:23], v[180:183], a[176:179], v[20:23]
  v_mfma_f32_16x16x32_bf16 v[20:23], v[176:179], a[160:163], v[20:23]
  s_waitcnt lgkmcnt(0)
  v_mfma_f32_16x16x32_bf16 v[36:39], v[164:167], a[160:163], v[36:39]
  ds_read_b64_tr_b16 v[176:177], v241 offset:0
  v_mfma_f32_16x16x32_bf16 v[36:39], v[168:171], a[176:179], v[36:39]
  buffer_load_dwordx2 a[254:255], v253, s[28:31], s60 offen offset:512 sc1
  v_mfma_f32_16x16x32_bf16 v[36:39], v[172:175], a[192:195], v[36:39]
  ds_read_b64_tr_b16 v[178:179], v241 offset:6144
  v_mfma_f32_16x16x32_bf16 v[40:43], v[172:175], a[196:199], v[40:43]
  ds_read_b64_tr_b16 v[180:181], v241 offset:1024
  v_mfma_f32_16x16x32_bf16 v[40:43], v[168:171], a[180:183], v[40:43]
  ds_read_b64_tr_b16 v[182:183], v241 offset:7168
  v_mfma_f32_16x16x32_bf16 v[40:43], v[164:167], a[164:167], v[40:43]
  buffer_atomic_add v0, v254, s[28:31], s69 offen offset:4 sc1
  v_mfma_f32_16x16x32_bf16 v[44:47], v[164:167], a[168:171], v[44:47]
  s_add_u32 m0, s34, 0
  ds_read_b64_tr_b16 v[184:185], v241 offset:2048
  s_add_u32 s57, s33, 0
  v_mfma_f32_16x16x32_bf16 v[44:47], v[168:171], a[184:187], v[44:47]
  ds_read_b64_tr_b16 v[186:187], v241 offset:8192
  v_mfma_f32_16x16x32_bf16 v[44:47], v[172:175], a[200:203], v[44:47]
  v_mfma_f32_16x16x32_bf16 v[48:51], v[172:175], a[204:207], v[48:51]
  buffer_load_dwordx4 v252, s[28:31], s57 offen offset:0 sc1 lds
  v_mfma_f32_16x16x32_bf16 v[48:51], v[168:171], a[188:191], v[48:51]
  v_mfma_f32_16x16x32_bf16 v[48:51], v[164:167], a[172:175], v[48:51]
  s_waitcnt lgkmcnt(0)
  v_mfma_f32_16x16x32_bf16 v[64:67], v[176:179], a[172:175], v[64:67]
  ds_read_b64_tr_b16 v[164:165], v238 offset:49152
  v_mfma_f32_16x16x32_bf16 v[64:67], v[180:183], a[188:191], v[64:67]
  buffer_load_dwordx4 v252, s[28:31], s57 offen offset:1024 sc1 lds
  v_mfma_f32_16x16x32_bf16 v[64:67], v[184:187], a[204:207], v[64:67]
  ds_read_b64_tr_b16 v[166:167], v238 offset:55296
  v_mfma_f32_16x16x32_bf16 v[60:63], v[184:187], a[200:203], v[60:63]
  ds_read_b64_tr_b16 v[168:169], v238 offset:50176
  v_mfma_f32_16x16x32_bf16 v[60:63], v[180:183], a[184:187], v[60:63]
  ds_read_b64_tr_b16 v[170:171], v238 offset:56320
  v_mfma_f32_16x16x32_bf16 v[60:63], v[176:179], a[168:171], v[60:63]
  buffer_load_dwordx4 v252, s[28:31], s57 offen offset:2048 sc1 lds
  v_mfma_f32_16x16x32_bf16 v[56:59], v[176:179], a[164:167], v[56:59]
  ds_read_b64_tr_b16 v[172:173], v238 offset:51200
  v_mfma_f32_16x16x32_bf16 v[56:59], v[180:183], a[180:183], v[56:59]
  ds_read_b64_tr_b16 v[174:175], v238 offset:57344
  v_mfma_f32_16x16x32_bf16 v[56:59], v[184:187], a[196:199], v[56:59]
  v_mfma_f32_16x16x32_bf16 v[52:55], v[184:187], a[192:195], v[52:55]
  buffer_load_dwordx4 v252, s[28:31], s57 offen offset:3072 sc1 lds
  v_mfma_f32_16x16x32_bf16 v[52:55], v[180:183], a[176:179], v[52:55]
  s_add_u32 m0, s34, 4096
  s_add_u32 s57, s33, 4096
  v_mfma_f32_16x16x32_bf16 v[52:55], v[176:179], a[160:163], v[52:55]
  s_waitcnt lgkmcnt(0)
  v_mfma_f32_16x16x32_bf16 v[68:71], v[164:167], a[160:163], v[68:71]
  ds_read_b64_tr_b16 v[176:177], v242 offset:0
  v_mfma_f32_16x16x32_bf16 v[68:71], v[168:171], a[176:179], v[68:71]
  buffer_load_dwordx4 v252, s[28:31], s57 offen offset:0 sc1 lds
  v_mfma_f32_16x16x32_bf16 v[68:71], v[172:175], a[192:195], v[68:71]
  ds_read_b64_tr_b16 v[178:179], v242 offset:6144
  v_mfma_f32_16x16x32_bf16 v[72:75], v[172:175], a[196:199], v[72:75]
  ds_read_b64_tr_b16 v[180:181], v242 offset:1024
  v_mfma_f32_16x16x32_bf16 v[72:75], v[168:171], a[180:183], v[72:75]
  ds_read_b64_tr_b16 v[182:183], v242 offset:7168
  v_mfma_f32_16x16x32_bf16 v[72:75], v[164:167], a[164:167], v[72:75]
  buffer_load_dwordx4 v252, s[28:31], s57 offen offset:1024 sc1 lds
  v_mfma_f32_16x16x32_bf16 v[76:79], v[164:167], a[168:171], v[76:79]
  ds_read_b64_tr_b16 v[184:185], v242 offset:2048
  v_mfma_f32_16x16x32_bf16 v[76:79], v[168:171], a[184:187], v[76:79]
  ds_read_b64_tr_b16 v[186:187], v242 offset:8192
  v_mfma_f32_16x16x32_bf16 v[76:79], v[172:175], a[200:203], v[76:79]
  v_mfma_f32_16x16x32_bf16 v[80:83], v[172:175], a[204:207], v[80:83]
  buffer_load_dwordx4 v252, s[28:31], s57 offen offset:2048 sc1 lds
  v_mfma_f32_16x16x32_bf16 v[80:83], v[168:171], a[188:191], v[80:83]
  v_mfma_f32_16x16x32_bf16 v[80:83], v[164:167], a[172:175], v[80:83]
  s_waitcnt lgkmcnt(0)
  v_mfma_f32_16x16x32_bf16 v[96:99], v[176:179], a[172:175], v[96:99]
  ds_read_b64_tr_b16 v[164:165], v239 offset:49152
  v_mfma_f32_16x16x32_bf16 v[96:99], v[180:183], a[188:191], v[96:99]
  buffer_load_dwordx4 v252, s[28:31], s57 offen offset:3072 sc1 lds
  v_mfma_f32_16x16x32_bf16 v[96:99], v[184:187], a[204:207], v[96:99]
  s_add_u32 m0, s34, 8192
  ds_read_b64_tr_b16 v[166:167], v239 offset:55296
  s_add_u32 s57, s33, 8192
  v_mfma_f32_16x16x32_bf16 v[92:95], v[184:187], a[200:203], v[92:95]
  ds_read_b64_tr_b16 v[168:169], v239 offset:50176
  v_mfma_f32_16x16x32_bf16 v[92:95], v[180:183], a[184:187], v[92:95]
  ds_read_b64_tr_b16 v[170:171], v239 offset:56320
  v_mfma_f32_16x16x32_bf16 v[92:95], v[176:179], a[168:171], v[92:95]
  buffer_load_dwordx4 v252, s[28:31], s57 offen offset:0 sc1 lds
  v_mfma_f32_16x16x32_bf16 v[88:91], v[176:179], a[164:167], v[88:91]
  s_add_u32 s57, s32, 128
  ds_read_b64_tr_b16 v[172:173], v239 offset:51200
  s_add_u32 s58, s32, 294016
  v_mfma_f32_16x16x32_bf16 v[88:91], v[180:183], a[180:183], v[88:91]
  s_add_u32 s59, s32, 587904
  ds_read_b64_tr_b16 v[174:175], v239 offset:57344
  s_add_u32 m0, s35, 135168
  v_mfma_f32_16x16x32_bf16 v[88:91], v[184:187], a[196:199], v[88:91]
  v_mfma_f32_16x16x32_bf16 v[84:87], v[184:187], a[192:195], v[84:87]
  buffer_load_dwordx4 v249, s[12:15], s57 offen offset:0  lds
  v_mfma_f32_16x16x32_bf16 v[84:87], v[180:183], a[176:179], v[84:87]
  v_mfma_f32_16x16x32_bf16 v[84:87], v[176:179], a[160:163], v[84:87]
  s_waitcnt lgkmcnt(0)
  v_mfma_f32_16x16x32_bf16 v[100:103], v[164:167], a[160:163], v[100:103]
  ds_read_b64_tr_b16 v[176:177], v243 offset:0
  v_mfma_f32_16x16x32_bf16 v[100:103], v[168:171], a[176:179], v[100:103]
  buffer_load_dwordx4 v249, s[12:15], s58 offen offset:1024  lds
  v_mfma_f32_16x16x32_bf16 v[100:103], v[172:175], a[192:195], v[100:103]
  ds_read_b64_tr_b16 v[178:179], v243 offset:6144
  v_mfma_f32_16x16x32_bf16 v[104:107], v[172:175], a[196:199], v[104:107]
  ds_read_b64_tr_b16 v[180:181], v243 offset:1024
  v_mfma_f32_16x16x32_bf16 v[104:107], v[168:171], a[180:183], v[104:107]
  ds_read_b64_tr_b16 v[182:183], v243 offset:7168
  v_mfma_f32_16x16x32_bf16 v[104:107], v[164:167], a[164:167], v[104:107]
  buffer_load_dwordx4 v249, s[12:15], s59 offen offset:2048  lds
  v_mfma_f32_16x16x32_bf16 v[108:111], v[164:167], a[168:171], v[108:111]
  s_add_u32 m0, s35, 147456
  ds_read_b64_tr_b16 v[184:185], v243 offset:2048
  v_mfma_f32_16x16x32_bf16 v[108:111], v[168:171], a[184:187], v[108:111]
  ds_read_b64_tr_b16 v[186:187], v243 offset:8192
  v_mfma_f32_16x16x32_bf16 v[108:111], v[172:175], a[200:203], v[108:111]
  v_mfma_f32_16x16x32_bf16 v[112:115], v[172:175], a[204:207], v[112:115]
  buffer_load_dwordx4 v249, s[16:19], s57 offen offset:0  lds
  v_mfma_f32_16x16x32_bf16 v[112:115], v[168:171], a[188:191], v[112:115]
  v_mfma_f32_16x16x32_bf16 v[112:115], v[164:167], a[172:175], v[112:115]
  s_waitcnt lgkmcnt(0)
  v_mfma_f32_16x16x32_bf16 v[128:131], v[176:179], a[172:175], v[128:131]
  ds_read_b64_tr_b16 v[164:165], v240 offset:12288
  v_mfma_f32_16x16x32_bf16 v[128:131], v[180:183], a[188:191], v[128:131]
  buffer_load_dwordx4 v249, s[16:19], s58 offen offset:1024  lds
  v_mfma_f32_16x16x32_bf16 v[128:131], v[184:187], a[204:207], v[128:131]
  ds_read_b64_tr_b16 v[166:167], v240 offset:18432
  v_mfma_f32_16x16x32_bf16 v[124:127], v[184:187], a[200:203], v[124:127]
  ds_read_b64_tr_b16 v[168:169], v240 offset:13312
  v_mfma_f32_16x16x32_bf16 v[124:127], v[180:183], a[184:187], v[124:127]
  ds_read_b64_tr_b16 v[170:171], v240 offset:19456
  v_mfma_f32_16x16x32_bf16 v[124:127], v[176:179], a[168:171], v[124:127]
  buffer_load_dwordx4 v249, s[16:19], s59 offen offset:2048  lds
  v_mfma_f32_16x16x32_bf16 v[120:123], v[176:179], a[164:167], v[120:123]
  s_add_u32 s57, s32, 884864
  ds_read_b64_tr_b16 v[172:173], v240 offset:14336
  s_add_u32 s58, s32, 1178752
  v_mfma_f32_16x16x32_bf16 v[120:123], v[180:183], a[180:183], v[120:123]
  s_add_u32 s59, s32, 1472640
  ds_read_b64_tr_b16 v[174:175], v240 offset:20480
  s_add_u32 m0, s35, 36864
  v_mfma_f32_16x16x32_bf16 v[120:123], v[184:187], a[196:199], v[120:123]
  v_mfma_f32_16x16x32_bf16 v[116:119], v[184:187], a[192:195], v[116:119]
  buffer_load_dwordx4 v249, s[12:15], s57 offen offset:0  lds
  v_mfma_f32_16x16x32_bf16 v[116:119], v[180:183], a[176:179], v[116:119]
  v_mfma_f32_16x16x32_bf16 v[116:119], v[176:179], a[160:163], v[116:119]
  s_waitcnt lgkmcnt(0) vmcnt(17)
  v_mfma_f32_16x16x32_bf16 v[4:7], v[164:167], a[208:211], v[4:7]
  ds_read_b64_tr_b16 v[176:177], v240 offset:24576
  v_mfma_f32_16x16x32_bf16 v[4:7], v[168:171], a[224:227], v[4:7]
  buffer_load_dwordx4 v249, s[12:15], s58 offen offset:1024  lds
  v_mfma_f32_16x16x32_bf16 v[4:7], v[172:175], a[240:243], v[4:7]
  ds_read_b64_tr_b16 v[178:179], v240 offset:30720
  v_mfma_f32_16x16x32_bf16 v[8:11], v[172:175], a[244:247], v[8:11]
  ds_read_b64_tr_b16 v[180:181], v240 offset:25600
  v_mfma_f32_16x16x32_bf16 v[8:11], v[168:171], a[228:231], v[8:11]
  ds_read_b64_tr_b16 v[182:183], v240 offset:31744
  v_mfma_f32_16x16x32_bf16 v[8:11], v[164:167], a[212:215], v[8:11]
  buffer_load_dwordx4 v249, s[12:15], s59 offen offset:2048  lds
  v_mfma_f32_16x16x32_bf16 v[12:15], v[164:167], a[216:219], v[12:15]
  s_add_u32 m0, s35, 49152
  ds_read_b64_tr_b16 v[184:185], v240 offset:26624
  v_mfma_f32_16x16x32_bf16 v[12:15], v[168:171], a[232:235], v[12:15]
  ds_read_b64_tr_b16 v[186:187], v240 offset:32768
  v_mfma_f32_16x16x32_bf16 v[12:15], v[172:175], a[248:251], v[12:15]
  v_mfma_f32_16x16x32_bf16 v[16:19], v[172:175], a[252:255], v[16:19]
  buffer_load_dwordx4 v249, s[16:19], s57 offen offset:0  lds
  v_mfma_f32_16x16x32_bf16 v[16:19], v[168:171], a[236:239], v[16:19]
  v_mfma_f32_16x16x32_bf16 v[16:19], v[164:167], a[220:223], v[16:19]
  s_waitcnt lgkmcnt(0)
  v_mfma_f32_16x16x32_bf16 v[32:35], v[176:179], a[220:223], v[32:35]
  ds_read_b64_tr_b16 v[164:165], v241 offset:12288
  v_mfma_f32_16x16x32_bf16 v[32:35], v[180:183], a[236:239], v[32:35]
  buffer_load_dwordx4 v249, s[16:19], s58 offen offset:1024  lds
  v_mfma_f32_16x16x32_bf16 v[32:35], v[184:187], a[252:255], v[32:35]
  ds_read_b64_tr_b16 v[166:167], v241 offset:18432
L_hop7:
  s_cbranch_execz L_main
  v_mfma_f32_16x16x32_bf16 v[28:31], v[184:187], a[248:251], v[28:31]
  ds_read_b64_tr_b16 v[168:169], v241 offset:13312
  v_mfma_f32_16x16x32_bf16 v[28:31], v[180:183], a[232:235], v[28:31]
  ds_read_b64_tr_b16 v[170:171], v241 offset:19456
  v_mfma_f32_16x16x32_bf16 v[28:31], v[176:179], a[216:219], v[28:31]
  buffer_load_dwordx4 v249, s[16:19], s59 offen offset:2048  lds
  v_mfma_f32_16x16x32_bf16 v[24:27], v[176:179], a[212:215], v[24:27]
  s_add_u32 s57, s32, 1769600
  ds_read_b64_tr_b16 v[172:173], v241 offset:14336
  s_add_u32 s58, s32, 2063488
  v_mfma_f32_16x16x32_bf16 v[24:27], v[180:183], a[228:231], v[24:27]
  s_add_u32 s59, s32, 2357376
  ds_read_b64_tr_b16 v[174:175], v241 offset:20480
  s_add_u32 m0, s35, 61440
  v_mfma_f32_16x16x32_bf16 v[24:27], v[184:187], a[244:247], v[24:27]
  v_mfma_f32_16x16x32_bf16 v[20:23], v[184:187], a[240:243], v[20:23]
  v_mfma_f32_16x16x32_bf16 v[20:23], v[180:183], a[224:227], v[20:23]
  buffer_load_dwordx4 v249, s[12:15], s57 offen offset:0  lds
  v_mfma_f32_16x16x32_bf16 v[20:23], v[176:179], a[208:211], v[20:23]
  s_waitcnt lgkmcnt(0)
  v_mfma_f32_16x16x32_bf16 v[36:39], v[164:167], a[208:211], v[36:39]
  ds_read_b64_tr_b16 v[176:177], v241 offset:24576
  v_mfma_f32_16x16x32_bf16 v[36:39], v[168:171], a[224:227], v[36:39]
  ds_read_b64_tr_b16 v[178:179], v241 offset:30720
  v_mfma_f32_16x16x32_bf16 v[36:39], v[172:175], a[240:243], v[36:39]
  ds_read_b64_tr_b16 v[180:181], v241 offset:25600
  v_mfma_f32_16x16x32_bf16 v[40:43], v[172:175], a[244:247], v[40:43]
  buffer_load_dwordx4 v249, s[12:15], s58 offen offset:1024  lds
  v_mfma_f32_16x16x32_bf16 v[40:43], v[168:171], a[228:231], v[40:43]
  ds_read_b64_tr_b16 v[182:183], v241 offset:31744
  v_mfma_f32_16x16x32_bf16 v[40:43], v[164:167], a[212:215], v[40:43]
  ds_read_b64_tr_b16 v[184:185], v241 offset:26624
  v_mfma_f32_16x16x32_bf16 v[44:47], v[164:167], a[216:219], v[44:47]
  ds_read_b64_tr_b16 v[186:187], v241 offset:32768
  v_mfma_f32_16x16x32_bf16 v[44:47], v[168:171], a[232:235], v[44:47]
  v_mul_f32 v4, v4, v20
  v_mul_f32 v5, v5, v21
  v_mfma_f32_16x16x32_bf16 v[44:47], v[172:175], a[248:251], v[44:47]
  buffer_load_dwordx4 v249, s[12:15], s59 offen offset:2048  lds
  v_mfma_f32_16x16x32_bf16 v[48:51], v[172:175], a[252:255], v[48:51]
  s_add_u32 m0, s35, 73728
  v_mul_f32 v6, v6, v22
  v_mul_f32 v7, v7, v23
  v_mfma_f32_16x16x32_bf16 v[48:51], v[168:171], a[236:239], v[48:51]
  v_cvt_pk_bf16_f32 v220, v4, v5
  v_cvt_pk_bf16_f32 v221, v6, v7
  v_mfma_f32_16x16x32_bf16 v[48:51], v[164:167], a[220:223], v[48:51]
  s_waitcnt lgkmcnt(0)
  v_mul_f32 v8, v8, v24
  v_mul_f32 v9, v9, v25
  v_mfma_f32_16x16x32_bf16 v[64:67], v[176:179], a[220:223], v[64:67]
  ds_read_b64_tr_b16 v[164:165], v242 offset:12288
  v_mul_f32 v10, v10, v26
  v_mfma_f32_16x16x32_bf16 v[64:67], v[180:183], a[236:239], v[64:67]
  buffer_load_dwordx4 v249, s[16:19], s57 offen offset:0  lds
  v_mfma_f32_16x16x32_bf16 v[64:67], v[184:187], a[252:255], v[64:67]
  ds_read_b64_tr_b16 v[166:167], v242 offset:18432
  v_mul_f32 v11, v11, v27
  v_mfma_f32_16x16x32_bf16 v[60:63], v[184:187], a[248:251], v[60:63]
  ds_read_b64_tr_b16 v[168:169], v242 offset:13312
  v_cvt_pk_bf16_f32 v224, v8, v9
  v_mfma_f32_16x16x32_bf16 v[60:63], v[180:183], a[232:235], v[60:63]
  ds_read_b64_tr_b16 v[170:171], v242 offset:19456
  v_cvt_pk_bf16_f32 v225, v10, v11
  v_mfma_f32_16x16x32_bf16 v[60:63], v[176:179], a[216:219], v[60:63]
  ds_read_b64_tr_b16 v[172:173], v242 offset:14336
  v_mul_f32 v12, v12, v28
  v_mfma_f32_16x16x32_bf16 v[56:59], v[176:179], a[212:215], v[56:59]
  buffer_load_dwordx4 v249, s[16:19], s58 offen offset:1024  lds
  v_mfma_f32_16x16x32_bf16 v[56:59], v[180:183], a[228:231], v[56:59]
  ds_read_b64_tr_b16 v[174:175], v242 offset:20480
  v_mul_f32 v13, v13, v29
  v_mfma_f32_16x16x32_bf16 v[56:59], v[184:187], a[244:247], v[56:59]
  v_mul_f32 v14, v14, v30
  v_mul_f32 v15, v15, v31
  v_mfma_f32_16x16x32_bf16 v[52:55], v[184:187], a[240:243], v[52:55]
  v_cvt_pk_bf16_f32 v228, v12, v13
  v_cvt_pk_bf16_f32 v229, v14, v15
  v_mfma_f32_16x16x32_bf16 v[52:55], v[180:183], a[224:227], v[52:55]
  v_mul_f32 v16, v16, v32
  v_mul_f32 v17, v17, v33
  v_mfma_f32_16x16x32_bf16 v[52:55], v[176:179], a[208:211], v[52:55]
  s_waitcnt lgkmcnt(0)
  v_mul_f32 v18, v18, v34
  v_mul_f32 v19, v19, v35
  v_mfma_f32_16x16x32_bf16 v[68:71], v[164:167], a[208:211], v[68:71]
  buffer_load_dwordx4 v249, s[16:19], s59 offen offset:2048  lds
  v_mfma_f32_16x16x32_bf16 v[68:71], v[168:171], a[224:227], v[68:71]
  ds_read_b64_tr_b16 v[176:177], v242 offset:24576
  v_cvt_pk_bf16_f32 v232, v16, v17
  v_mfma_f32_16x16x32_bf16 v[68:71], v[172:175], a[240:243], v[68:71]
  ds_read_b64_tr_b16 v[178:179], v242 offset:30720
  v_cvt_pk_bf16_f32 v233, v18, v19
  v_mfma_f32_16x16x32_bf16 v[72:75], v[172:175], a[244:247], v[72:75]
  ds_read_b64_tr_b16 v[180:181], v242 offset:25600
  v_mfma_f32_16x16x32_bf16 v[72:75], v[168:171], a[228:231], v[72:75]
  ds_read_b64_tr_b16 v[182:183], v242 offset:31744
  v_mfma_f32_16x16x32_bf16 v[72:75], v[164:167], a[212:215], v[72:75]
  ds_read_b64_tr_b16 v[184:185], v242 offset:26624
  v_mfma_f32_16x16x32_bf16 v[76:79], v[164:167], a[216:219], v[76:79]
  ds_read_b64_tr_b16 v[186:187], v242 offset:32768
  v_mfma_f32_16x16x32_bf16 v[76:79], v[168:171], a[232:235], v[76:79]
  s_add_u32 s61, s37, 0
  v_mul_f32 v36, v36, v52
  v_mul_f32 v37, v37, v53
  v_mfma_f32_16x16x32_bf16 v[76:79], v[172:175], a[248:251], v[76:79]
  v_mul_f32 v38, v38, v54
  v_mul_f32 v39, v39, v55
  v_mfma_f32_16x16x32_bf16 v[80:83], v[172:175], a[252:255], v[80:83]
  v_cvt_pk_bf16_f32 v222, v36, v37
  v_cvt_pk_bf16_f32 v223, v38, v39
  v_mfma_f32_16x16x32_bf16 v[80:83], v[168:171], a[236:239], v[80:83]
  buffer_store_dwordx4 v[220:223], v252, s[28:31], s61 offen offset:0 sc1
  v_mfma_f32_16x16x32_bf16 v[80:83], v[164:167], a[220:223], v[80:83]
  s_waitcnt lgkmcnt(0)
  v_mul_f32 v40, v40, v56
  v_mul_f32 v41, v41, v57
  v_mfma_f32_16x16x32_bf16 v[96:99], v[176:179], a[220:223], v[96:99]
  ds_read_b64_tr_b16 v[164:165], v243 offset:12288
  v_mul_f32 v42, v42, v58
  v_mfma_f32_16x16x32_bf16 v[96:99], v[180:183], a[236:239], v[96:99]
  ds_read_b64_tr_b16 v[166:167], v243 offset:18432
  v_mul_f32 v43, v43, v59
  v_mfma_f32_16x16x32_bf16 v[96:99], v[184:187], a[252:255], v[96:99]
  ds_read_b64_tr_b16 v[168:169], v243 offset:13312
  v_cvt_pk_bf16_f32 v226, v40, v41
  v_mfma_f32_16x16x32_bf16 v[92:95], v[184:187], a[248:251], v[92:95]
  ds_read_b64_tr_b16 v[170:171], v243 offset:19456
  v_cvt_pk_bf16_f32 v227, v42, v43
  v_mfma_f32_16x16x32_bf16 v[92:95], v[180:183], a[232:235], v[92:95]
  buffer_store_dwordx4 v[224:227], v252, s[28:31], s61 offen offset:1024 sc1
  v_mfma_f32_16x16x32_bf16 v[92:95], v[176:179], a[216:219], v[92:95]
  ds_read_b64_tr_b16 v[172:173], v243 offset:14336
  v_mul_f32 v44, v44, v60
  v_mfma_f32_16x16x32_bf16 v[88:91], v[176:179], a[212:215], v[88:91]
  ds_read_b64_tr_b16 v[174:175], v243 offset:20480
  v_mul_f32 v45, v45, v61
  v_mfma_f32_16x16x32_bf16 v[88:91], v[180:183], a[228:231], v[88:91]
  v_mul_f32 v46, v46, v62
  v_mul_f32 v47, v47, v63
  v_mfma_f32_16x16x32_bf16 v[88:91], v[184:187], a[244:247], v[88:91]
  v_cvt_pk_bf16_f32 v230, v44, v45
  v_cvt_pk_bf16_f32 v231, v46, v47
  v_mfma_f32_16x16x32_bf16 v[84:87], v[184:187], a[240:243], v[84:87]
  v_mfma_f32_16x16x32_bf16 v[84:87], v[180:183], a[224:227], v[84:87]
  buffer_store_dwordx4 v[228:231], v252, s[28:31], s61 offen offset:2048 sc1
  v_mfma_f32_16x16x32_bf16 v[84:87], v[176:179], a[208:211], v[84:87]
  s_waitcnt lgkmcnt(0)
  v_mul_f32 v48, v48, v64
  v_mul_f32 v49, v49, v65
  v_mfma_f32_16x16x32_bf16 v[100:103], v[164:167], a[208:211], v[100:103]
  ds_read_b64_tr_b16 v[176:177], v243 offset:24576
  v_mul_f32 v50, v50, v66
  v_mfma_f32_16x16x32_bf16 v[100:103], v[168:171], a[224:227], v[100:103]
  ds_read_b64_tr_b16 v[178:179], v243 offset:30720
  v_mul_f32 v51, v51, v67
  v_mfma_f32_16x16x32_bf16 v[100:103], v[172:175], a[240:243], v[100:103]
  ds_read_b64_tr_b16 v[180:181], v243 offset:25600
  v_cvt_pk_bf16_f32 v234, v48, v49
  v_mfma_f32_16x16x32_bf16 v[104:107], v[172:175], a[244:247], v[104:107]
  ds_read_b64_tr_b16 v[182:183], v243 offset:31744
  v_cvt_pk_bf16_f32 v235, v50, v51
  v_mfma_f32_16x16x32_bf16 v[104:107], v[168:171], a[228:231], v[104:107]
  buffer_store_dwordx4 v[232:235], v252, s[28:31], s61 offen offset:3072 sc1
  v_mfma_f32_16x16x32_bf16 v[104:107], v[164:167], a[212:215], v[104:107]
  ds_read_b64_tr_b16 v[184:185], v243 offset:26624
  v_mfma_f32_16x16x32_bf16 v[108:111], v[164:167], a[216:219], v[108:111]
  ds_read_b64_tr_b16 v[186:187], v243 offset:32768
  v_mfma_f32_16x16x32_bf16 v[108:111], v[168:171], a[232:235], v[108:111]
  v_mul_f32 v68, v68, v84
  v_mul_f32 v69, v69, v85
  v_mfma_f32_16x16x32_bf16 v[108:111], v[172:175], a[248:251], v[108:111]
  v_mul_f32 v70, v70, v86
  v_mul_f32 v71, v71, v87
  v_mfma_f32_16x16x32_bf16 v[112:115], v[172:175], a[252:255], v[112:115]
  v_cvt_pk_bf16_f32 v220, v68, v69
  v_cvt_pk_bf16_f32 v221, v70, v71
  v_mfma_f32_16x16x32_bf16 v[112:115], v[168:171], a[236:239], v[112:115]
  v_mul_f32 v72, v72, v88
  v_mul_f32 v73, v73, v89
  v_mfma_f32_16x16x32_bf16 v[112:115], v[164:167], a[220:223], v[112:115]
  s_waitcnt lgkmcnt(0) vmcnt(22)
  s_barrier
  v_mul_f32 v74, v74, v90
  v_mfma_f32_16x16x32_bf16 v[128:131], v[176:179], a[220:223], v[128:131]
  ds_read_b64_tr_b16 v[164:165], v248 offset:0
  v_mul_f32 v75, v75, v91
  v_mfma_f32_16x16x32_bf16 v[128:131], v[180:183], a[236:239], v[128:131]
  ds_read_b64_tr_b16 v[166:167], v248 offset:512
  v_cvt_pk_bf16_f32 v224, v72, v73
  v_mfma_f32_16x16x32_bf16 v[128:131], v[184:187], a[252:255], v[128:131]
  ds_read_b64_tr_b16 v[168:169], v248 offset:1024
  v_cvt_pk_bf16_f32 v225, v74, v75
  v_mfma_f32_16x16x32_bf16 v[124:127], v[184:187], a[248:251], v[124:127]
  ds_read_b64_tr_b16 v[170:171], v248 offset:1536
  v_mul_f32 v76, v76, v92
  v_mfma_f32_16x16x32_bf16 v[124:127], v[180:183], a[232:235], v[124:127]
  ds_read_b64_tr_b16 v[172:173], v248 offset:2048
  v_mul_f32 v77, v77, v93
  v_mfma_f32_16x16x32_bf16 v[124:127], v[176:179], a[216:219], v[124:127]
  ds_read_b64_tr_b16 v[174:175], v248 offset:2560
  v_mul_f32 v78, v78, v94
  v_mfma_f32_16x16x32_bf16 v[120:123], v[176:179], a[212:215], v[120:123]
  v_mul_f32 v79, v79, v95
  v_cvt_pk_bf16_f32 v228, v76, v77
  v_mfma_f32_16x16x32_bf16 v[120:123], v[180:183], a[228:231], v[120:123]
  v_cvt_pk_bf16_f32 v229, v78, v79
  v_mul_f32 v80, v80, v96
  v_mfma_f32_16x16x32_bf16 v[120:123], v[184:187], a[244:247], v[120:123]
  v_mul_f32 v81, v81, v97
  v_mul_f32 v82, v82, v98
  v_mfma_f32_16x16x32_bf16 v[116:119], v[184:187], a[240:243], v[116:119]
  v_mul_f32 v83, v83, v99
  v_cvt_pk_bf16_f32 v232, v80, v81
  v_mfma_f32_16x16x32_bf16 v[116:119], v[180:183], a[224:227], v[116:119]
  v_cvt_pk_bf16_f32 v233, v82, v83
  v_mfma_f32_16x16x32_bf16 v[116:119], v[176:179], a[208:211], v[116:119]
  s_waitcnt lgkmcnt(0)
  v_mfma_f32_16x16x32_bf16 v[132:135], v[164:167], v[188:191], 0
  ds_read_b64_tr_b16 v[176:177], v248 offset:18432
  v_mfma_f32_16x16x32_bf16 v[132:135], v[168:171], v[204:207], v[132:135]
  ds_read_b64_tr_b16 v[178:179], v248 offset:18944
  v_mfma_f32_16x16x32_bf16 v[132:135], v[172:175], a[0:3], v[132:135]
  ds_read_b64_tr_b16 v[180:181], v248 offset:19456
  v_mfma_f32_16x16x32_bf16 v[136:139], v[172:175], a[4:7], 0
  ds_read_b64_tr_b16 v[182:183], v248 offset:19968
  v_mfma_f32_16x16x32_bf16 v[136:139], v[168:171], v[208:211], v[136:139]
  ds_read_b64_tr_b16 v[184:185], v248 offset:20480
  v_mfma_f32_16x16x32_bf16 v[136:139], v[164:167], v[192:195], v[136:139]
  ds_read_b64_tr_b16 v[186:187], v248 offset:20992
  v_mfma_f32_16x16x32_bf16 v[140:143], v[164:167], v[196:199], 0
  v_mfma_f32_16x16x32_bf16 v[140:143], v[168:171], v[212:215], v[140:143]
  s_add_u32 s61, s37, 4096
  v_mul_f32 v100, v100, v116
  v_mul_f32 v101, v101, v117
  v_mfma_f32_16x16x32_bf16 v[140:143], v[172:175], a[8:11], v[140:143]
  v_mul_f32 v102, v102, v118
  v_mul_f32 v103, v103, v119
  v_mfma_f32_16x16x32_bf16 v[144:147], v[172:175], a[12:15], 0
  v_cvt_pk_bf16_f32 v222, v100, v101
  v_cvt_pk_bf16_f32 v223, v102, v103
  v_mfma_f32_16x16x32_bf16 v[144:147], v[168:171], v[216:219], v[144:147]
  buffer_store_dwordx4 v[220:223], v252, s[28:31], s61 offen offset:0 sc1
  v_mfma_f32_16x16x32_bf16 v[144:147], v[164:167], v[200:203], v[144:147]
  s_waitcnt lgkmcnt(0)
  v_mul_f32 v104, v104, v120
  v_mul_f32 v105, v105, v121
  v_mfma_f32_16x16x32_bf16 v[160:163], v[176:179], v[200:203], 0
  ds_read_b64_tr_b16 v[164:165], v248 offset:3072
  v_mul_f32 v106, v106, v122
  v_mfma_f32_16x16x32_bf16 v[160:163], v[180:183], v[216:219], v[160:163]
  ds_read_b64_tr_b16 v[166:167], v248 offset:3584
  v_mul_f32 v107, v107, v123
  v_mfma_f32_16x16x32_bf16 v[160:163], v[184:187], a[12:15], v[160:163]
  ds_read_b64_tr_b16 v[168:169], v248 offset:4096
  v_cvt_pk_bf16_f32 v226, v104, v105
  v_mfma_f32_16x16x32_bf16 v[156:159], v[184:187], a[8:11], 0
  ds_read_b64_tr_b16 v[170:171], v248 offset:4608
  v_cvt_pk_bf16_f32 v227, v106, v107
  v_mfma_f32_16x16x32_bf16 v[156:159], v[180:183], v[212:215], v[156:159]
  buffer_store_dwordx4 v[224:227], v252, s[28:31], s61 offen offset:1024 sc1
  v_mfma_f32_16x16x32_bf16 v[156:159], v[176:179], v[196:199], v[156:159]
  ds_read_b64_tr_b16 v[172:173], v248 offset:5120
  v_mul_f32 v108, v108, v124
  v_mfma_f32_16x16x32_bf16 v[152:155], v[176:179], v[192:195], 0
  ds_read_b64_tr_b16 v[174:175], v248 offset:5632
  v_mul_f32 v109, v109, v125
  v_mfma_f32_16x16x32_bf16 v[152:155], v[180:183], v[208:211], v[152:155]
  v_mul_f32 v110, v110, v126
  v_mul_f32 v111, v111, v127
  v_mfma_f32_16x16x32_bf16 v[152:155], v[184:187], a[4:7], v[152:155]
  v_cvt_pk_bf16_f32 v230, v108, v109
  v_cvt_pk_bf16_f32 v231, v110, v111
  v_mfma_f32_16x16x32_bf16 v[148:151], v[184:187], a[0:3], 0
  v_mfma_f32_16x16x32_bf16 v[148:151], v[180:183], v[204:207], v[148:151]
  buffer_store_dwordx4 v[228:231], v252, s[28:31], s61 offen offset:2048 sc1
  v_mfma_f32_16x16x32_bf16 v[148:151], v[176:179], v[188:191], v[148:151]
  s_waitcnt lgkmcnt(0)
  v_mul_f32 v112, v112, v128
  v_mul_f32 v113, v113, v129
  v_mfma_f32_16x16x32_bf16 v[132:135], v[164:167], a[16:19], v[132:135]
  ds_read_b64_tr_b16 v[176:177], v248 offset:21504
  v_mul_f32 v114, v114, v130
  v_mfma_f32_16x16x32_bf16 v[132:135], v[168:171], a[32:35], v[132:135]
  ds_read_b64_tr_b16 v[178:179], v248 offset:22016
  v_mul_f32 v115, v115, v131
  v_mfma_f32_16x16x32_bf16 v[132:135], v[172:175], a[48:51], v[132:135]
  ds_read_b64_tr_b16 v[180:181], v248 offset:22528
  v_cvt_pk_bf16_f32 v234, v112, v113
  v_mfma_f32_16x16x32_bf16 v[136:139], v[172:175], a[52:55], v[136:139]
  ds_read_b64_tr_b16 v[182:183], v248 offset:23040
  v_cvt_pk_bf16_f32 v235, v114, v115
  v_mfma_f32_16x16x32_bf16 v[136:139], v[168:171], a[36:39], v[136:139]
  buffer_store_dwordx4 v[232:235], v252, s[28:31], s61 offen offset:3072 sc1
  v_mfma_f32_16x16x32_bf16 v[136:139], v[164:167], a[20:23], v[136:139]
  ds_read_b64_tr_b16 v[184:185], v248 offset:23552
  v_mfma_f32_16x16x32_bf16 v[140:143], v[164:167], a[24:27], v[140:143]
  ds_read_b64_tr_b16 v[186:187], v248 offset:24064
  v_mfma_f32_16x16x32_bf16 v[140:143], v[168:171], a[40:43], v[140:143]
  v_mfma_f32_16x16x32_bf16 v[140:143], v[172:175], a[56:59], v[140:143]
  v_mfma_f32_16x16x32_bf16 v[144:147], v[172:175], a[60:63], v[144:147]
  v_mfma_f32_16x16x32_bf16 v[144:147], v[168:171], a[44:47], v[144:147]
  v_mfma_f32_16x16x32_bf16 v[144:147], v[164:167], a[28:31], v[144:147]
  s_waitcnt lgkmcnt(0)
  v_mfma_f32_16x16x32_bf16 v[160:163], v[176:179], a[28:31], v[160:163]
  ds_read_b64_tr_b16 v[164:165], v248 offset:6144
  v_mfma_f32_16x16x32_bf16 v[160:163], v[180:183], a[44:47], v[160:163]
  ds_read_b64_tr_b16 v[166:167], v248 offset:6656
  v_mfma_f32_16x16x32_bf16 v[160:163], v[184:187], a[60:63], v[160:163]
  ds_read_b64_tr_b16 v[168:169], v248 offset:7168
  v_mfma_f32_16x16x32_bf16 v[156:159], v[184:187], a[56:59], v[156:159]
  ds_read_b64_tr_b16 v[170:171], v248 offset:7680
  v_mfma_f32_16x16x32_bf16 v[156:159], v[180:183], a[40:43], v[156:159]
  ds_read_b64_tr_b16 v[172:173], v248 offset:8192
  v_mfma_f32_16x16x32_bf16 v[156:159], v[176:179], a[24:27], v[156:159]
  ds_read_b64_tr_b16 v[174:175], v248 offset:8704
  v_mfma_f32_16x16x32_bf16 v[152:155], v[176:179], a[20:23], v[152:155]
  v_mfma_f32_16x16x32_bf16 v[152:155], v[180:183], a[36:39], v[152:155]
  v_mfma_f32_16x16x32_bf16 v[152:155], v[184:187], a[52:55], v[152:155]
  v_mfma_f32_16x16x32_bf16 v[148:151], v[184:187], a[48:51], v[148:151]
  v_mfma_f32_16x16x32_bf16 v[148:151], v[180:183], a[32:35], v[148:151]
  v_mfma_f32_16x16x32_bf16 v[148:151], v[176:179], a[16:19], v[148:151]
  s_waitcnt lgkmcnt(0)
  v_mfma_f32_16x16x32_bf16 v[132:135], v[164:167], a[64:67], v[132:135]
  global_load_dword v247, v246, s[8:9]
  v_mfma_f32_16x16x32_bf16 v[132:135], v[168:171], a[80:83], v[132:135]
  s_add_u32 s57, s32, 2654336
  ds_read_b64_tr_b16 v[176:177], v248 offset:24576
  s_add_u32 s58, s32, 2948224
  v_mfma_f32_16x16x32_bf16 v[132:135], v[172:175], a[96:99], v[132:135]
  s_add_u32 s59, s32, 3242112
  ds_read_b64_tr_b16 v[178:179], v248 offset:25088
  s_add_u32 m0, s35, 86016
  v_mfma_f32_16x16x32_bf16 v[136:139], v[172:175], a[100:103], v[136:139]
  ds_read_b64_tr_b16 v[180:181], v248 offset:25600
  v_mfma_f32_16x16x32_bf16 v[136:139], v[168:171], a[84:87], v[136:139]
  ds_read_b64_tr_b16 v[182:183], v248 offset:26112
  v_mfma_f32_16x16x32_bf16 v[136:139], v[164:167], a[68:71], v[136:139]
  ds_read_b64_tr_b16 v[184:185], v248 offset:26624
  v_mfma_f32_16x16x32_bf16 v[140:143], v[164:167], a[72:75], v[140:143]
  ds_read_b64_tr_b16 v[186:187], v248 offset:27136
  v_mfma_f32_16x16x32_bf16 v[140:143], v[168:171], a[88:91], v[140:143]
  v_mfma_f32_16x16x32_bf16 v[140:143], v[172:175], a[104:107], v[140:143]
  v_mfma_f32_16x16x32_bf16 v[144:147], v[172:175], a[108:111], v[144:147]
  v_mfma_f32_16x16x32_bf16 v[144:147], v[168:171], a[92:95], v[144:147]
  v_mfma_f32_16x16x32_bf16 v[144:147], v[164:167], a[76:79], v[144:147]
  s_waitcnt lgkmcnt(0)
  v_mfma_f32_16x16x32_bf16 v[160:163], v[176:179], a[76:79], v[160:163]
  ds_read_b64_tr_b16 v[164:165], v248 offset:9216
  v_mfma_f32_16x16x32_bf16 v[160:163], v[180:183], a[92:95], v[160:163]
  ds_read_b64_tr_b16 v[166:167], v248 offset:9728
  v_mfma_f32_16x16x32_bf16 v[160:163], v[184:187], a[108:111], v[160:163]
  ds_read_b64_tr_b16 v[168:169], v248 offset:10240
  v_mfma_f32_16x16x32_bf16 v[156:159], v[184:187], a[104:107], v[156:159]
  ds_read_b64_tr_b16 v[170:171], v248 offset:10752
  v_mfma_f32_16x16x32_bf16 v[156:159], v[180:183], a[88:91], v[156:159]
  ds_read_b64_tr_b16 v[172:173], v248 offset:11264
  v_mfma_f32_16x16x32_bf16 v[156:159], v[176:179], a[72:75], v[156:159]
  ds_read_b64_tr_b16 v[174:175], v248 offset:11776
  v_mfma_f32_16x16x32_bf16 v[152:155], v[176:179], a[68:71], v[152:155]
  v_mfma_f32_16x16x32_bf16 v[152:155], v[180:183], a[84:87], v[152:155]
  v_mfma_f32_16x16x32_bf16 v[152:155], v[184:187], a[100:103], v[152:155]
  v_mfma_f32_16x16x32_bf16 v[148:151], v[184:187], a[96:99], v[148:151]
  v_mfma_f32_16x16x32_bf16 v[148:151], v[180:183], a[80:83], v[148:151]
  v_mfma_f32_16x16x32_bf16 v[148:151], v[176:179], a[64:67], v[148:151]
  s_waitcnt lgkmcnt(0)
  v_mfma_f32_16x16x32_bf16 v[132:135], v[164:167], a[112:115], v[132:135]
  ds_read_b64_tr_b16 v[176:177], v248 offset:27648
  v_mfma_f32_16x16x32_bf16 v[132:135], v[168:171], a[128:131], v[132:135]
  ds_read_b64_tr_b16 v[178:179], v248 offset:28160
  v_mfma_f32_16x16x32_bf16 v[132:135], v[172:175], a[144:147], v[132:135]
  ds_read_b64_tr_b16 v[180:181], v248 offset:28672
  v_mfma_f32_16x16x32_bf16 v[136:139], v[172:175], a[148:151], v[136:139]
  ds_read_b64_tr_b16 v[182:183], v248 offset:29184
  v_mfma_f32_16x16x32_bf16 v[136:139], v[168:171], a[132:135], v[136:139]
  ds_read_b64_tr_b16 v[184:185], v248 offset:29696
  v_mfma_f32_16x16x32_bf16 v[136:139], v[164:167], a[116:119], v[136:139]
  ds_read_b64_tr_b16 v[186:187], v248 offset:30208
  v_mfma_f32_16x16x32_bf16 v[140:143], v[164:167], a[120:123], v[140:143]
  v_mfma_f32_16x16x32_bf16 v[140:143], v[168:171], a[136:139], v[140:143]
  v_mfma_f32_16x16x32_bf16 v[140:143], v[172:175], a[152:155], v[140:143]
  v_mfma_f32_16x16x32_bf16 v[144:147], v[172:175], a[156:159], v[144:147]
  v_mfma_f32_16x16x32_bf16 v[144:147], v[168:171], a[140:143], v[144:147]
  v_mfma_f32_16x16x32_bf16 v[144:147], v[164:167], a[124:127], v[144:147]
  s_waitcnt lgkmcnt(0)
  v_mfma_f32_16x16x32_bf16 v[160:163], v[176:179], a[124:127], v[160:163]
  ds_read_b64_tr_b16 v[164:165], v248 offset:12288
  v_mfma_f32_16x16x32_bf16 v[160:163], v[180:183], a[140:143], v[160:163]
  ds_read_b64_tr_b16 v[166:167], v248 offset:12800
  v_mfma_f32_16x16x32_bf16 v[160:163], v[184:187], a[156:159], v[160:163]
  ds_read_b64_tr_b16 v[168:169], v248 offset:13312
  v_mfma_f32_16x16x32_bf16 v[156:159], v[184:187], a[152:155], v[156:159]
  ds_read_b64_tr_b16 v[170:171], v248 offset:13824
  v_mfma_f32_16x16x32_bf16 v[156:159], v[180:183], a[136:139], v[156:159]
  ds_read_b64_tr_b16 v[172:173], v248 offset:14336
  v_mfma_f32_16x16x32_bf16 v[156:159], v[176:179], a[120:123], v[156:159]
  ds_read_b64_tr_b16 v[174:175], v248 offset:14848
  v_mfma_f32_16x16x32_bf16 v[152:155], v[176:179], a[116:119], v[152:155]
  v_mfma_f32_16x16x32_bf16 v[152:155], v[180:183], a[132:135], v[152:155]
  v_mfma_f32_16x16x32_bf16 v[152:155], v[184:187], a[148:151], v[152:155]
  v_mfma_f32_16x16x32_bf16 v[148:151], v[184:187], a[144:147], v[148:151]
  v_mfma_f32_16x16x32_bf16 v[148:151], v[180:183], a[128:131], v[148:151]
  v_mfma_f32_16x16x32_bf16 v[148:151], v[176:179], a[112:115], v[148:151]
  s_waitcnt lgkmcnt(0)
  v_mfma_f32_16x16x32_bf16 v[132:135], v[164:167], a[160:163], v[132:135]
  ds_read_b64_tr_b16 v[176:177], v248 offset:30720
  v_mfma_f32_16x16x32_bf16 v[132:135], v[168:171], a[176:179], v[132:135]
  ds_read_b64_tr_b16 v[178:179], v248 offset:31232
  v_mfma_f32_16x16x32_bf16 v[132:135], v[172:175], a[192:195], v[132:135]
  ds_read_b64_tr_b16 v[180:181], v248 offset:31744
  v_mfma_f32_16x16x32_bf16 v[136:139], v[172:175], a[196:199], v[136:139]
  ds_read_b64_tr_b16 v[182:183], v248 offset:32256
  v_mfma_f32_16x16x32_bf16 v[136:139], v[168:171], a[180:183], v[136:139]
  ds_read_b64_tr_b16 v[184:185], v248 offset:32768
  v_mfma_f32_16x16x32_bf16 v[136:139], v[164:167], a[164:167], v[136:139]
  ds_read_b64_tr_b16 v[186:187], v248 offset:33280
  v_mfma_f32_16x16x32_bf16 v[140:143], v[164:167], a[168:171], v[140:143]
  v_mfma_f32_16x16x32_bf16 v[140:143], v[168:171], a[184:187], v[140:143]
  v_mfma_f32_16x16x32_bf16 v[140:143], v[172:175], a[200:203], v[140:143]
  v_mfma_f32_16x16x32_bf16 v[144:147], v[172:175], a[204:207], v[144:147]
  v_mfma_f32_16x16x32_bf16 v[144:147], v[168:171], a[188:191], v[144:147]
  v_mfma_f32_16x16x32_bf16 v[144:147], v[164:167], a[172:175], v[144:147]
  s_waitcnt lgkmcnt(0)
  v_mfma_f32_16x16x32_bf16 v[160:163], v[176:179], a[172:175], v[160:163]
  ds_read_b64_tr_b16 v[164:165], v248 offset:15360
  v_mfma_f32_16x16x32_bf16 v[160:163], v[180:183], a[188:191], v[160:163]
  ds_read_b64_tr_b16 v[166:167], v248 offset:15872
  v_mfma_f32_16x16x32_bf16 v[160:163], v[184:187], a[204:207], v[160:163]
  ds_read_b64_tr_b16 v[168:169], v248 offset:16384
  v_mfma_f32_16x16x32_bf16 v[156:159], v[184:187], a[200:203], v[156:159]
  ds_read_b64_tr_b16 v[170:171], v248 offset:16896
  v_mfma_f32_16x16x32_bf16 v[156:159], v[180:183], a[184:187], v[156:159]
  ds_read_b64_tr_b16 v[172:173], v248 offset:17408
  v_mfma_f32_16x16x32_bf16 v[156:159], v[176:179], a[168:171], v[156:159]
  ds_read_b64_tr_b16 v[174:175], v248 offset:17920
  v_mfma_f32_16x16x32_bf16 v[152:155], v[176:179], a[164:167], v[152:155]
  v_mfma_f32_16x16x32_bf16 v[152:155], v[180:183], a[180:183], v[152:155]
  v_mfma_f32_16x16x32_bf16 v[152:155], v[184:187], a[196:199], v[152:155]
  v_mfma_f32_16x16x32_bf16 v[148:151], v[184:187], a[192:195], v[148:151]
  v_mfma_f32_16x16x32_bf16 v[148:151], v[180:183], a[176:179], v[148:151]
  v_mfma_f32_16x16x32_bf16 v[148:151], v[176:179], a[160:163], v[148:151]
  s_waitcnt lgkmcnt(0)
  v_mfma_f32_16x16x32_bf16 v[132:135], v[164:167], a[208:211], v[132:135]
  ds_read_b64_tr_b16 v[176:177], v248 offset:33792
  v_mfma_f32_16x16x32_bf16 v[132:135], v[168:171], a[224:227], v[132:135]
  ds_read_b64_tr_b16 v[178:179], v248 offset:34304
  v_mfma_f32_16x16x32_bf16 v[132:135], v[172:175], a[240:243], v[132:135]
  ds_read_b64_tr_b16 v[180:181], v248 offset:34816
  v_mfma_f32_16x16x32_bf16 v[136:139], v[172:175], a[244:247], v[136:139]
  ds_read_b64_tr_b16 v[182:183], v248 offset:35328
  v_mfma_f32_16x16x32_bf16 v[136:139], v[168:171], a[228:231], v[136:139]
  ds_read_b64_tr_b16 v[184:185], v248 offset:35840
  v_mfma_f32_16x16x32_bf16 v[136:139], v[164:167], a[212:215], v[136:139]
  ds_read_b64_tr_b16 v[186:187], v248 offset:36352
  v_mfma_f32_16x16x32_bf16 v[140:143], v[164:167], a[216:219], v[140:143]
  v_mfma_f32_16x16x32_bf16 v[140:143], v[168:171], a[232:235], v[140:143]
  v_mfma_f32_16x16x32_bf16 v[140:143], v[172:175], a[248:251], v[140:143]
  v_mfma_f32_16x16x32_bf16 v[144:147], v[172:175], a[252:255], v[144:147]
  v_mfma_f32_16x16x32_bf16 v[144:147], v[168:171], a[236:239], v[144:147]
  v_mfma_f32_16x16x32_bf16 v[144:147], v[164:167], a[220:223], v[144:147]
  s_waitcnt lgkmcnt(0) vmcnt(21)
  s_barrier
  v_mfma_f32_16x16x32_bf16 v[160:163], v[176:179], a[220:223], v[160:163]
  ds_read_b64_tr_b16 v[164:165], v240 offset:36864
  v_mfma_f32_16x16x32_bf16 v[160:163], v[180:183], a[236:239], v[160:163]
  ds_read_b64_tr_b16 v[166:167], v240 offset:43008
  v_mfma_f32_16x16x32_bf16 v[160:163], v[184:187], a[252:255], v[160:163]
  ds_read_b64_tr_b16 v[168:169], v240 offset:37888
  v_mfma_f32_16x16x32_bf16 v[156:159], v[184:187], a[248:251], v[156:159]
  ds_read_b64_tr_b16 v[170:171], v240 offset:44032
  v_mfma_f32_16x16x32_bf16 v[156:159], v[180:183], a[232:235], v[156:159]
  ds_read_b64_tr_b16 v[172:173], v240 offset:38912
  v_mfma_f32_16x16x32_bf16 v[156:159], v[176:179], a[216:219], v[156:159]
  ds_read_b64_tr_b16 v[174:175], v240 offset:45056
  v_mfma_f32_16x16x32_bf16 v[152:155], v[176:179], a[212:215], v[152:155]
  v_mfma_f32_16x16x32_bf16 v[152:155], v[180:183], a[228:231], v[152:155]
  v_mfma_f32_16x16x32_bf16 v[152:155], v[184:187], a[244:247], v[152:155]
  v_mfma_f32_16x16x32_bf16 v[148:151], v[184:187], a[240:243], v[148:151]
  v_mfma_f32_16x16x32_bf16 v[148:151], v[180:183], a[224:227], v[148:151]
  v_mfma_f32_16x16x32_bf16 v[148:151], v[176:179], a[208:211], v[148:151]
  s_waitcnt lgkmcnt(0)
  v_mfma_f32_16x16x32_bf16 v[4:7], v[164:167], v[188:191], 0
  ds_read_b64_tr_b16 v[176:177], v240 offset:49152
  v_mfma_f32_16x16x32_bf16 v[4:7], v[168:171], v[204:207], v[4:7]
  ds_read_b64_tr_b16 v[178:179], v240 offset:55296
  v_mfma_f32_16x16x32_bf16 v[4:7], v[172:175], a[0:3], v[4:7]
  ds_read_b64_tr_b16 v[180:181], v240 offset:50176
  v_mfma_f32_16x16x32_bf16 v[8:11], v[172:175], a[4:7], 0
  ds_read_b64_tr_b16 v[182:183], v240 offset:56320
  v_mfma_f32_16x16x32_bf16 v[8:11], v[168:171], v[208:211], v[8:11]
  ds_read_b64_tr_b16 v[184:185], v240 offset:51200
  v_mfma_f32_16x16x32_bf16 v[8:11], v[164:167], v[192:195], v[8:11]
  ds_read_b64_tr_b16 v[186:187], v240 offset:57344
  v_mfma_f32_16x16x32_bf16 v[12:15], v[164:167], v[196:199], 0
  v_mfma_f32_16x16x32_bf16 v[12:15], v[168:171], v[212:215], v[12:15]
  v_mul_f32 v132, v132, v148
  v_mul_f32 v133, v133, v149
  v_mfma_f32_16x16x32_bf16 v[12:15], v[172:175], a[8:11], v[12:15]
  v_mul_f32 v134, v134, v150
  v_mul_f32 v135, v135, v151
  v_mfma_f32_16x16x32_bf16 v[16:19], v[172:175], a[12:15], 0
  v_cvt_pk_bf16_f32 v220, v132, v133
  v_cvt_pk_bf16_f32 v221, v134, v135
  v_mfma_f32_16x16x32_bf16 v[16:19], v[168:171], v[216:219], v[16:19]
  buffer_store_dwordx2 v[220:221], v253, s[28:31], s38 offen offset:0 sc1
  v_mfma_f32_16x16x32_bf16 v[16:19], v[164:167], v[200:203], v[16:19]
  s_waitcnt lgkmcnt(0)
  v_mul_f32 v136, v136, v152
  v_mul_f32 v137, v137, v153
  v_mfma_f32_16x16x32_bf16 v[32:35], v[176:179], v[200:203], 0
  ds_read_b64_tr_b16 v[164:165], v241 offset:36864
  v_mul_f32 v138, v138, v154
  v_mfma_f32_16x16x32_bf16 v[32:35], v[180:183], v[216:219], v[32:35]
  ds_read_b64_tr_b16 v[166:167], v241 offset:43008
  v_mul_f32 v139, v139, v155
  v_mfma_f32_16x16x32_bf16 v[32:35], v[184:187], a[12:15], v[32:35]
  ds_read_b64_tr_b16 v[168:169], v241 offset:37888
  v_cvt_pk_bf16_f32 v224, v136, v137
  v_mfma_f32_16x16x32_bf16 v[28:31], v[184:187], a[8:11], 0
  ds_read_b64_tr_b16 v[170:171], v241 offset:44032
  v_cvt_pk_bf16_f32 v225, v138, v139
  v_mfma_f32_16x16x32_bf16 v[28:31], v[180:183], v[212:215], v[28:31]
  buffer_store_dwordx2 v[224:225], v253, s[28:31], s38 offen offset:1024 sc1
  v_mfma_f32_16x16x32_bf16 v[28:31], v[176:179], v[196:199], v[28:31]
  ds_read_b64_tr_b16 v[172:173], v241 offset:38912
  v_mul_f32 v140, v140, v156
  v_mfma_f32_16x16x32_bf16 v[24:27], v[176:179], v[192:195], 0
  ds_read_b64_tr_b16 v[174:175], v241 offset:45056
  v_mul_f32 v141, v141, v157
  v_mfma_f32_16x16x32_bf16 v[24:27], v[180:183], v[208:211], v[24:27]
  v_mul_f32 v142, v142, v158
  v_mul_f32 v143, v143, v159
  v_mfma_f32_16x16x32_bf16 v[24:27], v[184:187], a[4:7], v[24:27]
  v_cvt_pk_bf16_f32 v228, v140, v141
  v_cvt_pk_bf16_f32 v229, v142, v143
  v_mfma_f32_16x16x32_bf16 v[20:23], v[184:187], a[0:3], 0
  v_mfma_f32_16x16x32_bf16 v[20:23], v[180:183], v[204:207], v[20:23]
  buffer_store_dwordx2 v[228:229], v253, s[28:31], s38 offen offset:2048 sc1
  v_mfma_f32_16x16x32_bf16 v[20:23], v[176:179], v[188:191], v[20:23]
  s_waitcnt lgkmcnt(0)
  v_mul_f32 v144, v144, v160
  v_mul_f32 v145, v145, v161
  v_mfma_f32_16x16x32_bf16 v[36:39], v[164:167], v[188:191], 0
  ds_read_b64_tr_b16 v[176:177], v241 offset:49152
  v_mul_f32 v146, v146, v162
  v_mfma_f32_16x16x32_bf16 v[36:39], v[168:171], v[204:207], v[36:39]
  ds_read_b64_tr_b16 v[178:179], v241 offset:55296
  v_mul_f32 v147, v147, v163
  v_mfma_f32_16x16x32_bf16 v[36:39], v[172:175], a[0:3], v[36:39]
  ds_read_b64_tr_b16 v[180:181], v241 offset:50176
  v_cvt_pk_bf16_f32 v232, v144, v145
  v_mfma_f32_16x16x32_bf16 v[40:43], v[172:175], a[4:7], 0
  ds_read_b64_tr_b16 v[182:183], v241 offset:56320
  v_cvt_pk_bf16_f32 v233, v146, v147
  v_mfma_f32_16x16x32_bf16 v[40:43], v[168:171], v[208:211], v[40:43]
  buffer_store_dwordx2 v[232:233], v253, s[28:31], s38 offen offset:3072 sc1
  v_mfma_f32_16x16x32_bf16 v[40:43], v[164:167], v[192:195], v[40:43]
  ds_read_b64_tr_b16 v[184:185], v241 offset:51200
  v_mfma_f32_16x16x32_bf16 v[44:47], v[164:167], v[196:199], 0
  ds_read_b64_tr_b16 v[186:187], v241 offset:57344
  v_mfma_f32_16x16x32_bf16 v[44:47], v[168:171], v[212:215], v[44:47]
  v_mfma_f32_16x16x32_bf16 v[44:47], v[172:175], a[8:11], v[44:47]
  v_mfma_f32_16x16x32_bf16 v[48:51], v[172:175], a[12:15], 0
L_hop8:
  s_cbranch_execz L_main
  v_mfma_f32_16x16x32_bf16 v[48:51], v[168:171], v[216:219], v[48:51]
  v_mfma_f32_16x16x32_bf16 v[48:51], v[164:167], v[200:203], v[48:51]
  s_waitcnt lgkmcnt(0)
  v_mfma_f32_16x16x32_bf16 v[64:67], v[176:179], v[200:203], 0
  ds_read_b64_tr_b16 v[164:165], v242 offset:36864
  v_mfma_f32_16x16x32_bf16 v[64:67], v[180:183], v[216:219], v[64:67]
  ds_read_b64_tr_b16 v[166:167], v242 offset:43008
  v_mfma_f32_16x16x32_bf16 v[64:67], v[184:187], a[12:15], v[64:67]
  ds_read_b64_tr_b16 v[168:169], v242 offset:37888
  v_mfma_f32_16x16x32_bf16 v[60:63], v[184:187], a[8:11], 0
  ds_read_b64_tr_b16 v[170:171], v242 offset:44032
  v_mfma_f32_16x16x32_bf16 v[60:63], v[180:183], v[212:215], v[60:63]
  ds_read_b64_tr_b16 v[172:173], v242 offset:38912
  v_mfma_f32_16x16x32_bf16 v[60:63], v[176:179], v[196:199], v[60:63]
  ds_read_b64_tr_b16 v[174:175], v242 offset:45056
  v_mfma_f32_16x16x32_bf16 v[56:59], v[176:179], v[192:195], 0
  v_mfma_f32_16x16x32_bf16 v[56:59], v[180:183], v[208:211], v[56:59]
  v_mfma_f32_16x16x32_bf16 v[56:59], v[184:187], a[4:7], v[56:59]
  v_mfma_f32_16x16x32_bf16 v[52:55], v[184:187], a[0:3], 0
  v_mfma_f32_16x16x32_bf16 v[52:55], v[180:183], v[204:207], v[52:55]
  v_mfma_f32_16x16x32_bf16 v[52:55], v[176:179], v[188:191], v[52:55]
  s_waitcnt lgkmcnt(0)
  v_mfma_f32_16x16x32_bf16 v[68:71], v[164:167], v[188:191], 0
  ds_read_b64_tr_b16 v[176:177], v242 offset:49152
  v_mfma_f32_16x16x32_bf16 v[68:71], v[168:171], v[204:207], v[68:71]
  buffer_load_dwordx4 v249, s[12:15], s57 offen offset:0  lds
  v_mfma_f32_16x16x32_bf16 v[68:71], v[172:175], a[0:3], v[68:71]
  ds_read_b64_tr_b16 v[178:179], v242 offset:55296
  v_mfma_f32_16x16x32_bf16 v[72:75], v[172:175], a[4:7], 0
  ds_read_b64_tr_b16 v[180:181], v242 offset:50176
  v_mfma_f32_16x16x32_bf16 v[72:75], v[168:171], v[208:211], v[72:75]
  ds_read_b64_tr_b16 v[182:183], v242 offset:56320
  v_mfma_f32_16x16x32_bf16 v[72:75], v[164:167], v[192:195], v[72:75]
  ds_read_b64_tr_b16 v[184:185], v242 offset:51200
  v_mfma_f32_16x16x32_bf16 v[76:79], v[164:167], v[196:199], 0
  buffer_load_dwordx4 v249, s[12:15], s58 offen offset:1024  lds
  v_mfma_f32_16x16x32_bf16 v[76:79], v[168:171], v[212:215], v[76:79]
  ds_read_b64_tr_b16 v[186:187], v242 offset:57344
  v_mfma_f32_16x16x32_bf16 v[76:79], v[172:175], a[8:11], v[76:79]
  v_mfma_f32_16x16x32_bf16 v[80:83], v[172:175], a[12:15], 0
  v_mfma_f32_16x16x32_bf16 v[80:83], v[168:171], v[216:219], v[80:83]
  v_mfma_f32_16x16x32_bf16 v[80:83], v[164:167], v[200:203], v[80:83]
  s_waitcnt lgkmcnt(0)
  v_mfma_f32_16x16x32_bf16 v[96:99], v[176:179], v[200:203], 0
  buffer_load_dwordx4 v249, s[12:15], s59 offen offset:2048  lds
  v_mfma_f32_16x16x32_bf16 v[96:99], v[180:183], v[216:219], v[96:99]
  s_add_u32 m0, s35, 98304
  ds_read_b64_tr_b16 v[164:165], v243 offset:36864
  v_mfma_f32_16x16x32_bf16 v[96:99], v[184:187], a[12:15], v[96:99]
  ds_read_b64_tr_b16 v[166:167], v243 offset:43008
  v_mfma_f32_16x16x32_bf16 v[92:95], v[184:187], a[8:11], 0
  ds_read_b64_tr_b16 v[168:169], v243 offset:37888
  v_mfma_f32_16x16x32_bf16 v[92:95], v[180:183], v[212:215], v[92:95]
  buffer_load_dwordx4 v249, s[16:19], s57 offen offset:0  lds
  v_mfma_f32_16x16x32_bf16 v[92:95], v[176:179], v[196:199], v[92:95]
  ds_read_b64_tr_b16 v[170:171], v243 offset:44032
  v_mfma_f32_16x16x32_bf16 v[88:91], v[176:179], v[192:195], 0
  ds_read_b64_tr_b16 v[172:173], v243 offset:38912
  v_mfma_f32_16x16x32_bf16 v[88:91], v[180:183], v[208:211], v[88:91]
  ds_read_b64_tr_b16 v[174:175], v243 offset:45056
  v_mfma_f32_16x16x32_bf16 v[88:91], v[184:187], a[4:7], v[88:91]
  v_mfma_f32_16x16x32_bf16 v[84:87], v[184:187], a[0:3], 0
  buffer_load_dwordx4 v249, s[16:19], s58 offen offset:1024  lds
  v_mfma_f32_16x16x32_bf16 v[84:87], v[180:183], v[204:207], v[84:87]
  v_mfma_f32_16x16x32_bf16 v[84:87], v[176:179], v[188:191], v[84:87]
  s_waitcnt lgkmcnt(0)
  v_mfma_f32_16x16x32_bf16 v[100:103], v[164:167], v[188:191], 0
  ds_read_b64_tr_b16 v[176:177], v243 offset:49152
  v_mfma_f32_16x16x32_bf16 v[100:103], v[168:171], v[204:207], v[100:103]
  ds_read_b64_tr_b16 v[178:179], v243 offset:55296
  v_mfma_f32_16x16x32_bf16 v[100:103], v[172:175], a[0:3], v[100:103]
  buffer_load_dwordx4 v249, s[16:19], s59 offen offset:2048  lds
  v_mfma_f32_16x16x32_bf16 v[104:107], v[172:175], a[4:7], 0
  s_add_u32 s57, s32, 3539072
  ds_read_b64_tr_b16 v[180:181], v243 offset:50176
  s_add_u32 s58, s32, 3832960
  v_mfma_f32_16x16x32_bf16 v[104:107], v[168:171], v[208:211], v[104:107]
  s_add_u32 s59, s32, 4126848
  ds_read_b64_tr_b16 v[182:183], v243 offset:56320
  s_add_u32 m0, s35, 110592
  v_mfma_f32_16x16x32_bf16 v[104:107], v[164:167], v[192:195], v[104:107]
  ds_read_b64_tr_b16 v[184:185], v243 offset:51200
  v_mfma_f32_16x16x32_bf16 v[108:111], v[164:167], v[196:199], 0
  ds_read_b64_tr_b16 v[186:187], v243 offset:57344
  v_mfma_f32_16x16x32_bf16 v[108:111], v[168:171], v[212:215], v[108:111]
  buffer_load_dwordx4 v249, s[12:15], s57 offen offset:0  lds
  v_mfma_f32_16x16x32_bf16 v[108:111], v[172:175], a[8:11], v[108:111]
  v_mfma_f32_16x16x32_bf16 v[112:115], v[172:175], a[12:15], 0
  v_mfma_f32_16x16x32_bf16 v[112:115], v[168:171], v[216:219], v[112:115]
  v_mfma_f32_16x16x32_bf16 v[112:115], v[164:167], v[200:203], v[112:115]
  s_waitcnt lgkmcnt(0) vmcnt(26)
  s_barrier
  v_mfma_f32_16x16x32_bf16 v[128:131], v[176:179], v[200:203], 0
  buffer_load_dwordx4 v249, s[12:15], s58 offen offset:1024  lds
  v_mfma_f32_16x16x32_bf16 v[128:131], v[180:183], v[216:219], v[128:131]
  ds_read_b64_tr_b16 v[164:165], v236 offset:0
  v_mfma_f32_16x16x32_bf16 v[128:131], v[184:187], a[12:15], v[128:131]
  ds_read_b64_tr_b16 v[166:167], v236 offset:6144
  v_mfma_f32_16x16x32_bf16 v[124:127], v[184:187], a[8:11], 0
  ds_read_b64_tr_b16 v[168:169], v236 offset:1024
  v_mfma_f32_16x16x32_bf16 v[124:127], v[180:183], v[212:215], v[124:127]
  ds_read_b64_tr_b16 v[170:171], v236 offset:7168
  v_mfma_f32_16x16x32_bf16 v[124:127], v[176:179], v[196:199], v[124:127]
  buffer_load_dwordx4 v249, s[12:15], s59 offen offset:2048  lds
  v_mfma_f32_16x16x32_bf16 v[120:123], v[176:179], v[192:195], 0
  s_add_u32 m0, s35, 122880
  ds_read_b64_tr_b16 v[172:173], v236 offset:2048
  v_mfma_f32_16x16x32_bf16 v[120:123], v[180:183], v[208:211], v[120:123]
  ds_read_b64_tr_b16 v[174:175], v236 offset:8192
  v_mfma_f32_16x16x32_bf16 v[120:123], v[184:187], a[4:7], v[120:123]
  v_mfma_f32_16x16x32_bf16 v[116:119], v[184:187], a[0:3], 0
  v_mfma_f32_16x16x32_bf16 v[116:119], v[180:183], v[204:207], v[116:119]
  buffer_load_dwordx4 v249, s[16:19], s57 offen offset:0  lds
  v_mfma_f32_16x16x32_bf16 v[116:119], v[176:179], v[188:191], v[116:119]
  s_waitcnt lgkmcnt(0)
  v_mfma_f32_16x16x32_bf16 v[4:7], v[164:167], a[16:19], v[4:7]
  ds_read_b64_tr_b16 v[176:177], v236 offset:12288
  v_mfma_f32_16x16x32_bf16 v[4:7], v[168:171], a[32:35], v[4:7]
  ds_read_b64_tr_b16 v[178:179], v236 offset:18432
  v_mfma_f32_16x16x32_bf16 v[4:7], v[172:175], a[48:51], v[4:7]
  ds_read_b64_tr_b16 v[180:181], v236 offset:13312
  v_mfma_f32_16x16x32_bf16 v[8:11], v[172:175], a[52:55], v[8:11]
  buffer_load_dwordx4 v249, s[16:19], s58 offen offset:1024  lds
  v_mfma_f32_16x16x32_bf16 v[8:11], v[168:171], a[36:39], v[8:11]
  ds_read_b64_tr_b16 v[182:183], v236 offset:19456
  v_mfma_f32_16x16x32_bf16 v[8:11], v[164:167], a[20:23], v[8:11]
  ds_read_b64_tr_b16 v[184:185], v236 offset:14336
  v_mfma_f32_16x16x32_bf16 v[12:15], v[164:167], a[24:27], v[12:15]
  ds_read_b64_tr_b16 v[186:187], v236 offset:20480
  v_mfma_f32_16x16x32_bf16 v[12:15], v[168:171], a[40:43], v[12:15]
  v_mfma_f32_16x16x32_bf16 v[12:15], v[172:175], a[56:59], v[12:15]
  buffer_load_dwordx4 v249, s[16:19], s59 offen offset:2048  lds
  v_mfma_f32_16x16x32_bf16 v[16:19], v[172:175], a[60:63], v[16:19]
  v_mfma_f32_16x16x32_bf16 v[16:19], v[168:171], a[44:47], v[16:19]
  v_mfma_f32_16x16x32_bf16 v[16:19], v[164:167], a[28:31], v[16:19]
  s_waitcnt lgkmcnt(0)
  v_mfma_f32_16x16x32_bf16 v[32:35], v[176:179], a[28:31], v[32:35]
  ds_read_b64_tr_b16 v[164:165], v237 offset:0
  v_mfma_f32_16x16x32_bf16 v[32:35], v[180:183], a[44:47], v[32:35]
  ds_read_b64_tr_b16 v[166:167], v237 offset:6144
  v_mfma_f32_16x16x32_bf16 v[32:35], v[184:187], a[60:63], v[32:35]
  ds_read_b64_tr_b16 v[168:169], v237 offset:1024
  v_mfma_f32_16x16x32_bf16 v[28:31], v[184:187], a[56:59], v[28:31]
  ds_read_b64_tr_b16 v[170:171], v237 offset:7168
  v_mfma_f32_16x16x32_bf16 v[28:31], v[180:183], a[40:43], v[28:31]
  s_waitcnt vmcnt(12)
  buffer_atomic_add v0, v254, s[28:31], s42 offen offset:0 sc1
  v_mfma_f32_16x16x32_bf16 v[28:31], v[176:179], a[24:27], v[28:31]
  s_add_u32 s57, s32, 4423808
  ds_read_b64_tr_b16 v[172:173], v237 offset:2048
  s_add_u32 s58, s32, 4717696
  v_mfma_f32_16x16x32_bf16 v[24:27], v[176:179], a[20:23], v[24:27]
  s_add_u32 s59, s32, 5011584
  ds_read_b64_tr_b16 v[174:175], v237 offset:8192
  s_add_u32 m0, s35, 135168
  v_mfma_f32_16x16x32_bf16 v[24:27], v[180:183], a[36:39], v[24:27]
  v_mfma_f32_16x16x32_bf16 v[24:27], v[184:187], a[52:55], v[24:27]
  buffer_load_dwordx4 v249, s[12:15], s57 offen offset:0  lds
  v_mfma_f32_16x16x32_bf16 v[20:23], v[184:187], a[48:51], v[20:23]
  v_mfma_f32_16x16x32_bf16 v[20:23], v[180:183], a[32:35], v[20:23]
  v_mfma_f32_16x16x32_bf16 v[20:23], v[176:179], a[16:19], v[20:23]
  s_waitcnt lgkmcnt(0)
  v_mfma_f32_16x16x32_bf16 v[36:39], v[164:167], a[16:19], v[36:39]
  buffer_load_dwordx4 v249, s[12:15], s58 offen offset:1024  lds
  v_mfma_f32_16x16x32_bf16 v[36:39], v[168:171], a[32:35], v[36:39]
  ds_read_b64_tr_b16 v[176:177], v237 offset:12288
  v_mfma_f32_16x16x32_bf16 v[36:39], v[172:175], a[48:51], v[36:39]
  ds_read_b64_tr_b16 v[178:179], v237 offset:18432
  v_mfma_f32_16x16x32_bf16 v[40:43], v[172:175], a[52:55], v[40:43]
  ds_read_b64_tr_b16 v[180:181], v237 offset:13312
  v_mfma_f32_16x16x32_bf16 v[40:43], v[168:171], a[36:39], v[40:43]
  buffer_load_dwordx4 v249, s[12:15], s59 offen offset:2048  lds
  v_mfma_f32_16x16x32_bf16 v[40:43], v[164:167], a[20:23], v[40:43]
  s_add_u32 m0, s35, 147456
  ds_read_b64_tr_b16 v[182:183], v237 offset:19456
  v_mfma_f32_16x16x32_bf16 v[44:47], v[164:167], a[24:27], v[44:47]
  ds_read_b64_tr_b16 v[184:185], v237 offset:14336
  v_mfma_f32_16x16x32_bf16 v[44:47], v[168:171], a[40:43], v[44:47]
  ds_read_b64_tr_b16 v[186:187], v237 offset:20480
  v_mfma_f32_16x16x32_bf16 v[44:47], v[172:175], a[56:59], v[44:47]
  buffer_load_dwordx4 v249, s[16:19], s57 offen offset:0  lds
  v_mfma_f32_16x16x32_bf16 v[48:51], v[172:175], a[60:63], v[48:51]
  v_mfma_f32_16x16x32_bf16 v[48:51], v[168:171], a[44:47], v[48:51]
  v_mfma_f32_16x16x32_bf16 v[48:51], v[164:167], a[28:31], v[48:51]
  s_waitcnt lgkmcnt(0)
  v_mfma_f32_16x16x32_bf16 v[64:67], v[176:179], a[28:31], v[64:67]
  buffer_load_dwordx4 v249, s[16:19], s58 offen offset:1024  lds
  v_mfma_f32_16x16x32_bf16 v[64:67], v[180:183], a[44:47], v[64:67]
  ds_read_b64_tr_b16 v[164:165], v238 offset:0
  v_mfma_f32_16x16x32_bf16 v[64:67], v[184:187], a[60:63], v[64:67]
  ds_read_b64_tr_b16 v[166:167], v238 offset:6144
  v_mfma_f32_16x16x32_bf16 v[60:63], v[184:187], a[56:59], v[60:63]
  ds_read_b64_tr_b16 v[168:169], v238 offset:1024
  v_mfma_f32_16x16x32_bf16 v[60:63], v[180:183], a[40:43], v[60:63]
  ds_read_b64_tr_b16 v[170:171], v238 offset:7168
  v_mfma_f32_16x16x32_bf16 v[60:63], v[176:179], a[24:27], v[60:63]
  buffer_load_dwordx4 v249, s[16:19], s59 offen offset:2048  lds
  v_mfma_f32_16x16x32_bf16 v[56:59], v[176:179], a[20:23], v[56:59]
  ds_read_b64_tr_b16 v[172:173], v238 offset:2048
  v_mfma_f32_16x16x32_bf16 v[56:59], v[180:183], a[36:39], v[56:59]
  ds_read_b64_tr_b16 v[174:175], v238 offset:8192
  v_mfma_f32_16x16x32_bf16 v[56:59], v[184:187], a[52:55], v[56:59]
  s_mul_i32 s57, s3, 5120
  s_min_u32 s57, s57, 13312
  v_mfma_f32_16x16x32_bf16 v[52:55], v[184:187], a[48:51], v[52:55]
  s_add_u32 s41, s41, s57
  s_add_u32 s34, s57, 0
  s_add_u32 m0, s34, 0
  v_mfma_f32_16x16x32_bf16 v[52:55], v[180:183], a[32:35], v[52:55]
  s_add_u32 s57, s41, 0
  v_mfma_f32_16x16x32_bf16 v[52:55], v[176:179], a[16:19], v[52:55]
  s_waitcnt lgkmcnt(0)
  v_mfma_f32_16x16x32_bf16 v[68:71], v[164:167], a[16:19], v[68:71]
  buffer_load_dwordx4 v252, s[28:31], s57 offen offset:0 sc1 lds
  v_mfma_f32_16x16x32_bf16 v[68:71], v[168:171], a[32:35], v[68:71]
  ds_read_b64_tr_b16 v[176:177], v238 offset:12288
  v_mfma_f32_16x16x32_bf16 v[68:71], v[172:175], a[48:51], v[68:71]
  ds_read_b64_tr_b16 v[178:179], v238 offset:18432
  v_mfma_f32_16x16x32_bf16 v[72:75], v[172:175], a[52:55], v[72:75]
  ds_read_b64_tr_b16 v[180:181], v238 offset:13312
  v_mfma_f32_16x16x32_bf16 v[72:75], v[168:171], a[36:39], v[72:75]
  buffer_load_dwordx4 v252, s[28:31], s57 offen offset:1024 sc1 lds
  v_mfma_f32_16x16x32_bf16 v[72:75], v[164:167], a[20:23], v[72:75]
  ds_read_b64_tr_b16 v[182:183], v238 offset:19456
  v_mfma_f32_16x16x32_bf16 v[76:79], v[164:167], a[24:27], v[76:79]
  ds_read_b64_tr_b16 v[184:185], v238 offset:14336
  v_mfma_f32_16x16x32_bf16 v[76:79], v[168:171], a[40:43], v[76:79]
  ds_read_b64_tr_b16 v[186:187], v238 offset:20480
  v_mfma_f32_16x16x32_bf16 v[76:79], v[172:175], a[56:59], v[76:79]
  buffer_load_dwordx4 v252, s[28:31], s57 offen offset:2048 sc1 lds
  v_mfma_f32_16x16x32_bf16 v[80:83], v[172:175], a[60:63], v[80:83]
  v_mfma_f32_16x16x32_bf16 v[80:83], v[168:171], a[44:47], v[80:83]
  v_mfma_f32_16x16x32_bf16 v[80:83], v[164:167], a[28:31], v[80:83]
  s_waitcnt lgkmcnt(0)
  v_mfma_f32_16x16x32_bf16 v[96:99], v[176:179], a[28:31], v[96:99]
  ds_read_b64_tr_b16 v[164:165], v239 offset:0
  v_mfma_f32_16x16x32_bf16 v[96:99], v[180:183], a[44:47], v[96:99]
  buffer_load_dwordx4 v252, s[28:31], s57 offen offset:3072 sc1 lds
  v_mfma_f32_16x16x32_bf16 v[96:99], v[184:187], a[60:63], v[96:99]
  s_add_u32 m0, s34, 4096
  ds_read_b64_tr_b16 v[166:167], v239 offset:6144
  s_add_u32 s57, s41, 4096
  v_mfma_f32_16x16x32_bf16 v[92:95], v[184:187], a[56:59], v[92:95]
  ds_read_b64_tr_b16 v[168:169], v239 offset:1024
  v_mfma_f32_16x16x32_bf16 v[92:95], v[180:183], a[40:43], v[92:95]
  ds_read_b64_tr_b16 v[170:171], v239 offset:7168
  v_mfma_f32_16x16x32_bf16 v[92:95], v[176:179], a[24:27], v[92:95]
  ds_read_b64_tr_b16 v[172:173], v239 offset:2048
  v_mfma_f32_16x16x32_bf16 v[88:91], v[176:179], a[20:23], v[88:91]
  buffer_load_dwordx4 v252, s[28:31], s57 offen offset:0 sc1 lds
  v_mfma_f32_16x16x32_bf16 v[88:91], v[180:183], a[36:39], v[88:91]
  ds_read_b64_tr_b16 v[174:175], v239 offset:8192
  v_mov_b32 v255, 0
  v_mfma_f32_16x16x32_bf16 v[88:91], v[184:187], a[52:55], v[88:91]
  v_mfma_f32_16x16x32_bf16 v[84:87], v[184:187], a[48:51], v[84:87]
  v_mfma_f32_16x16x32_bf16 v[84:87], v[180:183], a[32:35], v[84:87]
  v_mfma_f32_16x16x32_bf16 v[84:87], v[176:179], a[16:19], v[84:87]
  s_waitcnt lgkmcnt(0)
  v_mfma_f32_16x16x32_bf16 v[100:103], v[164:167], a[16:19], v[100:103]
  buffer_atomic_add v255, v254, s[28:31], s42 offen offset:0 sc0 sc1
  v_mfma_f32_16x16x32_bf16 v[100:103], v[168:171], a[32:35], v[100:103]
  s_add_u32 m0, s35, 36864
  ds_read_b64_tr_b16 v[176:177], v239 offset:12288
  s_add_u32 s57, s40, 0
  v_mfma_f32_16x16x32_bf16 v[100:103], v[172:175], a[48:51], v[100:103]
  ds_read_b64_tr_b16 v[178:179], v239 offset:18432
  v_mfma_f32_16x16x32_bf16 v[104:107], v[172:175], a[52:55], v[104:107]
  ds_read_b64_tr_b16 v[180:181], v239 offset:13312
  v_mfma_f32_16x16x32_bf16 v[104:107], v[168:171], a[36:39], v[104:107]
  ds_read_b64_tr_b16 v[182:183], v239 offset:19456
  v_mfma_f32_16x16x32_bf16 v[104:107], v[164:167], a[20:23], v[104:107]
  ds_read_b64_tr_b16 v[184:185], v239 offset:14336
  v_mfma_f32_16x16x32_bf16 v[108:111], v[164:167], a[24:27], v[108:111]
  ds_read_b64_tr_b16 v[186:187], v239 offset:20480
  v_mfma_f32_16x16x32_bf16 v[108:111], v[168:171], a[40:43], v[108:111]
  v_mfma_f32_16x16x32_bf16 v[108:111], v[172:175], a[56:59], v[108:111]
  v_mfma_f32_16x16x32_bf16 v[112:115], v[172:175], a[60:63], v[112:115]
  v_mfma_f32_16x16x32_bf16 v[112:115], v[168:171], a[44:47], v[112:115]
  v_mfma_f32_16x16x32_bf16 v[112:115], v[164:167], a[28:31], v[112:115]
  s_waitcnt lgkmcnt(0)
  s_barrier
  v_mfma_f32_16x16x32_bf16 v[128:131], v[176:179], a[28:31], v[128:131]
  buffer_load_dwordx4 v250, s[20:23], s57 offen offset:0  lds
  v_mfma_f32_16x16x32_bf16 v[128:131], v[180:183], a[44:47], v[128:131]
  s_add_u32 s57, s40, 35840
  ds_read_b64_tr_b16 v[164:165], v236 offset:24576
  v_mfma_f32_16x16x32_bf16 v[128:131], v[184:187], a[60:63], v[128:131]
  ds_read_b64_tr_b16 v[166:167], v236 offset:30720
  v_mfma_f32_16x16x32_bf16 v[124:127], v[184:187], a[56:59], v[124:127]
  ds_read_b64_tr_b16 v[168:169], v236 offset:25600
  v_mfma_f32_16x16x32_bf16 v[124:127], v[180:183], a[40:43], v[124:127]
  ds_read_b64_tr_b16 v[170:171], v236 offset:31744
  v_mfma_f32_16x16x32_bf16 v[124:127], v[176:179], a[24:27], v[124:127]
  buffer_load_dwordx4 v250, s[20:23], s57 offen offset:1024  lds
  v_mfma_f32_16x16x32_bf16 v[120:123], v[176:179], a[20:23], v[120:123]
  s_add_u32 s57, s40, 145408
  ds_read_b64_tr_b16 v[172:173], v236 offset:26624
  v_mfma_f32_16x16x32_bf16 v[120:123], v[180:183], a[36:39], v[120:123]
  ds_read_b64_tr_b16 v[174:175], v236 offset:32768
  v_mfma_f32_16x16x32_bf16 v[120:123], v[184:187], a[52:55], v[120:123]
  v_mfma_f32_16x16x32_bf16 v[116:119], v[184:187], a[48:51], v[116:119]
  v_mfma_f32_16x16x32_bf16 v[116:119], v[180:183], a[32:35], v[116:119]
  buffer_load_dwordx4 v250, s[20:23], s57 offen offset:2048  lds
  v_mfma_f32_16x16x32_bf16 v[116:119], v[176:179], a[16:19], v[116:119]
  s_waitcnt lgkmcnt(0)
  s_lshl_b32 s61, s66, 2
  s_add_u32 s61, s61, s65
  v_mfma_f32_16x16x32_bf16 v[4:7], v[164:167], a[64:67], v[4:7]
  s_lshl_b32 s61, s61, 2
  ds_read_b64_tr_b16 v[176:177], v236 offset:36864
  s_add_u32 s61, s61, s3
  v_mfma_f32_16x16x32_bf16 v[4:7], v[168:171], a[80:83], v[4:7]
  s_mul_i32 s61, s61, 163840
  ds_read_b64_tr_b16 v[178:179], v236 offset:43008
  s_add_u32 s76, s61, 25165824
  v_mfma_f32_16x16x32_bf16 v[4:7], v[172:175], a[96:99], v[4:7]
  s_mul_i32 s61, s64, 2560
  ds_read_b64_tr_b16 v[180:181], v236 offset:37888
  s_add_u32 s44, s76, s61
  v_mfma_f32_16x16x32_bf16 v[8:11], v[172:175], a[100:103], v[8:11]
  s_lshl_b32 s61, s61, 3
  ds_read_b64_tr_b16 v[182:183], v236 offset:44032
  s_add_u32 s76, s76, s61
  v_mfma_f32_16x16x32_bf16 v[8:11], v[168:171], a[84:87], v[8:11]
  s_lshr_b32 s79, s64, 2
  ds_read_b64_tr_b16 v[184:185], v236 offset:38912
  s_mul_i32 s72, s79, 81920
  v_mfma_f32_16x16x32_bf16 v[8:11], v[164:167], a[68:71], v[8:11]
  s_sub_u32 s71, 81920, s72
  ds_read_b64_tr_b16 v[186:187], v236 offset:45056
  s_lshr_b32 s61, s3, 1
  v_mfma_f32_16x16x32_bf16 v[12:15], v[164:167], a[72:75], v[12:15]
  s_mul_i32 s73, s61, 81920
  s_lshl_b32 s77, s79, 7
  s_add_u32 s77, s77, s43
  v_mfma_f32_16x16x32_bf16 v[12:15], v[168:171], a[88:91], v[12:15]
  s_and_b32 s78, s64, 3
  s_xor_b32 s61, s78, 3
  s_mul_i32 s61, s61, 20480
  v_mfma_f32_16x16x32_bf16 v[12:15], v[172:175], a[104:107], v[12:15]
  s_add_u32 s67, s61, s44
  s_xor_b32 s61, s78, 2
  s_mul_i32 s61, s61, 20480
  v_mfma_f32_16x16x32_bf16 v[16:19], v[172:175], a[108:111], v[16:19]
  s_add_u32 s68, s61, s44
  s_xor_b32 s61, s78, 1
  s_mul_i32 s61, s61, 20480
  v_mfma_f32_16x16x32_bf16 v[16:19], v[168:171], a[92:95], v[16:19]
  s_add_u32 s69, s61, s44
  s_xor_b32 s61, s78, 0
  s_mul_i32 s61, s61, 20480
  v_mfma_f32_16x16x32_bf16 v[16:19], v[164:167], a[76:79], v[16:19]
  s_waitcnt lgkmcnt(0)
  s_add_u32 s70, s61, s44
  s_lshl_b32 s61, s66, 4
  v_mfma_f32_16x16x32_bf16 v[32:35], v[176:179], a[76:79], v[32:35]
  s_add_u32 s78, s78, s61
  ds_read_b64_tr_b16 v[164:165], v237 offset:24576
  s_lshl_b32 s61, s3, 2
  v_mfma_f32_16x16x32_bf16 v[32:35], v[180:183], a[92:95], v[32:35]
  s_add_u32 s78, s78, s61
  ds_read_b64_tr_b16 v[166:167], v237 offset:30720
  s_add_u32 m0, s35, 49152
  v_mfma_f32_16x16x32_bf16 v[32:35], v[184:187], a[108:111], v[32:35]
  s_add_u32 s57, s40, 184320
  ds_read_b64_tr_b16 v[168:169], v237 offset:25600
  v_mfma_f32_16x16x32_bf16 v[28:31], v[184:187], a[104:107], v[28:31]
  buffer_load_dwordx4 v250, s[20:23], s57 offen offset:0  lds
  v_mfma_f32_16x16x32_bf16 v[28:31], v[180:183], a[88:91], v[28:31]
  s_add_u32 s57, s40, 293888
  ds_read_b64_tr_b16 v[170:171], v237 offset:31744
  v_mfma_f32_16x16x32_bf16 v[28:31], v[176:179], a[72:75], v[28:31]
  ds_read_b64_tr_b16 v[172:173], v237 offset:26624
  v_mfma_f32_16x16x32_bf16 v[24:27], v[176:179], a[68:71], v[24:27]
  ds_read_b64_tr_b16 v[174:175], v237 offset:32768
  v_mfma_f32_16x16x32_bf16 v[24:27], v[180:183], a[84:87], v[24:27]
  buffer_load_dwordx4 v250, s[20:23], s57 offen offset:1024  lds
  v_mfma_f32_16x16x32_bf16 v[24:27], v[184:187], a[100:103], v[24:27]
  s_add_u32 s57, s40, 329728
  v_mfma_f32_16x16x32_bf16 v[20:23], v[184:187], a[96:99], v[20:23]
  v_mfma_f32_16x16x32_bf16 v[20:23], v[180:183], a[80:83], v[20:23]
  v_mfma_f32_16x16x32_bf16 v[20:23], v[176:179], a[64:67], v[20:23]
  s_waitcnt lgkmcnt(0)
  v_mfma_f32_16x16x32_bf16 v[36:39], v[164:167], a[64:67], v[36:39]
  buffer_load_dwordx4 v250, s[20:23], s57 offen offset:2048  lds
  v_mfma_f32_16x16x32_bf16 v[36:39], v[168:171], a[80:83], v[36:39]
  ds_read_b64_tr_b16 v[176:177], v237 offset:36864
  v_mfma_f32_16x16x32_bf16 v[36:39], v[172:175], a[96:99], v[36:39]
  ds_read_b64_tr_b16 v[178:179], v237 offset:43008
  v_mfma_f32_16x16x32_bf16 v[40:43], v[172:175], a[100:103], v[40:43]
  ds_read_b64_tr_b16 v[180:181], v237 offset:37888
  v_mfma_f32_16x16x32_bf16 v[40:43], v[168:171], a[84:87], v[40:43]
  ds_read_b64_tr_b16 v[182:183], v237 offset:44032
  v_mfma_f32_16x16x32_bf16 v[40:43], v[164:167], a[68:71], v[40:43]
  ds_read_b64_tr_b16 v[184:185], v237 offset:38912
  v_mfma_f32_16x16x32_bf16 v[44:47], v[164:167], a[72:75], v[44:47]
  ds_read_b64_tr_b16 v[186:187], v237 offset:45056
  v_mfma_f32_16x16x32_bf16 v[44:47], v[168:171], a[88:91], v[44:47]
  s_waitcnt vmcnt(6)
  v_readfirstlane_b32 s62, v255
  v_mfma_f32_16x16x32_bf16 v[44:47], v[172:175], a[104:107], v[44:47]
  v_mfma_f32_16x16x32_bf16 v[48:51], v[172:175], a[108:111], v[48:51]
  s_nop 0
  s_cmp_ge_u32 s62, 4
  s_cbranch_scc0 Lp5_slow
Lp5_ok:
  s_add_u32 s60, s39, 0
  v_mfma_f32_16x16x32_bf16 v[48:51], v[168:171], a[92:95], v[48:51]
  buffer_load_dwordx4 a[0:3], v252, s[28:31], s60 offen offset:0 sc1
  v_mfma_f32_16x16x32_bf16 v[48:51], v[164:167], a[76:79], v[48:51]
  s_waitcnt lgkmcnt(0)
  v_mfma_f32_16x16x32_bf16 v[64:67], v[176:179], a[76:79], v[64:67]
  ds_read_b64_tr_b16 v[164:165], v238 offset:24576
  v_mfma_f32_16x16x32_bf16 v[64:67], v[180:183], a[92:95], v[64:67]
  ds_read_b64_tr_b16 v[166:167], v238 offset:30720
  v_mfma_f32_16x16x32_bf16 v[64:67], v[184:187], a[108:111], v[64:67]
  buffer_load_dwordx4 a[4:7], v252, s[28:31], s60 offen offset:1024 sc1
  v_mfma_f32_16x16x32_bf16 v[60:63], v[184:187], a[104:107], v[60:63]
  ds_read_b64_tr_b16 v[168:169], v238 offset:25600
  v_mfma_f32_16x16x32_bf16 v[60:63], v[180:183], a[88:91], v[60:63]
  ds_read_b64_tr_b16 v[170:171], v238 offset:31744
  v_mfma_f32_16x16x32_bf16 v[60:63], v[176:179], a[72:75], v[60:63]
  ds_read_b64_tr_b16 v[172:173], v238 offset:26624
  v_mfma_f32_16x16x32_bf16 v[56:59], v[176:179], a[68:71], v[56:59]
  ds_read_b64_tr_b16 v[174:175], v238 offset:32768
  v_mfma_f32_16x16x32_bf16 v[56:59], v[180:183], a[84:87], v[56:59]
  buffer_load_dwordx4 a[8:11], v252, s[28:31], s60 offen offset:2048 sc1
  v_mfma_f32_16x16x32_bf16 v[56:59], v[184:187], a[100:103], v[56:59]
  v_mfma_f32_16x16x32_bf16 v[52:55], v[184:187], a[96:99], v[52:55]
  v_mfma_f32_16x16x32_bf16 v[52:55], v[180:183], a[80:83], v[52:55]
  v_mfma_f32_16x16x32_bf16 v[52:55], v[176:179], a[64:67], v[52:55]
  s_waitcnt lgkmcnt(0)
  v_mfma_f32_16x16x32_bf16 v[68:71], v[164:167], a[64:67], v[68:71]
  buffer_load_dwordx4 a[12:15], v252, s[28:31], s60 offen offset:3072 sc1
  v_mfma_f32_16x16x32_bf16 v[68:71], v[168:171], a[80:83], v[68:71]
  s_add_u32 s60, s39, 4096
  ds_read_b64_tr_b16 v[176:177], v238 offset:36864
  v_mfma_f32_16x16x32_bf16 v[68:71], v[172:175], a[96:99], v[68:71]
  ds_read_b64_tr_b16 v[178:179], v238 offset:43008
  v_mfma_f32_16x16x32_bf16 v[72:75], v[172:175], a[100:103], v[72:75]
  ds_read_b64_tr_b16 v[180:181], v238 offset:37888
  v_mfma_f32_16x16x32_bf16 v[72:75], v[168:171], a[84:87], v[72:75]
  ds_read_b64_tr_b16 v[182:183], v238 offset:44032
  v_mfma_f32_16x16x32_bf16 v[72:75], v[164:167], a[68:71], v[72:75]
  buffer_load_dwordx4 a[16:19], v252, s[28:31], s60 offen offset:0 sc1
  v_mfma_f32_16x16x32_bf16 v[76:79], v[164:167], a[72:75], v[76:79]
  ds_read_b64_tr_b16 v[184:185], v238 offset:38912
  v_mfma_f32_16x16x32_bf16 v[76:79], v[168:171], a[88:91], v[76:79]
  ds_read_b64_tr_b16 v[186:187], v238 offset:45056
  v_mfma_f32_16x16x32_bf16 v[76:79], v[172:175], a[104:107], v[76:79]
  v_mfma_f32_16x16x32_bf16 v[80:83], v[172:175], a[108:111], v[80:83]
  v_mfma_f32_16x16x32_bf16 v[80:83], v[168:171], a[92:95], v[80:83]
  buffer_load_dwordx4 a[20:23], v252, s[28:31], s60 offen offset:1024 sc1
  v_mfma_f32_16x16x32_bf16 v[80:83], v[164:167], a[76:79], v[80:83]
  s_waitcnt lgkmcnt(0)
  v_mfma_f32_16x16x32_bf16 v[96:99], v[176:179], a[76:79], v[96:99]
  ds_read_b64_tr_b16 v[164:165], v239 offset:24576
  v_mfma_f32_16x16x32_bf16 v[96:99], v[180:183], a[92:95], v[96:99]
  ds_read_b64_tr_b16 v[166:167], v239 offset:30720
  v_mfma_f32_16x16x32_bf16 v[96:99], v[184:187], a[108:111], v[96:99]
  ds_read_b64_tr_b16 v[168:169], v239 offset:25600
  v_mfma_f32_16x16x32_bf16 v[92:95], v[184:187], a[104:107], v[92:95]
  buffer_load_dwordx4 a[24:27], v252, s[28:31], s60 offen offset:2048 sc1
  v_mfma_f32_16x16x32_bf16 v[92:95], v[180:183], a[88:91], v[92:95]
  ds_read_b64_tr_b16 v[170:171], v239 offset:31744
  v_mfma_f32_16x16x32_bf16 v[92:95], v[176:179], a[72:75], v[92:95]
  ds_read_b64_tr_b16 v[172:173], v239 offset:26624
  v_mfma_f32_16x16x32_bf16 v[88:91], v[176:179], a[68:71], v[88:91]
  ds_read_b64_tr_b16 v[174:175], v239 offset:32768
  v_mfma_f32_16x16x32_bf16 v[88:91], v[180:183], a[84:87], v[88:91]
  v_mfma_f32_16x16x32_bf16 v[88:91], v[184:187], a[100:103], v[88:91]
  buffer_load_dwordx4 a[28:31], v252, s[28:31], s60 offen offset:3072 sc1
  v_mfma_f32_16x16x32_bf16 v[84:87], v[184:187], a[96:99], v[84:87]
  s_add_u32 s60, s39, 16384
  v_mfma_f32_16x16x32_bf16 v[84:87], v[180:183], a[80:83], v[84:87]
  v_mfma_f32_16x16x32_bf16 v[84:87], v[176:179], a[64:67], v[84:87]
  s_waitcnt lgkmcnt(0)
  v_mfma_f32_16x16x32_bf16 v[100:103], v[164:167], a[64:67], v[100:103]
  ds_read_b64_tr_b16 v[176:177], v239 offset:36864
  v_mfma_f32_16x16x32_bf16 v[100:103], v[168:171], a[80:83], v[100:103]
  buffer_load_dwordx4 a[32:35], v252, s[28:31], s60 offen offset:0 sc1
  v_mfma_f32_16x16x32_bf16 v[100:103], v[172:175], a[96:99], v[100:103]
  ds_read_b64_tr_b16 v[178:179], v239 offset:43008
  v_mfma_f32_16x16x32_bf16 v[104:107], v[172:175], a[100:103], v[104:107]
  ds_read_b64_tr_b16 v[180:181], v239 offset:37888
  v_mfma_f32_16x16x32_bf16 v[104:107], v[168:171], a[84:87], v[104:107]
  ds_read_b64_tr_b16 v[182:183], v239 offset:44032
  v_mfma_f32_16x16x32_bf16 v[104:107], v[164:167], a[68:71], v[104:107]
  ds_read_b64_tr_b16 v[184:185], v239 offset:38912
  v_mfma_f32_16x16x32_bf16 v[108:111], v[164:167], a[72:75], v[108:111]
  buffer_load_dwordx4 a[36:39], v252, s[28:31], s60 offen offset:1024 sc1
  v_mfma_f32_16x16x32_bf16 v[108:111], v[168:171], a[88:91], v[108:111]
  ds_read_b64_tr_b16 v[186:187], v239 offset:45056
  v_mfma_f32_16x16x32_bf16 v[108:111], v[172:175], a[104:107], v[108:111]
  v_mfma_f32_16x16x32_bf16 v[112:115], v[172:175], a[108:111], v[112:115]
  v_mfma_f32_16x16x32_bf16 v[112:115], v[168:171], a[92:95], v[112:115]
  v_mfma_f32_16x16x32_bf16 v[112:115], v[164:167], a[76:79], v[112:115]
  s_waitcnt lgkmcnt(0)
  s_barrier
  v_mfma_f32_16x16x32_bf16 v[128:131], v[176:179], a[76:79], v[128:131]
  buffer_load_dwordx4 a[40:43], v252, s[28:31], s60 offen offset:2048 sc1
  v_mfma_f32_16x16x32_bf16 v[128:131], v[180:183], a[92:95], v[128:131]
  ds_read_b64_tr_b16 v[164:165], v236 offset:49152
  v_mfma_f32_16x16x32_bf16 v[128:131], v[184:187], a[108:111], v[128:131]
  ds_read_b64_tr_b16 v[166:167], v236 offset:55296
  v_mfma_f32_16x16x32_bf16 v[124:127], v[184:187], a[104:107], v[124:127]
  ds_read_b64_tr_b16 v[168:169], v236 offset:50176
  v_mfma_f32_16x16x32_bf16 v[124:127], v[180:183], a[88:91], v[124:127]
  buffer_load_dwordx4 a[44:47], v252, s[28:31], s60 offen offset:3072 sc1
  v_mfma_f32_16x16x32_bf16 v[124:127], v[176:179], a[72:75], v[124:127]
  s_add_u32 s60, s39, 20480
  ds_read_b64_tr_b16 v[170:171], v236 offset:56320
  v_mfma_f32_16x16x32_bf16 v[120:123], v[176:179], a[68:71], v[120:123]
  ds_read_b64_tr_b16 v[172:173], v236 offset:51200
  v_mfma_f32_16x16x32_bf16 v[120:123], v[180:183], a[84:87], v[120:123]
  ds_read_b64_tr_b16 v[174:175], v236 offset:57344
  v_mfma_f32_16x16x32_bf16 v[120:123], v[184:187], a[100:103], v[120:123]
  v_mfma_f32_16x16x32_bf16 v[116:119], v[184:187], a[96:99], v[116:119]
  buffer_load_dwordx4 a[48:51], v252, s[28:31], s60 offen offset:0 sc1
  v_mfma_f32_16x16x32_bf16 v[116:119], v[180:183], a[80:83], v[116:119]
  v_mfma_f32_16x16x32_bf16 v[116:119], v[176:179], a[64:67], v[116:119]
  s_waitcnt lgkmcnt(0)
  v_mfma_f32_16x16x32_bf16 v[4:7], v[164:167], a[112:115], v[4:7]
  ds_read_b64_tr_b16 v[176:177], v240 offset:0
  v_mfma_f32_16x16x32_bf16 v[4:7], v[168:171], a[128:131], v[4:7]
  ds_read_b64_tr_b16 v[178:179], v240 offset:6144
  v_mfma_f32_16x16x32_bf16 v[4:7], v[172:175], a[144:147], v[4:7]
  buffer_load_dwordx4 a[52:55], v252, s[28:31], s60 offen offset:1024 sc1
  v_mfma_f32_16x16x32_bf16 v[8:11], v[172:175], a[148:151], v[8:11]
  ds_read_b64_tr_b16 v[180:181], v240 offset:1024
  v_mfma_f32_16x16x32_bf16 v[8:11], v[168:171], a[132:135], v[8:11]
  ds_read_b64_tr_b16 v[182:183], v240 offset:7168
  v_mfma_f32_16x16x32_bf16 v[8:11], v[164:167], a[116:119], v[8:11]
  ds_read_b64_tr_b16 v[184:185], v240 offset:2048
  v_mfma_f32_16x16x32_bf16 v[12:15], v[164:167], a[120:123], v[12:15]
  ds_read_b64_tr_b16 v[186:187], v240 offset:8192
  v_mfma_f32_16x16x32_bf16 v[12:15], v[168:171], a[136:139], v[12:15]
  buffer_load_dwordx4 a[56:59], v252, s[28:31], s60 offen offset:2048 sc1
  v_mfma_f32_16x16x32_bf16 v[12:15], v[172:175], a[152:155], v[12:15]
  v_mfma_f32_16x16x32_bf16 v[16:19], v[172:175], a[156:159], v[16:19]
  v_mfma_f32_16x16x32_bf16 v[16:19], v[168:171], a[140:143], v[16:19]
  v_mfma_f32_16x16x32_bf16 v[16:19], v[164:167], a[124:127], v[16:19]
  s_waitcnt lgkmcnt(0)
  v_mfma_f32_16x16x32_bf16 v[32:35], v[176:179], a[124:127], v[32:35]
L_hopb1:
  s_cbranch_execz L_hopb5
  buffer_load_dwordx4 a[60:63], v252, s[28:31], s60 offen offset:3072 sc1
  v_mfma_f32_16x16x32_bf16 v[32:35], v[180:183], a[140:143], v[32:35]
  s_add_u32 m0, s35, 61440
  ds_read_b64_tr_b16 v[164:165], v237 offset:49152
  s_add_u32 s57, s40, 0
  v_mfma_f32_16x16x32_bf16 v[32:35], v[184:187], a[156:159], v[32:35]
  ds_read_b64_tr_b16 v[166:167], v237 offset:55296
  v_mfma_f32_16x16x32_bf16 v[28:31], v[184:187], a[152:155], v[28:31]
  ds_read_b64_tr_b16 v[168:169], v237 offset:50176
  v_mfma_f32_16x16x32_bf16 v[28:31], v[180:183], a[136:139], v[28:31]
  ds_read_b64_tr_b16 v[170:171], v237 offset:56320
  v_mfma_f32_16x16x32_bf16 v[28:31], v[176:179], a[120:123], v[28:31]
  buffer_load_dwordx4 v251, s[20:23], s57 offen offset:0  lds
  v_mfma_f32_16x16x32_bf16 v[24:27], v[176:179], a[116:119], v[24:27]
  s_add_u32 s57, s40, 35840
  ds_read_b64_tr_b16 v[172:173], v237 offset:51200
  v_mfma_f32_16x16x32_bf16 v[24:27], v[180:183], a[132:135], v[24:27]
  ds_read_b64_tr_b16 v[174:175], v237 offset:57344
  v_mfma_f32_16x16x32_bf16 v[24:27], v[184:187], a[148:151], v[24:27]
  v_mfma_f32_16x16x32_bf16 v[20:23], v[184:187], a[144:147], v[20:23]
  v_mfma_f32_16x16x32_bf16 v[20:23], v[180:183], a[128:131], v[20:23]
  buffer_load_dwordx4 v251, s[20:23], s57 offen offset:1024  lds
  v_mfma_f32_16x16x32_bf16 v[20:23], v[176:179], a[112:115], v[20:23]
  s_waitcnt lgkmcnt(0)
  s_add_u32 s57, s40, 145408
  v_mfma_f32_16x16x32_bf16 v[36:39], v[164:167], a[112:115], v[36:39]
  ds_read_b64_tr_b16 v[176:177], v241 offset:0
  v_mfma_f32_16x16x32_bf16 v[36:39], v[168:171], a[128:131], v[36:39]
  ds_read_b64_tr_b16 v[178:179], v241 offset:6144
  v_mfma_f32_16x16x32_bf16 v[36:39], v[172:175], a[144:147], v[36:39]
  ds_read_b64_tr_b16 v[180:181], v241 offset:1024
  v_mfma_f32_16x16x32_bf16 v[40:43], v[172:175], a[148:151], v[40:43]
  buffer_load_dwordx4 v251, s[20:23], s57 offen offset:2048  lds
  v_mfma_f32_16x16x32_bf16 v[40:43], v[168:171], a[132:135], v[40:43]
  s_add_u32 m0, s35, 73728
  ds_read_b64_tr_b16 v[182:183], v241 offset:7168
  s_add_u32 s57, s40, 184320
  v_mfma_f32_16x16x32_bf16 v[40:43], v[164:167], a[116:119], v[40:43]
  ds_read_b64_tr_b16 v[184:185], v241 offset:2048
  v_mfma_f32_16x16x32_bf16 v[44:47], v[164:167], a[120:123], v[44:47]
  ds_read_b64_tr_b16 v[186:187], v241 offset:8192
  v_mfma_f32_16x16x32_bf16 v[44:47], v[168:171], a[136:139], v[44:47]
  v_mfma_f32_16x16x32_bf16 v[44:47], v[172:175], a[152:155], v[44:47]
  buffer_load_dwordx4 v251, s[20:23], s57 offen offset:0  lds
  v_mfma_f32_16x16x32_bf16 v[48:51], v[172:175], a[156:159], v[48:51]
  s_add_u32 s57, s40, 293888
  v_mfma_f32_16x16x32_bf16 v[48:51], v[168:171], a[140:143], v[48:51]
  v_mfma_f32_16x16x32_bf16 v[48:51], v[164:167], a[124:127], v[48:51]
  s_waitcnt lgkmcnt(0)
  v_mfma_f32_16x16x32_bf16 v[64:67], v[176:179], a[124:127], v[64:67]
  ds_read_b64_tr_b16 v[164:165], v238 offset:49152
  v_mfma_f32_16x16x32_bf16 v[64:67], v[180:183], a[140:143], v[64:67]
  buffer_load_dwordx4 v251, s[20:23], s57 offen offset:1024  lds
  v_mfma_f32_16x16x32_bf16 v[64:67], v[184:187], a[156:159], v[64:67]
  s_add_u32 s57, s40, 329728
  ds_read_b64_tr_b16 v[166:167], v238 offset:55296
  v_mfma_f32_16x16x32_bf16 v[60:63], v[184:187], a[152:155], v[60:63]
  ds_read_b64_tr_b16 v[168:169], v238 offset:50176
  v_mfma_f32_16x16x32_bf16 v[60:63], v[180:183], a[136:139], v[60:63]
  ds_read_b64_tr_b16 v[170:171], v238 offset:56320
  v_mfma_f32_16x16x32_bf16 v[60:63], v[176:179], a[120:123], v[60:63]
  ds_read_b64_tr_b16 v[172:173], v238 offset:51200
  v_mfma_f32_16x16x32_bf16 v[56:59], v[176:179], a[116:119], v[56:59]
  buffer_load_dwordx4 v251, s[20:23], s57 offen offset:2048  lds
  v_mfma_f32_16x16x32_bf16 v[56:59], v[180:183], a[132:135], v[56:59]
  s_add_u32 s60, s39, 32768
  ds_read_b64_tr_b16 v[174:175], v238 offset:57344
  v_mfma_f32_16x16x32_bf16 v[56:59], v[184:187], a[148:151], v[56:59]
  v_mfma_f32_16x16x32_bf16 v[52:55], v[184:187], a[144:147], v[52:55]
  v_mfma_f32_16x16x32_bf16 v[52:55], v[180:183], a[128:131], v[52:55]
  v_mfma_f32_16x16x32_bf16 v[52:55], v[176:179], a[112:115], v[52:55]
  s_waitcnt lgkmcnt(0)
  v_mfma_f32_16x16x32_bf16 v[68:71], v[164:167], a[112:115], v[68:71]
  buffer_load_dwordx4 a[64:67], v252, s[28:31], s60 offen offset:0 sc1
  v_mfma_f32_16x16x32_bf16 v[68:71], v[168:171], a[128:131], v[68:71]
  ds_read_b64_tr_b16 v[176:177], v242 offset:0
  v_mfma_f32_16x16x32_bf16 v[68:71], v[172:175], a[144:147], v[68:71]
  ds_read_b64_tr_b16 v[178:179], v242 offset:6144
  v_mfma_f32_16x16x32_bf16 v[72:75], v[172:175], a[148:151], v[72:75]
  ds_read_b64_tr_b16 v[180:181], v242 offset:1024
  v_mfma_f32_16x16x32_bf16 v[72:75], v[168:171], a[132:135], v[72:75]
  buffer_load_dwordx4 a[68:71], v252, s[28:31], s60 offen offset:1024 sc1
  v_mfma_f32_16x16x32_bf16 v[72:75], v[164:167], a[116:119], v[72:75]
  ds_read_b64_tr_b16 v[182:183], v242 offset:7168
  v_mfma_f32_16x16x32_bf16 v[76:79], v[164:167], a[120:123], v[76:79]
  ds_read_b64_tr_b16 v[184:185], v242 offset:2048
  v_mfma_f32_16x16x32_bf16 v[76:79], v[168:171], a[136:139], v[76:79]
  ds_read_b64_tr_b16 v[186:187], v242 offset:8192
  v_mfma_f32_16x16x32_bf16 v[76:79], v[172:175], a[152:155], v[76:79]
  v_mfma_f32_16x16x32_bf16 v[80:83], v[172:175], a[156:159], v[80:83]
  buffer_load_dwordx4 a[72:75], v252, s[28:31], s60 offen offset:2048 sc1
  v_mfma_f32_16x16x32_bf16 v[80:83], v[168:171], a[140:143], v[80:83]
  v_mfma_f32_16x16x32_bf16 v[80:83], v[164:167], a[124:127], v[80:83]
  s_waitcnt lgkmcnt(0)
  v_mfma_f32_16x16x32_bf16 v[96:99], v[176:179], a[124:127], v[96:99]
  ds_read_b64_tr_b16 v[164:165], v239 offset:49152
  v_mfma_f32_16x16x32_bf16 v[96:99], v[180:183], a[140:143], v[96:99]
  ds_read_b64_tr_b16 v[166:167], v239 offset:55296
  v_mfma_f32_16x16x32_bf16 v[96:99], v[184:187], a[156:159], v[96:99]
  buffer_load_dwordx4 a[76:79], v252, s[28:31], s60 offen offset:3072 sc1
  v_mfma_f32_16x16x32_bf16 v[92:95], v[184:187], a[152:155], v[92:95]
  s_add_u32 s60, s39, 36864
  ds_read_b64_tr_b16 v[168:169], v239 offset:50176
  v_mfma_f32_16x16x32_bf16 v[92:95], v[180:183], a[136:139], v[92:95]
  ds_read_b64_tr_b16 v[170:171], v239 offset:56320
  v_mfma_f32_16x16x32_bf16 v[92:95], v[176:179], a[120:123], v[92:95]
  ds_read_b64_tr_b16 v[172:173], v239 offset:51200
  v_mfma_f32_16x16x32_bf16 v[88:91], v[176:179], a[116:119], v[88:91]
  ds_read_b64_tr_b16 v[174:175], v239 offset:57344
  v_mfma_f32_16x16x32_bf16 v[88:91], v[180:183], a[132:135], v[88:91]
  buffer_load_dwordx4 a[80:83], v252, s[28:31], s60 offen offset:0 sc1
  v_mfma_f32_16x16x32_bf16 v[88:91], v[184:187], a[148:151], v[88:91]
  v_mfma_f32_16x16x32_bf16 v[84:87], v[184:187], a[144:147], v[84:87]
  v_mfma_f32_16x16x32_bf16 v[84:87], v[180:183], a[128:131], v[84:87]
  v_mfma_f32_16x16x32_bf16 v[84:87], v[176:179], a[112:115], v[84:87]
  s_waitcnt lgkmcnt(0)
  v_mfma_f32_16x16x32_bf16 v[100:103], v[164:167], a[112:115], v[100:103]
  buffer_load_dwordx4 a[84:87], v252, s[28:31], s60 offen offset:1024 sc1
  v_mfma_f32_16x16x32_bf16 v[100:103], v[168:171], a[128:131], v[100:103]
  ds_read_b64_tr_b16 v[176:177], v243 offset:0
  v_mfma_f32_16x16x32_bf16 v[100:103], v[172:175], a[144:147], v[100:103]
  ds_read_b64_tr_b16 v[178:179], v243 offset:6144
  v_mfma_f32_16x16x32_bf16 v[104:107], v[172:175], a[148:151], v[104:107]
  ds_read_b64_tr_b16 v[180:181], v243 offset:1024
  v_mfma_f32_16x16x32_bf16 v[104:107], v[168:171], a[132:135], v[104:107]
  ds_read_b64_tr_b16 v[182:183], v243 offset:7168
  v_mfma_f32_16x16x32_bf16 v[104:107], v[164:167], a[116:119], v[104:107]
  buffer_load_dwordx4 a[88:91], v252, s[28:31], s60 offen offset:2048 sc1
  v_mfma_f32_16x16x32_bf16 v[108:111], v[164:167], a[120:123], v[108:111]
  ds_read_b64_tr_b16 v[184:185], v243 offset:2048
  v_mfma_f32_16x16x32_bf16 v[108:111], v[168:171], a[136:139], v[108:111]
  ds_read_b64_tr_b16 v[186:187], v243 offset:8192
  v_mfma_f32_16x16x32_bf16 v[108:111], v[172:175], a[152:155], v[108:111]
  v_mfma_f32_16x16x32_bf16 v[112:115], v[172:175], a[156:159], v[112:115]
  v_mfma_f32_16x16x32_bf16 v[112:115], v[168:171], a[140:143], v[112:115]
  buffer_load_dwordx4 a[92:95], v252, s[28:31], s60 offen offset:3072 sc1
  v_mfma_f32_16x16x32_bf16 v[112:115], v[164:167], a[124:127], v[112:115]
  s_waitcnt lgkmcnt(0)
  s_barrier
  s_add_u32 s60, s39, 49152
  v_mfma_f32_16x16x32_bf16 v[128:131], v[176:179], a[124:127], v[128:131]
  ds_read_b64_tr_b16 v[164:165], v240 offset:12288
  v_mfma_f32_16x16x32_bf16 v[128:131], v[180:183], a[140:143], v[128:131]
  ds_read_b64_tr_b16 v[166:167], v240 offset:18432
  v_mfma_f32_16x16x32_bf16 v[128:131], v[184:187], a[156:159], v[128:131]
  ds_read_b64_tr_b16 v[168:169], v240 offset:13312
  v_mfma_f32_16x16x32_bf16 v[124:127], v[184:187], a[152:155], v[124:127]
  buffer_load_dwordx4 a[96:99], v252, s[28:31], s60 offen offset:0 sc1
  v_mfma_f32_16x16x32_bf16 v[124:127], v[180:183], a[136:139], v[124:127]
  ds_read_b64_tr_b16 v[170:171], v240 offset:19456
  v_mfma_f32_16x16x32_bf16 v[124:127], v[176:179], a[120:123], v[124:127]
  ds_read_b64_tr_b16 v[172:173], v240 offset:14336
  v_mfma_f32_16x16x32_bf16 v[120:123], v[176:179], a[116:119], v[120:123]
  ds_read_b64_tr_b16 v[174:175], v240 offset:20480
  v_mfma_f32_16x16x32_bf16 v[120:123], v[180:183], a[132:135], v[120:123]
  v_mfma_f32_16x16x32_bf16 v[120:123], v[184:187], a[148:151], v[120:123]
  buffer_load_dwordx4 a[100:103], v252, s[28:31], s60 offen offset:1024 sc1
  v_mfma_f32_16x16x32_bf16 v[116:119], v[184:187], a[144:147], v[116:119]
  v_mfma_f32_16x16x32_bf16 v[116:119], v[180:183], a[128:131], v[116:119]
  v_mfma_f32_16x16x32_bf16 v[116:119], v[176:179], a[112:115], v[116:119]
  s_waitcnt lgkmcnt(0)
  v_mfma_f32_16x16x32_bf16 v[4:7], v[164:167], a[160:163], v[4:7]
  ds_read_b64_tr_b16 v[176:177], v240 offset:24576
  v_mfma_f32_16x16x32_bf16 v[4:7], v[168:171], a[176:179], v[4:7]
  buffer_load_dwordx4 a[104:107], v252, s[28:31], s60 offen offset:2048 sc1
  v_mfma_f32_16x16x32_bf16 v[4:7], v[172:175], a[192:195], v[4:7]
  ds_read_b64_tr_b16 v[178:179], v240 offset:30720
  v_mfma_f32_16x16x32_bf16 v[8:11], v[172:175], a[196:199], v[8:11]
  ds_read_b64_tr_b16 v[180:181], v240 offset:25600
  v_mfma_f32_16x16x32_bf16 v[8:11], v[168:171], a[180:183], v[8:11]
  ds_read_b64_tr_b16 v[182:183], v240 offset:31744
  v_mfma_f32_16x16x32_bf16 v[8:11], v[164:167], a[164:167], v[8:11]
  ds_read_b64_tr_b16 v[184:185], v240 offset:26624
  v_mfma_f32_16x16x32_bf16 v[12:15], v[164:167], a[168:171], v[12:15]
  buffer_load_dwordx4 a[108:111], v252, s[28:31], s60 offen offset:3072 sc1
  v_mfma_f32_16x16x32_bf16 v[12:15], v[168:171], a[184:187], v[12:15]
  ds_read_b64_tr_b16 v[186:187], v240 offset:32768
  v_mfma_f32_16x16x32_bf16 v[12:15], v[172:175], a[200:203], v[12:15]
  v_mfma_f32_16x16x32_bf16 v[16:19], v[172:175], a[204:207], v[16:19]
  v_mfma_f32_16x16x32_bf16 v[16:19], v[168:171], a[188:191], v[16:19]
  v_mfma_f32_16x16x32_bf16 v[16:19], v[164:167], a[172:175], v[16:19]
  s_waitcnt lgkmcnt(0)
  v_mfma_f32_16x16x32_bf16 v[32:35], v[176:179], a[172:175], v[32:35]
  s_lshl_b32 s36, s78, 7
  s_add_u32 s36, s36, 58730496
  buffer_load_dword v255, off, s[28:31], s36 offset:4 sc1
  v_mfma_f32_16x16x32_bf16 v[32:35], v[180:183], a[188:191], v[32:35]
  s_add_u32 m0, s35, 86016
  ds_read_b64_tr_b16 v[164:165], v241 offset:12288
  s_add_u32 s57, s40, 442368
  v_mfma_f32_16x16x32_bf16 v[32:35], v[184:187], a[204:207], v[32:35]
  ds_read_b64_tr_b16 v[166:167], v241 offset:18432
  v_mfma_f32_16x16x32_bf16 v[28:31], v[184:187], a[200:203], v[28:31]
  ds_read_b64_tr_b16 v[168:169], v241 offset:13312
  v_mfma_f32_16x16x32_bf16 v[28:31], v[180:183], a[184:187], v[28:31]
  buffer_load_dwordx4 v250, s[20:23], s57 offen offset:0  lds
  v_mfma_f32_16x16x32_bf16 v[28:31], v[176:179], a[168:171], v[28:31]
  s_add_u32 s57, s40, 478208
  ds_read_b64_tr_b16 v[170:171], v241 offset:19456
  v_mfma_f32_16x16x32_bf16 v[24:27], v[176:179], a[164:167], v[24:27]
  ds_read_b64_tr_b16 v[172:173], v241 offset:14336
  v_mfma_f32_16x16x32_bf16 v[24:27], v[180:183], a[180:183], v[24:27]
  ds_read_b64_tr_b16 v[174:175], v241 offset:20480
  v_mfma_f32_16x16x32_bf16 v[24:27], v[184:187], a[196:199], v[24:27]
  buffer_load_dwordx4 v250, s[20:23], s57 offen offset:1024  lds
  v_mfma_f32_16x16x32_bf16 v[20:23], v[184:187], a[192:195], v[20:23]
  s_add_u32 s57, s40, 587776
  v_mfma_f32_16x16x32_bf16 v[20:23], v[180:183], a[176:179], v[20:23]
  v_mfma_f32_16x16x32_bf16 v[20:23], v[176:179], a[160:163], v[20:23]
  s_waitcnt lgkmcnt(0)
  v_mfma_f32_16x16x32_bf16 v[36:39], v[164:167], a[160:163], v[36:39]
  buffer_load_dwordx4 v250, s[20:23], s57 offen offset:2048  lds
  v_mfma_f32_16x16x32_bf16 v[36:39], v[168:171], a[176:179], v[36:39]
  s_add_u32 m0, s35, 98304
  ds_read_b64_tr_b16 v[176:177], v241 offset:24576
  s_add_u32 s57, s40, 626688
  v_mfma_f32_16x16x32_bf16 v[36:39], v[172:175], a[192:195], v[36:39]
  ds_read_b64_tr_b16 v[178:179], v241 offset:30720
  v_mfma_f32_16x16x32_bf16 v[40:43], v[172:175], a[196:199], v[40:43]
  ds_read_b64_tr_b16 v[180:181], v241 offset:25600
  v_mfma_f32_16x16x32_bf16 v[40:43], v[168:171], a[180:183], v[40:43]
  buffer_load_dwordx4 v250, s[20:23], s57 offen offset:0  lds
  v_mfma_f32_16x16x32_bf16 v[40:43], v[164:167], a[164:167], v[40:43]
  s_add_u32 s57, s45, 72704
  ds_read_b64_tr_b16 v[182:183], v241 offset:31744
  v_mfma_f32_16x16x32_bf16 v[44:47], v[164:167], a[168:171], v[44:47]
  ds_read_b64_tr_b16 v[184:185], v241 offset:26624
  v_mfma_f32_16x16x32_bf16 v[44:47], v[168:171], a[184:187], v[44:47]
  ds_read_b64_tr_b16 v[186:187], v241 offset:32768
  v_mfma_f32_16x16x32_bf16 v[44:47], v[172:175], a[200:203], v[44:47]
  buffer_load_dwordx4 v250, s[20:23], s57 offen offset:1024  lds
  v_mfma_f32_16x16x32_bf16 v[48:51], v[172:175], a[204:207], v[48:51]
  s_add_u32 s57, s45, 108544
  v_mfma_f32_16x16x32_bf16 v[48:51], v[168:171], a[188:191], v[48:51]
  v_mfma_f32_16x16x32_bf16 v[48:51], v[164:167], a[172:175], v[48:51]
  s_waitcnt lgkmcnt(0)
  v_mfma_f32_16x16x32_bf16 v[64:67], v[176:179], a[172:175], v[64:67]
  ds_read_b64_tr_b16 v[164:165], v242 offset:12288
  v_mfma_f32_16x16x32_bf16 v[64:67], v[180:183], a[188:191], v[64:67]
  buffer_load_dwordx4 v250, s[20:23], s57 offen offset:2048  lds
  v_mfma_f32_16x16x32_bf16 v[64:67], v[184:187], a[204:207], v[64:67]
  s_add_u32 s60, s39, 53248
  ds_read_b64_tr_b16 v[166:167], v242 offset:18432
  v_mfma_f32_16x16x32_bf16 v[60:63], v[184:187], a[200:203], v[60:63]
  ds_read_b64_tr_b16 v[168:169], v242 offset:13312
  v_mfma_f32_16x16x32_bf16 v[60:63], v[180:183], a[184:187], v[60:63]
  ds_read_b64_tr_b16 v[170:171], v242 offset:19456
  v_mfma_f32_16x16x32_bf16 v[60:63], v[176:179], a[168:171], v[60:63]
  ds_read_b64_tr_b16 v[172:173], v242 offset:14336
  v_mfma_f32_16x16x32_bf16 v[56:59], v[176:179], a[164:167], v[56:59]
  buffer_load_dwordx4 a[112:115], v252, s[28:31], s60 offen offset:0 sc1
  v_mfma_f32_16x16x32_bf16 v[56:59], v[180:183], a[180:183], v[56:59]
  ds_read_b64_tr_b16 v[174:175], v242 offset:20480
  v_mfma_f32_16x16x32_bf16 v[56:59], v[184:187], a[196:199], v[56:59]
  v_mfma_f32_16x16x32_bf16 v[52:55], v[184:187], a[192:195], v[52:55]
  v_mfma_f32_16x16x32_bf16 v[52:55], v[180:183], a[176:179], v[52:55]
  v_mfma_f32_16x16x32_bf16 v[52:55], v[176:179], a[160:163], v[52:55]
  s_waitcnt lgkmcnt(0)
  v_mfma_f32_16x16x32_bf16 v[68:71], v[164:167], a[160:163], v[68:71]
  buffer_load_dwordx4 a[116:119], v252, s[28:31], s60 offen offset:1024 sc1
  v_mfma_f32_16x16x32_bf16 v[68:71], v[168:171], a[176:179], v[68:71]
  ds_read_b64_tr_b16 v[176:177], v242 offset:24576
  v_mfma_f32_16x16x32_bf16 v[68:71], v[172:175], a[192:195], v[68:71]
  ds_read_b64_tr_b16 v[178:179], v242 offset:30720
  v_mfma_f32_16x16x32_bf16 v[72:75], v[172:175], a[196:199], v[72:75]
  ds_read_b64_tr_b16 v[180:181], v242 offset:25600
  v_mfma_f32_16x16x32_bf16 v[72:75], v[168:171], a[180:183], v[72:75]
  buffer_load_dwordx4 a[120:123], v252, s[28:31], s60 offen offset:2048 sc1
  v_mfma_f32_16x16x32_bf16 v[72:75], v[164:167], a[164:167], v[72:75]
  ds_read_b64_tr_b16 v[182:183], v242 offset:31744
  v_mfma_f32_16x16x32_bf16 v[76:79], v[164:167], a[168:171], v[76:79]
  ds_read_b64_tr_b16 v[184:185], v242 offset:26624
  v_mfma_f32_16x16x32_bf16 v[76:79], v[168:171], a[184:187], v[76:79]
  ds_read_b64_tr_b16 v[186:187], v242 offset:32768
  v_mfma_f32_16x16x32_bf16 v[76:79], v[172:175], a[200:203], v[76:79]
  v_mfma_f32_16x16x32_bf16 v[80:83], v[172:175], a[204:207], v[80:83]
  buffer_load_dwordx4 a[124:127], v252, s[28:31], s60 offen offset:3072 sc1
  v_mfma_f32_16x16x32_bf16 v[80:83], v[168:171], a[188:191], v[80:83]
  v_mfma_f32_16x16x32_bf16 v[80:83], v[164:167], a[172:175], v[80:83]
  s_waitcnt lgkmcnt(0)
  v_mfma_f32_16x16x32_bf16 v[96:99], v[176:179], a[172:175], v[96:99]
  ds_read_b64_tr_b16 v[164:165], v243 offset:12288
  v_mfma_f32_16x16x32_bf16 v[96:99], v[180:183], a[188:191], v[96:99]
  ds_read_b64_tr_b16 v[166:167], v243 offset:18432
  v_mfma_f32_16x16x32_bf16 v[96:99], v[184:187], a[204:207], v[96:99]
  ds_read_b64_tr_b16 v[168:169], v243 offset:13312
  v_mfma_f32_16x16x32_bf16 v[92:95], v[184:187], a[200:203], v[92:95]
  ds_read_b64_tr_b16 v[170:171], v243 offset:19456
  v_mfma_f32_16x16x32_bf16 v[92:95], v[180:183], a[184:187], v[92:95]
  ds_read_b64_tr_b16 v[172:173], v243 offset:14336
  v_mfma_f32_16x16x32_bf16 v[92:95], v[176:179], a[168:171], v[92:95]
  ds_read_b64_tr_b16 v[174:175], v243 offset:20480
  v_mfma_f32_16x16x32_bf16 v[88:91], v[176:179], a[164:167], v[88:91]
  s_waitcnt vmcnt(10)
  v_readfirstlane_b32 s62, v255
  v_mfma_f32_16x16x32_bf16 v[88:91], v[180:183], a[180:183], v[88:91]
  s_nop 1
  s_cmp_ge_u32 s62, 8
  s_cbranch_scc0 Lp6_slow
Lp6_ok:
  s_add_u32 s60, s39, 65536
  v_mfma_f32_16x16x32_bf16 v[88:91], v[184:187], a[196:199], v[88:91]
  buffer_load_dwordx2 a[128:129], v253, s[28:31], s60 offen offset:0 sc1
  v_mfma_f32_16x16x32_bf16 v[84:87], v[184:187], a[192:195], v[84:87]
  v_mfma_f32_16x16x32_bf16 v[84:87], v[180:183], a[176:179], v[84:87]
  v_mfma_f32_16x16x32_bf16 v[84:87], v[176:179], a[160:163], v[84:87]
  s_waitcnt lgkmcnt(0)
  v_mfma_f32_16x16x32_bf16 v[100:103], v[164:167], a[160:163], v[100:103]
  buffer_load_dwordx2 a[130:131], v253, s[28:31], s60 offen offset:512 sc1
  v_mfma_f32_16x16x32_bf16 v[100:103], v[168:171], a[176:179], v[100:103]
  ds_read_b64_tr_b16 v[176:177], v243 offset:24576
  v_mfma_f32_16x16x32_bf16 v[100:103], v[172:175], a[192:195], v[100:103]
  ds_read_b64_tr_b16 v[178:179], v243 offset:30720
  v_mfma_f32_16x16x32_bf16 v[104:107], v[172:175], a[196:199], v[104:107]
  ds_read_b64_tr_b16 v[180:181], v243 offset:25600
  v_mfma_f32_16x16x32_bf16 v[104:107], v[168:171], a[180:183], v[104:107]
  buffer_load_dwordx2 a[132:133], v253, s[28:31], s60 offen offset:1024 sc1
  v_mfma_f32_16x16x32_bf16 v[104:107], v[164:167], a[164:167], v[104:107]
  ds_read_b64_tr_b16 v[182:183], v243 offset:31744
  v_mfma_f32_16x16x32_bf16 v[108:111], v[164:167], a[168:171], v[108:111]
  ds_read_b64_tr_b16 v[184:185], v243 offset:26624
  v_mfma_f32_16x16x32_bf16 v[108:111], v[168:171], a[184:187], v[108:111]
  ds_read_b64_tr_b16 v[186:187], v243 offset:32768
  v_mfma_f32_16x16x32_bf16 v[108:111], v[172:175], a[200:203], v[108:111]
  buffer_load_dwordx2 a[134:135], v253, s[28:31], s60 offen offset:1536 sc1
  v_mfma_f32_16x16x32_bf16 v[112:115], v[172:175], a[204:207], v[112:115]
  v_mfma_f32_16x16x32_bf16 v[112:115], v[168:171], a[188:191], v[112:115]
  v_mfma_f32_16x16x32_bf16 v[112:115], v[164:167], a[172:175], v[112:115]
  s_waitcnt lgkmcnt(0)
  s_barrier
  v_mfma_f32_16x16x32_bf16 v[128:131], v[176:179], a[172:175], v[128:131]
  buffer_load_dwordx2 a[136:137], v253, s[28:31], s60 offen offset:2048 sc1
  v_mfma_f32_16x16x32_bf16 v[128:131], v[180:183], a[188:191], v[128:131]
  ds_read_b64_tr_b16 v[164:165], v240 offset:36864
  v_mfma_f32_16x16x32_bf16 v[128:131], v[184:187], a[204:207], v[128:131]
  ds_read_b64_tr_b16 v[166:167], v240 offset:43008
  v_mfma_f32_16x16x32_bf16 v[124:127], v[184:187], a[200:203], v[124:127]
  ds_read_b64_tr_b16 v[168:169], v240 offset:37888
  v_mfma_f32_16x16x32_bf16 v[124:127], v[180:183], a[184:187], v[124:127]
  buffer_load_dwordx2 a[138:139], v253, s[28:31], s60 offen offset:2560 sc1
  v_mfma_f32_16x16x32_bf16 v[124:127], v[176:179], a[168:171], v[124:127]
  ds_read_b64_tr_b16 v[170:171], v240 offset:44032
  v_mfma_f32_16x16x32_bf16 v[120:123], v[176:179], a[164:167], v[120:123]
  ds_read_b64_tr_b16 v[172:173], v240 offset:38912
  v_mfma_f32_16x16x32_bf16 v[120:123], v[180:183], a[180:183], v[120:123]
  ds_read_b64_tr_b16 v[174:175], v240 offset:45056
  v_mfma_f32_16x16x32_bf16 v[120:123], v[184:187], a[196:199], v[120:123]
  buffer_load_dwordx2 a[140:141], v253, s[28:31], s60 offen offset:3072 sc1
  v_mfma_f32_16x16x32_bf16 v[116:119], v[184:187], a[192:195], v[116:119]
  v_mfma_f32_16x16x32_bf16 v[116:119], v[180:183], a[176:179], v[116:119]
  v_mfma_f32_16x16x32_bf16 v[116:119], v[176:179], a[160:163], v[116:119]
  s_waitcnt lgkmcnt(0)
  s_cmp_eq_u32 s73, s72
  s_cselect_b32 s32, 0, 0x40000000
  v_mfma_f32_16x16x32_bf16 v[4:7], v[164:167], a[208:211], v[4:7]
  buffer_load_dwordx2 a[142:143], v253, s[28:31], s60 offen offset:3584 sc1
  v_mfma_f32_16x16x32_bf16 v[4:7], v[168:171], a[224:227], v[4:7]
  s_add_u32 s60, s39, 69632
  ds_read_b64_tr_b16 v[176:177], v240 offset:49152
  v_mfma_f32_16x16x32_bf16 v[4:7], v[172:175], a[240:243], v[4:7]
  ds_read_b64_tr_b16 v[178:179], v240 offset:55296
  v_mfma_f32_16x16x32_bf16 v[8:11], v[172:175], a[244:247], v[8:11]
  ds_read_b64_tr_b16 v[180:181], v240 offset:50176
  v_mfma_f32_16x16x32_bf16 v[8:11], v[168:171], a[228:231], v[8:11]
  buffer_load_dwordx2 a[144:145], v253, s[28:31], s60 offen offset:0 sc1
  v_mfma_f32_16x16x32_bf16 v[8:11], v[164:167], a[212:215], v[8:11]
  ds_read_b64_tr_b16 v[182:183], v240 offset:56320
  v_mfma_f32_16x16x32_bf16 v[12:15], v[164:167], a[216:219], v[12:15]
  ds_read_b64_tr_b16 v[184:185], v240 offset:51200
  v_mfma_f32_16x16x32_bf16 v[12:15], v[168:171], a[232:235], v[12:15]
  ds_read_b64_tr_b16 v[186:187], v240 offset:57344
  v_mfma_f32_16x16x32_bf16 v[12:15], v[172:175], a[248:251], v[12:15]
  buffer_load_dwordx2 a[146:147], v253, s[28:31], s60 offen offset:512 sc1
  v_mfma_f32_16x16x32_bf16 v[16:19], v[172:175], a[252:255], v[16:19]
  v_mfma_f32_16x16x32_bf16 v[16:19], v[168:171], a[236:239], v[16:19]
  v_mfma_f32_16x16x32_bf16 v[16:19], v[164:167], a[220:223], v[16:19]
  s_waitcnt lgkmcnt(0)
  v_mfma_f32_16x16x32_bf16 v[32:35], v[176:179], a[220:223], v[32:35]
  buffer_load_dwordx2 a[148:149], v253, s[28:31], s60 offen offset:1024 sc1
  v_mfma_f32_16x16x32_bf16 v[32:35], v[180:183], a[236:239], v[32:35]
  ds_read_b64_tr_b16 v[164:165], v241 offset:36864
  v_mfma_f32_16x16x32_bf16 v[32:35], v[184:187], a[252:255], v[32:35]
  ds_read_b64_tr_b16 v[166:167], v241 offset:43008
  v_mfma_f32_16x16x32_bf16 v[28:31], v[184:187], a[248:251], v[28:31]
  ds_read_b64_tr_b16 v[168:169], v241 offset:37888
  v_mfma_f32_16x16x32_bf16 v[28:31], v[180:183], a[232:235], v[28:31]
  buffer_load_dwordx2 a[150:151], v253, s[28:31], s60 offen offset:1536 sc1
  v_mfma_f32_16x16x32_bf16 v[28:31], v[176:179], a[216:219], v[28:31]
  ds_read_b64_tr_b16 v[170:171], v241 offset:44032
  v_mfma_f32_16x16x32_bf16 v[24:27], v[176:179], a[212:215], v[24:27]
  ds_read_b64_tr_b16 v[172:173], v241 offset:38912
  v_mfma_f32_16x16x32_bf16 v[24:27], v[180:183], a[228:231], v[24:27]
  ds_read_b64_tr_b16 v[174:175], v241 offset:45056
  v_mfma_f32_16x16x32_bf16 v[24:27], v[184:187], a[244:247], v[24:27]
  buffer_load_dwordx2 a[152:153], v253, s[28:31], s60 offen offset:2048 sc1
  v_mfma_f32_16x16x32_bf16 v[20:23], v[184:187], a[240:243], v[20:23]
  v_mfma_f32_16x16x32_bf16 v[20:23], v[180:183], a[224:227], v[20:23]
  v_mfma_f32_16x16x32_bf16 v[20:23], v[176:179], a[208:211], v[20:23]
  s_waitcnt lgkmcnt(0)
  v_mfma_f32_16x16x32_bf16 v[36:39], v[164:167], a[208:211], v[36:39]
  buffer_load_dwordx2 a[154:155], v253, s[28:31], s60 offen offset:2560 sc1
  v_mfma_f32_16x16x32_bf16 v[36:39], v[168:171], a[224:227], v[36:39]
  ds_read_b64_tr_b16 v[176:177], v241 offset:49152
  v_mfma_f32_16x16x32_bf16 v[36:39], v[172:175], a[240:243], v[36:39]
  ds_read_b64_tr_b16 v[178:179], v241 offset:55296
  v_mfma_f32_16x16x32_bf16 v[40:43], v[172:175], a[244:247], v[40:43]
  ds_read_b64_tr_b16 v[180:181], v241 offset:50176
  v_mfma_f32_16x16x32_bf16 v[40:43], v[168:171], a[228:231], v[40:43]
  buffer_load_dwordx2 a[156:157], v253, s[28:31], s60 offen offset:3072 sc1
  v_mfma_f32_16x16x32_bf16 v[40:43], v[164:167], a[212:215], v[40:43]
  ds_read_b64_tr_b16 v[182:183], v241 offset:56320
  v_mfma_f32_16x16x32_bf16 v[44:47], v[164:167], a[216:219], v[44:47]
  ds_read_b64_tr_b16 v[184:185], v241 offset:51200
  v_mfma_f32_16x16x32_bf16 v[44:47], v[168:171], a[232:235], v[44:47]
  ds_read_b64_tr_b16 v[186:187], v241 offset:57344
  v_mul_f32 v4, v4, v20
  v_mfma_f32_16x16x32_bf16 v[44:47], v[172:175], a[248:251], v[44:47]
  buffer_load_dwordx2 a[158:159], v253, s[28:31], s60 offen offset:3584 sc1
  v_mfma_f32_16x16x32_bf16 v[48:51], v[172:175], a[252:255], v[48:51]
  s_add_u32 m0, s35, 110592
  v_mul_f32 v5, v5, v21
  v_mul_f32 v6, v6, v22
  v_mfma_f32_16x16x32_bf16 v[48:51], v[168:171], a[236:239], v[48:51]
  s_add_u32 s57, s40, 442368
  v_mul_f32 v7, v7, v23
  v_cvt_pk_bf16_f32 v188, v4, v5
  v_mfma_f32_16x16x32_bf16 v[48:51], v[164:167], a[220:223], v[48:51]
  s_waitcnt lgkmcnt(0)
  v_cvt_pk_bf16_f32 v189, v6, v7
  v_mul_f32 v8, v8, v24
  v_mfma_f32_16x16x32_bf16 v[64:67], v[176:179], a[220:223], v[64:67]
  buffer_load_dwordx4 v251, s[20:23], s57 offen offset:0  lds
  v_mfma_f32_16x16x32_bf16 v[64:67], v[180:183], a[236:239], v[64:67]
  s_add_u32 s57, s40, 478208
  ds_read_b64_tr_b16 v[164:165], v242 offset:36864
  v_mul_f32 v9, v9, v25
  v_mfma_f32_16x16x32_bf16 v[64:67], v[184:187], a[252:255], v[64:67]
  ds_read_b64_tr_b16 v[166:167], v242 offset:43008
  v_mul_f32 v10, v10, v26
  v_mfma_f32_16x16x32_bf16 v[60:63], v[184:187], a[248:251], v[60:63]
  ds_read_b64_tr_b16 v[168:169], v242 offset:37888
  v_mul_f32 v11, v11, v27
  v_mfma_f32_16x16x32_bf16 v[60:63], v[180:183], a[232:235], v[60:63]
  buffer_load_dwordx4 v251, s[20:23], s57 offen offset:1024  lds
  v_mfma_f32_16x16x32_bf16 v[60:63], v[176:179], a[216:219], v[60:63]
  s_add_u32 s57, s40, 587776
  ds_read_b64_tr_b16 v[170:171], v242 offset:44032
  v_cvt_pk_bf16_f32 v192, v8, v9
  v_mfma_f32_16x16x32_bf16 v[56:59], v[176:179], a[212:215], v[56:59]
  ds_read_b64_tr_b16 v[172:173], v242 offset:38912
  v_cvt_pk_bf16_f32 v193, v10, v11
  v_mfma_f32_16x16x32_bf16 v[56:59], v[180:183], a[228:231], v[56:59]
  ds_read_b64_tr_b16 v[174:175], v242 offset:45056
  v_mul_f32 v12, v12, v28
  v_mfma_f32_16x16x32_bf16 v[56:59], v[184:187], a[244:247], v[56:59]
  buffer_load_dwordx4 v251, s[20:23], s57 offen offset:2048  lds
  v_mfma_f32_16x16x32_bf16 v[52:55], v[184:187], a[240:243], v[52:55]
  s_add_u32 m0, s35, 122880
  v_mul_f32 v13, v13, v29
  v_mul_f32 v14, v14, v30
  v_mfma_f32_16x16x32_bf16 v[52:55], v[180:183], a[224:227], v[52:55]
  s_add_u32 s57, s40, 626688
  v_mul_f32 v15, v15, v31
  v_cvt_pk_bf16_f32 v196, v12, v13
  v_mfma_f32_16x16x32_bf16 v[52:55], v[176:179], a[208:211], v[52:55]
  s_waitcnt lgkmcnt(0)
  v_cvt_pk_bf16_f32 v197, v14, v15
  v_mul_f32 v16, v16, v32
  v_mfma_f32_16x16x32_bf16 v[68:71], v[164:167], a[208:211], v[68:71]
  buffer_load_dwordx4 v251, s[20:23], s57 offen offset:0  lds
  v_mfma_f32_16x16x32_bf16 v[68:71], v[168:171], a[224:227], v[68:71]
  s_add_u32 s57, s45, 72704
  ds_read_b64_tr_b16 v[176:177], v242 offset:49152
  v_mul_f32 v17, v17, v33
  v_mfma_f32_16x16x32_bf16 v[68:71], v[172:175], a[240:243], v[68:71]
  ds_read_b64_tr_b16 v[178:179], v242 offset:55296
  v_mul_f32 v18, v18, v34
  v_mfma_f32_16x16x32_bf16 v[72:75], v[172:175], a[244:247], v[72:75]
  ds_read_b64_tr_b16 v[180:181], v242 offset:50176
  v_mul_f32 v19, v19, v35
  v_mfma_f32_16x16x32_bf16 v[72:75], v[168:171], a[228:231], v[72:75]
  buffer_load_dwordx4 v251, s[20:23], s57 offen offset:1024  lds
  v_mfma_f32_16x16x32_bf16 v[72:75], v[164:167], a[212:215], v[72:75]
  s_add_u32 s57, s45, 108544
  ds_read_b64_tr_b16 v[182:183], v242 offset:56320
  v_cvt_pk_bf16_f32 v200, v16, v17
  v_mfma_f32_16x16x32_bf16 v[76:79], v[164:167], a[216:219], v[76:79]
  ds_read_b64_tr_b16 v[184:185], v242 offset:51200
  v_cvt_pk_bf16_f32 v201, v18, v19
  v_mfma_f32_16x16x32_bf16 v[76:79], v[168:171], a[232:235], v[76:79]
  s_add_u32 s61, s37, 8192
  ds_read_b64_tr_b16 v[186:187], v242 offset:57344
  v_mul_f32 v36, v36, v52
  v_mfma_f32_16x16x32_bf16 v[76:79], v[172:175], a[248:251], v[76:79]
  buffer_load_dwordx4 v251, s[20:23], s57 offen offset:2048  lds
  v_mfma_f32_16x16x32_bf16 v[80:83], v[172:175], a[252:255], v[80:83]
  v_mul_f32 v37, v37, v53
  v_mul_f32 v38, v38, v54
  v_mfma_f32_16x16x32_bf16 v[80:83], v[168:171], a[236:239], v[80:83]
  v_mul_f32 v39, v39, v55
  v_cvt_pk_bf16_f32 v190, v36, v37
  v_mfma_f32_16x16x32_bf16 v[80:83], v[164:167], a[220:223], v[80:83]
  s_waitcnt lgkmcnt(0)
  v_cvt_pk_bf16_f32 v191, v38, v39
  v_mfma_f32_16x16x32_bf16 v[96:99], v[176:179], a[220:223], v[96:99]
  buffer_store_dwordx4 v[188:191], v252, s[28:31], s61 offen offset:0 sc1
  v_mfma_f32_16x16x32_bf16 v[96:99], v[180:183], a[236:239], v[96:99]
  ds_read_b64_tr_b16 v[164:165], v243 offset:36864
  v_mul_f32 v40, v40, v56
  v_mfma_f32_16x16x32_bf16 v[96:99], v[184:187], a[252:255], v[96:99]
  ds_read_b64_tr_b16 v[166:167], v243 offset:43008
  v_mul_f32 v41, v41, v57
  v_mfma_f32_16x16x32_bf16 v[92:95], v[184:187], a[248:251], v[92:95]
  ds_read_b64_tr_b16 v[168:169], v243 offset:37888
  v_mul_f32 v42, v42, v58
  v_mfma_f32_16x16x32_bf16 v[92:95], v[180:183], a[232:235], v[92:95]
  ds_read_b64_tr_b16 v[170:171], v243 offset:44032
  v_mul_f32 v43, v43, v59
  v_mfma_f32_16x16x32_bf16 v[92:95], v[176:179], a[216:219], v[92:95]
  ds_read_b64_tr_b16 v[172:173], v243 offset:38912
  v_cvt_pk_bf16_f32 v194, v40, v41
  v_mfma_f32_16x16x32_bf16 v[88:91], v[176:179], a[212:215], v[88:91]
  ds_read_b64_tr_b16 v[174:175], v243 offset:45056
  v_cvt_pk_bf16_f32 v195, v42, v43
  v_mfma_f32_16x16x32_bf16 v[88:91], v[180:183], a[228:231], v[88:91]
  buffer_store_dwordx4 v[192:195], v252, s[28:31], s61 offen offset:1024 sc1
  v_mfma_f32_16x16x32_bf16 v[88:91], v[184:187], a[244:247], v[88:91]
  v_mul_f32 v44, v44, v60
  v_mul_f32 v45, v45, v61
  v_mfma_f32_16x16x32_bf16 v[84:87], v[184:187], a[240:243], v[84:87]
  v_mul_f32 v46, v46, v62
  v_mul_f32 v47, v47, v63
  v_mfma_f32_16x16x32_bf16 v[84:87], v[180:183], a[224:227], v[84:87]
  v_cvt_pk_bf16_f32 v198, v44, v45
  v_cvt_pk_bf16_f32 v199, v46, v47
  v_mfma_f32_16x16x32_bf16 v[84:87], v[176:179], a[208:211], v[84:87]
  s_waitcnt lgkmcnt(0)
  v_mfma_f32_16x16x32_bf16 v[100:103], v[164:167], a[208:211], v[100:103]
  ds_read_b64_tr_b16 v[176:177], v243 offset:49152
  v_mfma_f32_16x16x32_bf16 v[100:103], v[168:171], a[224:227], v[100:103]
  buffer_store_dwordx4 v[196:199], v252, s[28:31], s61 offen offset:2048 sc1
  v_mfma_f32_16x16x32_bf16 v[100:103], v[172:175], a[240:243], v[100:103]
  ds_read_b64_tr_b16 v[178:179], v243 offset:55296
L_hopb2:
  s_cbranch_execz L_mainb
  v_mul_f32 v48, v48, v64
  v_mfma_f32_16x16x32_bf16 v[104:107], v[172:175], a[244:247], v[104:107]
  ds_read_b64_tr_b16 v[180:181], v243 offset:50176
  v_mul_f32 v49, v49, v65
  v_mfma_f32_16x16x32_bf16 v[104:107], v[168:171], a[228:231], v[104:107]
  ds_read_b64_tr_b16 v[182:183], v243 offset:56320
  v_mul_f32 v50, v50, v66
  v_mfma_f32_16x16x32_bf16 v[104:107], v[164:167], a[212:215], v[104:107]
  ds_read_b64_tr_b16 v[184:185], v243 offset:51200
  v_mul_f32 v51, v51, v67
  v_mfma_f32_16x16x32_bf16 v[108:111], v[164:167], a[216:219], v[108:111]
  ds_read_b64_tr_b16 v[186:187], v243 offset:57344
  v_cvt_pk_bf16_f32 v202, v48, v49
  v_mfma_f32_16x16x32_bf16 v[108:111], v[168:171], a[232:235], v[108:111]
  v_cvt_pk_bf16_f32 v203, v50, v51
  v_mfma_f32_16x16x32_bf16 v[108:111], v[172:175], a[248:251], v[108:111]
  buffer_store_dwordx4 v[200:203], v252, s[28:31], s61 offen offset:3072 sc1
  v_mfma_f32_16x16x32_bf16 v[112:115], v[172:175], a[252:255], v[112:115]
  v_mul_f32 v68, v68, v84
  v_mul_f32 v69, v69, v85
  v_mfma_f32_16x16x32_bf16 v[112:115], v[168:171], a[236:239], v[112:115]
  v_mul_f32 v70, v70, v86
  v_mul_f32 v71, v71, v87
  v_mfma_f32_16x16x32_bf16 v[112:115], v[164:167], a[220:223], v[112:115]
  s_waitcnt lgkmcnt(0)
  s_barrier
  v_cvt_pk_bf16_f32 v204, v68, v69
  v_mfma_f32_16x16x32_bf16 v[128:131], v[176:179], a[220:223], v[128:131]
  ds_read_b64_tr_b16 v[164:165], v236 offset:0
  v_cvt_pk_bf16_f32 v205, v70, v71
  v_mfma_f32_16x16x32_bf16 v[128:131], v[180:183], a[236:239], v[128:131]
  ds_read_b64_tr_b16 v[166:167], v236 offset:6144
  v_mul_f32 v72, v72, v88
  v_mfma_f32_16x16x32_bf16 v[128:131], v[184:187], a[252:255], v[128:131]
  ds_read_b64_tr_b16 v[168:169], v236 offset:1024
  v_mul_f32 v73, v73, v89
  v_mfma_f32_16x16x32_bf16 v[124:127], v[184:187], a[248:251], v[124:127]
  ds_read_b64_tr_b16 v[170:171], v236 offset:7168
  v_mul_f32 v74, v74, v90
  v_mfma_f32_16x16x32_bf16 v[124:127], v[180:183], a[232:235], v[124:127]
  ds_read_b64_tr_b16 v[172:173], v236 offset:2048
  v_mul_f32 v75, v75, v91
  v_mfma_f32_16x16x32_bf16 v[124:127], v[176:179], a[216:219], v[124:127]
  ds_read_b64_tr_b16 v[174:175], v236 offset:8192
  v_cvt_pk_bf16_f32 v208, v72, v73
  v_mfma_f32_16x16x32_bf16 v[120:123], v[176:179], a[212:215], v[120:123]
  v_cvt_pk_bf16_f32 v209, v74, v75
  v_mul_f32 v76, v76, v92
  v_mfma_f32_16x16x32_bf16 v[120:123], v[180:183], a[228:231], v[120:123]
  v_mul_f32 v77, v77, v93
  v_mul_f32 v78, v78, v94
  v_mfma_f32_16x16x32_bf16 v[120:123], v[184:187], a[244:247], v[120:123]
  v_mul_f32 v79, v79, v95
  v_cvt_pk_bf16_f32 v212, v76, v77
  v_mfma_f32_16x16x32_bf16 v[116:119], v[184:187], a[240:243], v[116:119]
  v_cvt_pk_bf16_f32 v213, v78, v79
  v_mul_f32 v80, v80, v96
  v_mfma_f32_16x16x32_bf16 v[116:119], v[180:183], a[224:227], v[116:119]
  v_mul_f32 v81, v81, v97
  v_mul_f32 v82, v82, v98
  v_mfma_f32_16x16x32_bf16 v[116:119], v[176:179], a[208:211], v[116:119]
  s_waitcnt lgkmcnt(0)
  v_mul_f32 v83, v83, v99
  v_cvt_pk_bf16_f32 v216, v80, v81
  v_mfma_f32_16x16x32_bf16 v[132:135], v[164:167], a[0:3], 0
  ds_read_b64_tr_b16 v[176:177], v237 offset:0
  v_cvt_pk_bf16_f32 v217, v82, v83
  v_mfma_f32_16x16x32_bf16 v[132:135], v[168:171], a[16:19], v[132:135]
  ds_read_b64_tr_b16 v[178:179], v237 offset:6144
  v_mfma_f32_16x16x32_bf16 v[132:135], v[172:175], a[32:35], v[132:135]
  ds_read_b64_tr_b16 v[180:181], v237 offset:1024
  v_mfma_f32_16x16x32_bf16 v[136:139], v[172:175], a[36:39], 0
  ds_read_b64_tr_b16 v[182:183], v237 offset:7168
  v_mfma_f32_16x16x32_bf16 v[136:139], v[168:171], a[20:23], v[136:139]
  ds_read_b64_tr_b16 v[184:185], v237 offset:2048
  v_mfma_f32_16x16x32_bf16 v[136:139], v[164:167], a[4:7], v[136:139]
  ds_read_b64_tr_b16 v[186:187], v237 offset:8192
  v_mfma_f32_16x16x32_bf16 v[140:143], v[164:167], a[8:11], 0
  v_mfma_f32_16x16x32_bf16 v[140:143], v[168:171], a[24:27], v[140:143]
  s_add_u32 s61, s37, 12288
  v_mul_f32 v100, v100, v116
  v_mul_f32 v101, v101, v117
  v_mfma_f32_16x16x32_bf16 v[140:143], v[172:175], a[40:43], v[140:143]
  v_mul_f32 v102, v102, v118
  v_mul_f32 v103, v103, v119
  v_mfma_f32_16x16x32_bf16 v[144:147], v[172:175], a[44:47], 0
  v_cvt_pk_bf16_f32 v206, v100, v101
  v_cvt_pk_bf16_f32 v207, v102, v103
  v_mfma_f32_16x16x32_bf16 v[144:147], v[168:171], a[28:31], v[144:147]
  buffer_store_dwordx4 v[204:207], v252, s[28:31], s61 offen offset:0 sc1
  v_mfma_f32_16x16x32_bf16 v[144:147], v[164:167], a[12:15], v[144:147]
  s_waitcnt lgkmcnt(0)
  v_mul_f32 v104, v104, v120
  v_mul_f32 v105, v105, v121
  v_mfma_f32_16x16x32_bf16 v[160:163], v[176:179], a[12:15], 0
  ds_read_b64_tr_b16 v[164:165], v238 offset:0
  v_mul_f32 v106, v106, v122
  v_mfma_f32_16x16x32_bf16 v[160:163], v[180:183], a[28:31], v[160:163]
  ds_read_b64_tr_b16 v[166:167], v238 offset:6144
  v_mul_f32 v107, v107, v123
  v_mfma_f32_16x16x32_bf16 v[160:163], v[184:187], a[44:47], v[160:163]
  ds_read_b64_tr_b16 v[168:169], v238 offset:1024
  v_cvt_pk_bf16_f32 v210, v104, v105
  v_mfma_f32_16x16x32_bf16 v[156:159], v[184:187], a[40:43], 0
  ds_read_b64_tr_b16 v[170:171], v238 offset:7168
  v_cvt_pk_bf16_f32 v211, v106, v107
  v_mfma_f32_16x16x32_bf16 v[156:159], v[180:183], a[24:27], v[156:159]
  buffer_store_dwordx4 v[208:211], v252, s[28:31], s61 offen offset:1024 sc1
  v_mfma_f32_16x16x32_bf16 v[156:159], v[176:179], a[8:11], v[156:159]
  ds_read_b64_tr_b16 v[172:173], v238 offset:2048
  v_mul_f32 v108, v108, v124
  v_mfma_f32_16x16x32_bf16 v[152:155], v[176:179], a[4:7], 0
  ds_read_b64_tr_b16 v[174:175], v238 offset:8192
  v_mul_f32 v109, v109, v125
  v_mfma_f32_16x16x32_bf16 v[152:155], v[180:183], a[20:23], v[152:155]
  v_mul_f32 v110, v110, v126
  v_mul_f32 v111, v111, v127
  v_mfma_f32_16x16x32_bf16 v[152:155], v[184:187], a[36:39], v[152:155]
  v_cvt_pk_bf16_f32 v214, v108, v109
  v_cvt_pk_bf16_f32 v215, v110, v111
  v_mfma_f32_16x16x32_bf16 v[148:151], v[184:187], a[32:35], 0
  v_mfma_f32_16x16x32_bf16 v[148:151], v[180:183], a[16:19], v[148:151]
  buffer_store_dwordx4 v[212:215], v252, s[28:31], s61 offen offset:2048 sc1
  v_mfma_f32_16x16x32_bf16 v[148:151], v[176:179], a[0:3], v[148:151]
  s_waitcnt lgkmcnt(0)
  v_mul_f32 v112, v112, v128
  v_mul_f32 v113, v113, v129
  v_mfma_f32_16x16x32_bf16 v[4:7], v[164:167], a[0:3], 0
  ds_read_b64_tr_b16 v[176:177], v239 offset:0
  v_mul_f32 v114, v114, v130
  v_mfma_f32_16x16x32_bf16 v[4:7], v[168:171], a[16:19], v[4:7]
  ds_read_b64_tr_b16 v[178:179], v239 offset:6144
  v_mul_f32 v115, v115, v131
  v_mfma_f32_16x16x32_bf16 v[4:7], v[172:175], a[32:35], v[4:7]
  ds_read_b64_tr_b16 v[180:181], v239 offset:1024
  v_cvt_pk_bf16_f32 v218, v112, v113
  v_mfma_f32_16x16x32_bf16 v[8:11], v[172:175], a[36:39], 0
  ds_read_b64_tr_b16 v[182:183], v239 offset:7168
  v_cvt_pk_bf16_f32 v219, v114, v115
  v_mfma_f32_16x16x32_bf16 v[8:11], v[168:171], a[20:23], v[8:11]
  buffer_store_dwordx4 v[216:219], v252, s[28:31], s61 offen offset:3072 sc1
  v_mfma_f32_16x16x32_bf16 v[8:11], v[164:167], a[4:7], v[8:11]
  ds_read_b64_tr_b16 v[184:185], v239 offset:2048
  v_mfma_f32_16x16x32_bf16 v[12:15], v[164:167], a[8:11], 0
  ds_read_b64_tr_b16 v[186:187], v239 offset:8192
  v_mfma_f32_16x16x32_bf16 v[12:15], v[168:171], a[24:27], v[12:15]
  v_mfma_f32_16x16x32_bf16 v[12:15], v[172:175], a[40:43], v[12:15]
  v_mfma_f32_16x16x32_bf16 v[16:19], v[172:175], a[44:47], 0
  v_mfma_f32_16x16x32_bf16 v[16:19], v[168:171], a[28:31], v[16:19]
  v_mfma_f32_16x16x32_bf16 v[16:19], v[164:167], a[12:15], v[16:19]
  s_waitcnt lgkmcnt(0)
  v_mfma_f32_16x16x32_bf16 v[32:35], v[176:179], a[12:15], 0
  ds_read_b64_tr_b16 v[164:165], v248 offset:0
  v_mfma_f32_16x16x32_bf16 v[32:35], v[180:183], a[28:31], v[32:35]
  ds_read_b64_tr_b16 v[166:167], v248 offset:512
  v_mfma_f32_16x16x32_bf16 v[32:35], v[184:187], a[44:47], v[32:35]
  ds_read_b64_tr_b16 v[168:169], v248 offset:1024
  v_mfma_f32_16x16x32_bf16 v[28:31], v[184:187], a[40:43], 0
  ds_read_b64_tr_b16 v[170:171], v248 offset:1536
  v_mfma_f32_16x16x32_bf16 v[28:31], v[180:183], a[24:27], v[28:31]
  ds_read_b64_tr_b16 v[172:173], v248 offset:4096
  v_mfma_f32_16x16x32_bf16 v[28:31], v[176:179], a[8:11], v[28:31]
  ds_read_b64_tr_b16 v[174:175], v248 offset:4608
  v_mfma_f32_16x16x32_bf16 v[24:27], v[176:179], a[4:7], 0
  v_mfma_f32_16x16x32_bf16 v[24:27], v[180:183], a[20:23], v[24:27]
  v_mfma_f32_16x16x32_bf16 v[24:27], v[184:187], a[36:39], v[24:27]
  v_mfma_f32_16x16x32_bf16 v[20:23], v[184:187], a[32:35], 0
  v_mfma_f32_16x16x32_bf16 v[20:23], v[180:183], a[16:19], v[20:23]
  v_mfma_f32_16x16x32_bf16 v[20:23], v[176:179], a[0:3], v[20:23]
  s_waitcnt lgkmcnt(0)
  v_mfma_f32_16x16x32_bf16 v[36:39], v[164:167], a[0:3], 0
  ds_read_b64_tr_b16 v[176:177], v236 offset:24576
  v_mfma_f32_16x16x32_bf16 v[36:39], v[168:171], a[16:19], v[36:39]
  ds_read_b64_tr_b16 v[178:179], v236 offset:30720
  v_mfma_f32_16x16x32_bf16 v[36:39], v[172:175], a[32:35], v[36:39]
  ds_read_b64_tr_b16 v[180:181], v236 offset:25600
  v_mfma_f32_16x16x32_bf16 v[40:43], v[172:175], a[36:39], 0
  ds_read_b64_tr_b16 v[182:183], v236 offset:31744
  v_mfma_f32_16x16x32_bf16 v[40:43], v[168:171], a[20:23], v[40:43]
  ds_read_b64_tr_b16 v[184:185], v236 offset:26624
  v_mfma_f32_16x16x32_bf16 v[40:43], v[164:167], a[4:7], v[40:43]
  ds_read_b64_tr_b16 v[186:187], v236 offset:32768
  v_mfma_f32_16x16x32_bf16 v[44:47], v[164:167], a[8:11], 0
  v_mfma_f32_16x16x32_bf16 v[44:47], v[168:171], a[24:27], v[44:47]
  v_mfma_f32_16x16x32_bf16 v[44:47], v[172:175], a[40:43], v[44:47]
  v_mfma_f32_16x16x32_bf16 v[48:51], v[172:175], a[44:47], 0
  v_mfma_f32_16x16x32_bf16 v[48:51], v[168:171], a[28:31], v[48:51]
  v_mfma_f32_16x16x32_bf16 v[48:51], v[164:167], a[12:15], v[48:51]
  s_waitcnt lgkmcnt(0)
  v_mfma_f32_16x16x32_bf16 v[60:63], v[176:179], a[8:11], 0
  ds_read_b64_tr_b16 v[164:165], v236 offset:12288
  v_mfma_f32_16x16x32_bf16 v[60:63], v[180:183], a[24:27], v[60:63]
  ds_read_b64_tr_b16 v[166:167], v236 offset:18432
  v_mfma_f32_16x16x32_bf16 v[60:63], v[184:187], a[40:43], v[60:63]
  ds_read_b64_tr_b16 v[168:169], v236 offset:13312
  v_mfma_f32_16x16x32_bf16 v[56:59], v[184:187], a[36:39], 0
  ds_read_b64_tr_b16 v[170:171], v236 offset:19456
  v_mfma_f32_16x16x32_bf16 v[56:59], v[180:183], a[20:23], v[56:59]
  ds_read_b64_tr_b16 v[172:173], v236 offset:14336
  v_mfma_f32_16x16x32_bf16 v[56:59], v[176:179], a[4:7], v[56:59]
  ds_read_b64_tr_b16 v[174:175], v236 offset:20480
  v_mfma_f32_16x16x32_bf16 v[52:55], v[176:179], a[0:3], 0
  s_waitcnt vmcnt(4)
  buffer_atomic_add v0, v254, s[28:31], s42 offen offset:128 sc1
  v_mfma_f32_16x16x32_bf16 v[52:55], v[180:183], a[16:19], v[52:55]
  s_add_u32 m0, s35, 135168
  s_add_u32 s57, s46, 73728
  v_mfma_f32_16x16x32_bf16 v[52:55], v[184:187], a[32:35], v[52:55]
  s_waitcnt lgkmcnt(0)
  v_mfma_f32_16x16x32_bf16 v[132:135], v[164:167], a[48:51], v[132:135]
  ds_read_b64_tr_b16 v[176:177], v237 offset:12288
  v_mfma_f32_16x16x32_bf16 v[132:135], v[168:171], a[64:67], v[132:135]
  buffer_load_dwordx4 v250, s[20:23], s57 offen offset:0  lds
  v_mfma_f32_16x16x32_bf16 v[132:135], v[172:175], a[80:83], v[132:135]
  s_add_u32 s57, s47, 72704
  ds_read_b64_tr_b16 v[178:179], v237 offset:18432
  v_mfma_f32_16x16x32_bf16 v[136:139], v[172:175], a[84:87], v[136:139]
  ds_read_b64_tr_b16 v[180:181], v237 offset:13312
  v_mfma_f32_16x16x32_bf16 v[136:139], v[168:171], a[68:71], v[136:139]
  ds_read_b64_tr_b16 v[182:183], v237 offset:19456
  v_mfma_f32_16x16x32_bf16 v[136:139], v[164:167], a[52:55], v[136:139]
  buffer_load_dwordx4 v250, s[20:23], s57 offen offset:1024  lds
  v_mfma_f32_16x16x32_bf16 v[140:143], v[164:167], a[56:59], v[140:143]
  s_add_u32 s57, s48, 71680
  ds_read_b64_tr_b16 v[184:185], v237 offset:14336
  v_mfma_f32_16x16x32_bf16 v[140:143], v[168:171], a[72:75], v[140:143]
  ds_read_b64_tr_b16 v[186:187], v237 offset:20480
  v_mfma_f32_16x16x32_bf16 v[140:143], v[172:175], a[88:91], v[140:143]
  v_mfma_f32_16x16x32_bf16 v[144:147], v[172:175], a[92:95], v[144:147]
  buffer_load_dwordx4 v250, s[20:23], s57 offen offset:2048  lds
  v_mfma_f32_16x16x32_bf16 v[144:147], v[168:171], a[76:79], v[144:147]
  s_add_u32 m0, s35, 147456
  s_add_u32 s57, s46, 110592
  v_mfma_f32_16x16x32_bf16 v[144:147], v[164:167], a[60:63], v[144:147]
  s_waitcnt lgkmcnt(0)
  v_mfma_f32_16x16x32_bf16 v[160:163], v[176:179], a[60:63], v[160:163]
  ds_read_b64_tr_b16 v[164:165], v238 offset:12288
  v_mfma_f32_16x16x32_bf16 v[160:163], v[180:183], a[76:79], v[160:163]
  buffer_load_dwordx4 v250, s[20:23], s57 offen offset:0  lds
  v_mfma_f32_16x16x32_bf16 v[160:163], v[184:187], a[92:95], v[160:163]
  s_add_u32 s57, s47, 109568
  ds_read_b64_tr_b16 v[166:167], v238 offset:18432
  v_mfma_f32_16x16x32_bf16 v[156:159], v[184:187], a[88:91], v[156:159]
  ds_read_b64_tr_b16 v[168:169], v238 offset:13312
  v_mfma_f32_16x16x32_bf16 v[156:159], v[180:183], a[72:75], v[156:159]
  ds_read_b64_tr_b16 v[170:171], v238 offset:19456
  v_mfma_f32_16x16x32_bf16 v[156:159], v[176:179], a[56:59], v[156:159]
  buffer_load_dwordx4 v250, s[20:23], s57 offen offset:1024  lds
  v_mfma_f32_16x16x32_bf16 v[152:155], v[176:179], a[52:55], v[152:155]
  s_add_u32 s57, s48, 108544
  ds_read_b64_tr_b16 v[172:173], v238 offset:14336
  v_mfma_f32_16x16x32_bf16 v[152:155], v[180:183], a[68:71], v[152:155]
  ds_read_b64_tr_b16 v[174:175], v238 offset:20480
  v_mfma_f32_16x16x32_bf16 v[152:155], v[184:187], a[84:87], v[152:155]
  v_mfma_f32_16x16x32_bf16 v[148:151], v[184:187], a[80:83], v[148:151]
  buffer_load_dwordx4 v250, s[20:23], s57 offen offset:2048  lds
  v_mfma_f32_16x16x32_bf16 v[148:151], v[180:183], a[64:67], v[148:151]
  v_mov_b32 v255, 0
  v_mfma_f32_16x16x32_bf16 v[148:151], v[176:179], a[48:51], v[148:151]
  s_waitcnt lgkmcnt(0)
  v_mfma_f32_16x16x32_bf16 v[4:7], v[164:167], a[48:51], v[4:7]
  ds_read_b64_tr_b16 v[176:177], v239 offset:12288
  v_mfma_f32_16x16x32_bf16 v[4:7], v[168:171], a[64:67], v[4:7]
  ds_read_b64_tr_b16 v[178:179], v239 offset:18432
  v_mfma_f32_16x16x32_bf16 v[4:7], v[172:175], a[80:83], v[4:7]
  ds_read_b64_tr_b16 v[180:181], v239 offset:13312
  v_mfma_f32_16x16x32_bf16 v[8:11], v[172:175], a[84:87], v[8:11]
  ds_read_b64_tr_b16 v[182:183], v239 offset:19456
  v_mfma_f32_16x16x32_bf16 v[8:11], v[168:171], a[68:71], v[8:11]
  ds_read_b64_tr_b16 v[184:185], v239 offset:14336
  v_mfma_f32_16x16x32_bf16 v[8:11], v[164:167], a[52:55], v[8:11]
  ds_read_b64_tr_b16 v[186:187], v239 offset:20480
  v_mfma_f32_16x16x32_bf16 v[12:15], v[164:167], a[56:59], v[12:15]
  v_mfma_f32_16x16x32_bf16 v[12:15], v[168:171], a[72:75], v[12:15]
  v_mfma_f32_16x16x32_bf16 v[12:15], v[172:175], a[88:91], v[12:15]
  v_mfma_f32_16x16x32_bf16 v[16:19], v[172:175], a[92:95], v[16:19]
  v_mfma_f32_16x16x32_bf16 v[16:19], v[168:171], a[76:79], v[16:19]
  v_mfma_f32_16x16x32_bf16 v[16:19], v[164:167], a[60:63], v[16:19]
  s_waitcnt lgkmcnt(0)
  v_mfma_f32_16x16x32_bf16 v[32:35], v[176:179], a[60:63], v[32:35]
  ds_read_b64_tr_b16 v[164:165], v248 offset:5120
  v_mfma_f32_16x16x32_bf16 v[32:35], v[180:183], a[76:79], v[32:35]
  ds_read_b64_tr_b16 v[166:167], v248 offset:5632
  v_mfma_f32_16x16x32_bf16 v[32:35], v[184:187], a[92:95], v[32:35]
  ds_read_b64_tr_b16 v[168:169], v248 offset:8192
  v_mfma_f32_16x16x32_bf16 v[28:31], v[184:187], a[88:91], v[28:31]
  ds_read_b64_tr_b16 v[170:171], v248 offset:8704
  v_mfma_f32_16x16x32_bf16 v[28:31], v[180:183], a[72:75], v[28:31]
  buffer_atomic_add v255, v254, s[28:31], s42 offen offset:128 sc0 sc1
  v_mfma_f32_16x16x32_bf16 v[28:31], v[176:179], a[56:59], v[28:31]
  ds_read_b64_tr_b16 v[172:173], v248 offset:9216
  v_mfma_f32_16x16x32_bf16 v[24:27], v[176:179], a[52:55], v[24:27]
  ds_read_b64_tr_b16 v[174:175], v248 offset:9728
  v_mfma_f32_16x16x32_bf16 v[24:27], v[180:183], a[68:71], v[24:27]
  v_mfma_f32_16x16x32_bf16 v[24:27], v[184:187], a[84:87], v[24:27]
  s_waitcnt vmcnt(8)
  buffer_atomic_add v0, v254, s[28:31], s42 offen offset:256 sc1
  v_mfma_f32_16x16x32_bf16 v[20:23], v[184:187], a[80:83], v[20:23]
  s_add_u32 m0, s35, 36864
  s_add_u32 s57, s46, 73728
  v_mfma_f32_16x16x32_bf16 v[20:23], v[180:183], a[64:67], v[20:23]
  v_mfma_f32_16x16x32_bf16 v[20:23], v[176:179], a[48:51], v[20:23]
  s_waitcnt lgkmcnt(0)
  v_mfma_f32_16x16x32_bf16 v[36:39], v[164:167], a[48:51], v[36:39]
  ds_read_b64_tr_b16 v[176:177], v236 offset:36864
  v_mfma_f32_16x16x32_bf16 v[36:39], v[168:171], a[64:67], v[36:39]
  ds_read_b64_tr_b16 v[178:179], v236 offset:43008
  v_mfma_f32_16x16x32_bf16 v[36:39], v[172:175], a[80:83], v[36:39]
  ds_read_b64_tr_b16 v[180:181], v236 offset:37888
  v_mfma_f32_16x16x32_bf16 v[40:43], v[172:175], a[84:87], v[40:43]
  ds_read_b64_tr_b16 v[182:183], v236 offset:44032
  v_mfma_f32_16x16x32_bf16 v[40:43], v[168:171], a[68:71], v[40:43]
  ds_read_b64_tr_b16 v[184:185], v236 offset:38912
  v_mfma_f32_16x16x32_bf16 v[40:43], v[164:167], a[52:55], v[40:43]
  ds_read_b64_tr_b16 v[186:187], v236 offset:45056
  v_mfma_f32_16x16x32_bf16 v[44:47], v[164:167], a[56:59], v[44:47]
  v_mfma_f32_16x16x32_bf16 v[44:47], v[168:171], a[72:75], v[44:47]
  v_mfma_f32_16x16x32_bf16 v[44:47], v[172:175], a[88:91], v[44:47]
  v_mfma_f32_16x16x32_bf16 v[48:51], v[172:175], a[92:95], v[48:51]
  v_mfma_f32_16x16x32_bf16 v[48:51], v[168:171], a[76:79], v[48:51]
  v_mfma_f32_16x16x32_bf16 v[48:51], v[164:167], a[60:63], v[48:51]
  s_waitcnt lgkmcnt(0)
  s_barrier
  v_mfma_f32_16x16x32_bf16 v[60:63], v[176:179], a[56:59], v[60:63]
  ds_read_b64_tr_b16 v[164:165], v236 offset:49152
  v_mfma_f32_16x16x32_bf16 v[60:63], v[180:183], a[72:75], v[60:63]
  ds_read_b64_tr_b16 v[166:167], v236 offset:55296
  v_mfma_f32_16x16x32_bf16 v[60:63], v[184:187], a[88:91], v[60:63]
  ds_read_b64_tr_b16 v[168:169], v236 offset:50176
  v_mfma_f32_16x16x32_bf16 v[56:59], v[184:187], a[84:87], v[56:59]
  ds_read_b64_tr_b16 v[170:171], v236 offset:56320
  v_mfma_f32_16x16x32_bf16 v[56:59], v[180:183], a[68:71], v[56:59]
  ds_read_b64_tr_b16 v[172:173], v236 offset:51200
  v_mfma_f32_16x16x32_bf16 v[56:59], v[176:179], a[52:55], v[56:59]
  ds_read_b64_tr_b16 v[174:175], v236 offset:57344
  v_mfma_f32_16x16x32_bf16 v[52:55], v[176:179], a[48:51], v[52:55]
  buffer_load_dwordx4 v251, s[20:23], s57 offen offset:0  lds
  v_mfma_f32_16x16x32_bf16 v[52:55], v[180:183], a[64:67], v[52:55]
  s_add_u32 s57, s47, 72704
  v_mfma_f32_16x16x32_bf16 v[52:55], v[184:187], a[80:83], v[52:55]
  s_waitcnt lgkmcnt(0)
  v_mfma_f32_16x16x32_bf16 v[132:135], v[164:167], a[96:99], v[132:135]
  ds_read_b64_tr_b16 v[176:177], v237 offset:49152
  v_mfma_f32_16x16x32_bf16 v[132:135], v[168:171], a[112:115], v[132:135]
  buffer_load_dwordx4 v251, s[20:23], s57 offen offset:1024  lds
  v_mfma_f32_16x16x32_bf16 v[132:135], v[172:175], a[128:131], v[132:135]
  s_add_u32 s57, s48, 71680
  ds_read_b64_tr_b16 v[178:179], v237 offset:55296
  v_mfma_f32_16x16x32_bf16 v[136:139], v[172:175], a[132:135], v[136:139]
  ds_read_b64_tr_b16 v[180:181], v237 offset:50176
  v_mfma_f32_16x16x32_bf16 v[136:139], v[168:171], a[116:119], v[136:139]
  ds_read_b64_tr_b16 v[182:183], v237 offset:56320
  v_mfma_f32_16x16x32_bf16 v[136:139], v[164:167], a[100:103], v[136:139]
  buffer_load_dwordx4 v251, s[20:23], s57 offen offset:2048  lds
  v_mfma_f32_16x16x32_bf16 v[140:143], v[164:167], a[104:107], v[140:143]
  s_add_u32 m0, s35, 49152
  ds_read_b64_tr_b16 v[184:185], v237 offset:51200
  s_add_u32 s57, s46, 110592
  v_mfma_f32_16x16x32_bf16 v[140:143], v[168:171], a[120:123], v[140:143]
  ds_read_b64_tr_b16 v[186:187], v237 offset:57344
  v_mfma_f32_16x16x32_bf16 v[140:143], v[172:175], a[136:139], v[140:143]
  v_mfma_f32_16x16x32_bf16 v[144:147], v[172:175], a[140:143], v[144:147]
  buffer_load_dwordx4 v251, s[20:23], s57 offen offset:0  lds
  v_mfma_f32_16x16x32_bf16 v[144:147], v[168:171], a[124:127], v[144:147]
  s_add_u32 s57, s47, 109568
  v_mfma_f32_16x16x32_bf16 v[144:147], v[164:167], a[108:111], v[144:147]
  s_waitcnt lgkmcnt(0)
  v_mfma_f32_16x16x32_bf16 v[160:163], v[176:179], a[108:111], v[160:163]
  ds_read_b64_tr_b16 v[164:165], v238 offset:49152
  v_mfma_f32_16x16x32_bf16 v[160:163], v[180:183], a[124:127], v[160:163]
  buffer_load_dwordx4 v251, s[20:23], s57 offen offset:1024  lds
  v_mfma_f32_16x16x32_bf16 v[160:163], v[184:187], a[140:143], v[160:163]
  s_add_u32 s57, s48, 108544
  ds_read_b64_tr_b16 v[166:167], v238 offset:55296
  v_mfma_f32_16x16x32_bf16 v[156:159], v[184:187], a[136:139], v[156:159]
  ds_read_b64_tr_b16 v[168:169], v238 offset:50176
  v_mfma_f32_16x16x32_bf16 v[156:159], v[180:183], a[120:123], v[156:159]
  ds_read_b64_tr_b16 v[170:171], v238 offset:56320
  v_mfma_f32_16x16x32_bf16 v[156:159], v[176:179], a[104:107], v[156:159]
  buffer_load_dwordx4 v251, s[20:23], s57 offen offset:2048  lds
  v_mfma_f32_16x16x32_bf16 v[152:155], v[176:179], a[100:103], v[152:155]
  ds_read_b64_tr_b16 v[172:173], v238 offset:51200
  v_mfma_f32_16x16x32_bf16 v[152:155], v[180:183], a[116:119], v[152:155]
  ds_read_b64_tr_b16 v[174:175], v238 offset:57344
  v_mfma_f32_16x16x32_bf16 v[152:155], v[184:187], a[132:135], v[152:155]
  v_mfma_f32_16x16x32_bf16 v[148:151], v[184:187], a[128:131], v[148:151]
  v_mfma_f32_16x16x32_bf16 v[148:151], v[180:183], a[112:115], v[148:151]
  v_mfma_f32_16x16x32_bf16 v[148:151], v[176:179], a[96:99], v[148:151]
  s_waitcnt lgkmcnt(0)
  v_mfma_f32_16x16x32_bf16 v[4:7], v[164:167], a[96:99], v[4:7]
  ds_read_b64_tr_b16 v[176:177], v239 offset:49152
  v_mfma_f32_16x16x32_bf16 v[4:7], v[168:171], a[112:115], v[4:7]
  ds_read_b64_tr_b16 v[178:179], v239 offset:55296
  v_mfma_f32_16x16x32_bf16 v[4:7], v[172:175], a[128:131], v[4:7]
  ds_read_b64_tr_b16 v[180:181], v239 offset:50176
  v_mfma_f32_16x16x32_bf16 v[8:11], v[172:175], a[132:135], v[8:11]
  ds_read_b64_tr_b16 v[182:183], v239 offset:56320
  v_mfma_f32_16x16x32_bf16 v[8:11], v[168:171], a[116:119], v[8:11]
  ds_read_b64_tr_b16 v[184:185], v239 offset:51200
  v_mfma_f32_16x16x32_bf16 v[8:11], v[164:167], a[100:103], v[8:11]
  ds_read_b64_tr_b16 v[186:187], v239 offset:57344
  v_mfma_f32_16x16x32_bf16 v[12:15], v[164:167], a[104:107], v[12:15]
  s_waitcnt vmcnt(7)
  v_readfirstlane_b32 s62, v255
  v_mfma_f32_16x16x32_bf16 v[12:15], v[168:171], a[120:123], v[12:15]
  s_nop 1
  s_cmp_ge_u32 s62, 4
  s_cbranch_scc0 Lp7_slow
Lp7_ok:
  s_add_u32 s60, s50, 8192
  v_mfma_f32_16x16x32_bf16 v[12:15], v[172:175], a[136:139], v[12:15]
  buffer_load_dwordx4 a[160:163], v252, s[28:31], s60 offen offset:0 sc1
  v_mfma_f32_16x16x32_bf16 v[16:19], v[172:175], a[140:143], v[16:19]
  v_mfma_f32_16x16x32_bf16 v[16:19], v[168:171], a[124:127], v[16:19]
  v_mfma_f32_16x16x32_bf16 v[16:19], v[164:167], a[108:111], v[16:19]
  s_waitcnt lgkmcnt(0)
  v_mfma_f32_16x16x32_bf16 v[32:35], v[176:179], a[108:111], v[32:35]
  buffer_load_dwordx4 a[164:167], v252, s[28:31], s60 offen offset:1024 sc1
  v_mfma_f32_16x16x32_bf16 v[32:35], v[180:183], a[124:127], v[32:35]
  ds_read_b64_tr_b16 v[164:165], v248 offset:12288
  v_mfma_f32_16x16x32_bf16 v[32:35], v[184:187], a[140:143], v[32:35]
  ds_read_b64_tr_b16 v[166:167], v248 offset:12800
  v_mfma_f32_16x16x32_bf16 v[28:31], v[184:187], a[136:139], v[28:31]
  ds_read_b64_tr_b16 v[168:169], v248 offset:13312
  v_mfma_f32_16x16x32_bf16 v[28:31], v[180:183], a[120:123], v[28:31]
  buffer_load_dwordx4 a[168:171], v252, s[28:31], s60 offen offset:2048 sc1
  v_mfma_f32_16x16x32_bf16 v[28:31], v[176:179], a[104:107], v[28:31]
  ds_read_b64_tr_b16 v[170:171], v248 offset:13824
  v_mfma_f32_16x16x32_bf16 v[24:27], v[176:179], a[100:103], v[24:27]
  ds_read_b64_tr_b16 v[172:173], v248 offset:16384
  v_mfma_f32_16x16x32_bf16 v[24:27], v[180:183], a[116:119], v[24:27]
  ds_read_b64_tr_b16 v[174:175], v248 offset:16896
  v_mfma_f32_16x16x32_bf16 v[24:27], v[184:187], a[132:135], v[24:27]
  buffer_load_dwordx4 a[172:175], v252, s[28:31], s60 offen offset:3072 sc1
  v_mfma_f32_16x16x32_bf16 v[20:23], v[184:187], a[128:131], v[20:23]
  v_mov_b32 v255, 0
  v_mfma_f32_16x16x32_bf16 v[20:23], v[180:183], a[112:115], v[20:23]
  v_mfma_f32_16x16x32_bf16 v[20:23], v[176:179], a[96:99], v[20:23]
  s_waitcnt lgkmcnt(0)
  v_mfma_f32_16x16x32_bf16 v[36:39], v[164:167], a[96:99], v[36:39]
  ds_read_b64_tr_b16 v[176:177], v240 offset:12288
  v_mfma_f32_16x16x32_bf16 v[36:39], v[168:171], a[112:115], v[36:39]
  buffer_atomic_add v255, v254, s[28:31], s42 offen offset:256 sc0 sc1
  v_mfma_f32_16x16x32_bf16 v[36:39], v[172:175], a[128:131], v[36:39]
  s_add_u32 s60, s51, 8192
  ds_read_b64_tr_b16 v[178:179], v240 offset:18432
  v_mfma_f32_16x16x32_bf16 v[40:43], v[172:175], a[132:135], v[40:43]
  ds_read_b64_tr_b16 v[180:181], v240 offset:13312
  v_mfma_f32_16x16x32_bf16 v[40:43], v[168:171], a[116:119], v[40:43]
  ds_read_b64_tr_b16 v[182:183], v240 offset:19456
  v_mfma_f32_16x16x32_bf16 v[40:43], v[164:167], a[100:103], v[40:43]
  buffer_load_dwordx4 a[176:179], v252, s[28:31], s60 offen offset:0 sc1
  v_mfma_f32_16x16x32_bf16 v[44:47], v[164:167], a[104:107], v[44:47]
  ds_read_b64_tr_b16 v[184:185], v240 offset:14336
  v_mfma_f32_16x16x32_bf16 v[44:47], v[168:171], a[120:123], v[44:47]
  ds_read_b64_tr_b16 v[186:187], v240 offset:20480
  v_mfma_f32_16x16x32_bf16 v[44:47], v[172:175], a[136:139], v[44:47]
  v_mfma_f32_16x16x32_bf16 v[48:51], v[172:175], a[140:143], v[48:51]
  buffer_load_dwordx4 a[180:183], v252, s[28:31], s60 offen offset:1024 sc1
  v_mfma_f32_16x16x32_bf16 v[48:51], v[168:171], a[124:127], v[48:51]
  v_mfma_f32_16x16x32_bf16 v[48:51], v[164:167], a[108:111], v[48:51]
  s_waitcnt lgkmcnt(0)
  v_mfma_f32_16x16x32_bf16 v[60:63], v[176:179], a[104:107], v[60:63]
  ds_read_b64_tr_b16 v[164:165], v240 offset:0
  v_mfma_f32_16x16x32_bf16 v[60:63], v[180:183], a[120:123], v[60:63]
  ds_read_b64_tr_b16 v[166:167], v240 offset:6144
  v_mfma_f32_16x16x32_bf16 v[60:63], v[184:187], a[136:139], v[60:63]
  ds_read_b64_tr_b16 v[168:169], v240 offset:1024
  v_mfma_f32_16x16x32_bf16 v[56:59], v[184:187], a[132:135], v[56:59]
  ds_read_b64_tr_b16 v[170:171], v240 offset:7168
  v_mfma_f32_16x16x32_bf16 v[56:59], v[180:183], a[116:119], v[56:59]
  ds_read_b64_tr_b16 v[172:173], v240 offset:2048
  v_mfma_f32_16x16x32_bf16 v[56:59], v[176:179], a[100:103], v[56:59]
  ds_read_b64_tr_b16 v[174:175], v240 offset:8192
  v_mfma_f32_16x16x32_bf16 v[52:55], v[176:179], a[96:99], v[52:55]
  buffer_load_dwordx4 a[184:187], v252, s[28:31], s60 offen offset:2048 sc1
  v_mfma_f32_16x16x32_bf16 v[52:55], v[180:183], a[112:115], v[52:55]
  v_mfma_f32_16x16x32_bf16 v[52:55], v[184:187], a[128:131], v[52:55]
  s_waitcnt lgkmcnt(0)
  v_mfma_f32_16x16x32_bf16 v[132:135], v[164:167], a[144:147], v[132:135]
  ds_read_b64_tr_b16 v[176:177], v241 offset:0
  v_mfma_f32_16x16x32_bf16 v[132:135], v[168:171], v[188:191], v[132:135]
  buffer_load_dwordx4 a[188:191], v252, s[28:31], s60 offen offset:3072 sc1
  v_mfma_f32_16x16x32_bf16 v[132:135], v[172:175], v[204:207], v[132:135]
  s_add_u32 s60, s52, 8192
  ds_read_b64_tr_b16 v[178:179], v241 offset:6144
  v_mfma_f32_16x16x32_bf16 v[136:139], v[172:175], v[208:211], v[136:139]
  ds_read_b64_tr_b16 v[180:181], v241 offset:1024
  v_mfma_f32_16x16x32_bf16 v[136:139], v[168:171], v[192:195], v[136:139]
  ds_read_b64_tr_b16 v[182:183], v241 offset:7168
  v_mfma_f32_16x16x32_bf16 v[136:139], v[164:167], a[148:151], v[136:139]
  buffer_load_dwordx4 a[192:195], v252, s[28:31], s60 offen offset:0 sc1
  v_mfma_f32_16x16x32_bf16 v[140:143], v[164:167], a[152:155], v[140:143]
  ds_read_b64_tr_b16 v[184:185], v241 offset:2048
  v_mfma_f32_16x16x32_bf16 v[140:143], v[168:171], v[196:199], v[140:143]
  ds_read_b64_tr_b16 v[186:187], v241 offset:8192
  v_mfma_f32_16x16x32_bf16 v[140:143], v[172:175], v[212:215], v[140:143]
  v_mfma_f32_16x16x32_bf16 v[144:147], v[172:175], v[216:219], v[144:147]
  buffer_load_dwordx4 a[196:199], v252, s[28:31], s60 offen offset:1024 sc1
  v_mfma_f32_16x16x32_bf16 v[144:147], v[168:171], v[200:203], v[144:147]
  v_mfma_f32_16x16x32_bf16 v[144:147], v[164:167], a[156:159], v[144:147]
  s_waitcnt lgkmcnt(0)
  v_mfma_f32_16x16x32_bf16 v[160:163], v[176:179], a[156:159], v[160:163]
  ds_read_b64_tr_b16 v[164:165], v242 offset:0
  v_mfma_f32_16x16x32_bf16 v[160:163], v[180:183], v[200:203], v[160:163]
  buffer_load_dwordx4 a[200:203], v252, s[28:31], s60 offen offset:2048 sc1
  v_mfma_f32_16x16x32_bf16 v[160:163], v[184:187], v[216:219], v[160:163]
  ds_read_b64_tr_b16 v[166:167], v242 offset:6144
  v_mfma_f32_16x16x32_bf16 v[156:159], v[184:187], v[212:215], v[156:159]
  ds_read_b64_tr_b16 v[168:169], v242 offset:1024
  v_mfma_f32_16x16x32_bf16 v[156:159], v[180:183], v[196:199], v[156:159]
  ds_read_b64_tr_b16 v[170:171], v242 offset:7168
  v_mfma_f32_16x16x32_bf16 v[156:159], v[176:179], a[152:155], v[156:159]
  buffer_load_dwordx4 a[204:207], v252, s[28:31], s60 offen offset:3072 sc1
  v_mfma_f32_16x16x32_bf16 v[152:155], v[176:179], a[148:151], v[152:155]
  ds_read_b64_tr_b16 v[172:173], v242 offset:2048
  v_mfma_f32_16x16x32_bf16 v[152:155], v[180:183], v[192:195], v[152:155]
  ds_read_b64_tr_b16 v[174:175], v242 offset:8192
  v_mfma_f32_16x16x32_bf16 v[152:155], v[184:187], v[208:211], v[152:155]
  v_mfma_f32_16x16x32_bf16 v[148:151], v[184:187], v[204:207], v[148:151]
  v_mfma_f32_16x16x32_bf16 v[148:151], v[180:183], v[188:191], v[148:151]
  v_mfma_f32_16x16x32_bf16 v[148:151], v[176:179], a[144:147], v[148:151]
  s_waitcnt lgkmcnt(0)
  v_mfma_f32_16x16x32_bf16 v[4:7], v[164:167], a[144:147], v[4:7]
  ds_read_b64_tr_b16 v[176:177], v243 offset:0
  v_mfma_f32_16x16x32_bf16 v[4:7], v[168:171], v[188:191], v[4:7]
  ds_read_b64_tr_b16 v[178:179], v243 offset:6144
  v_mfma_f32_16x16x32_bf16 v[4:7], v[172:175], v[204:207], v[4:7]
  ds_read_b64_tr_b16 v[180:181], v243 offset:1024
  v_mfma_f32_16x16x32_bf16 v[8:11], v[172:175], v[208:211], v[8:11]
  ds_read_b64_tr_b16 v[182:183], v243 offset:7168
  v_mfma_f32_16x16x32_bf16 v[8:11], v[168:171], v[192:195], v[8:11]
  ds_read_b64_tr_b16 v[184:185], v243 offset:2048
  v_mfma_f32_16x16x32_bf16 v[8:11], v[164:167], a[148:151], v[8:11]
  ds_read_b64_tr_b16 v[186:187], v243 offset:8192
  v_mfma_f32_16x16x32_bf16 v[12:15], v[164:167], a[152:155], v[12:15]
  v_mfma_f32_16x16x32_bf16 v[12:15], v[168:171], v[196:199], v[12:15]
  v_mfma_f32_16x16x32_bf16 v[12:15], v[172:175], v[212:215], v[12:15]
  v_mfma_f32_16x16x32_bf16 v[16:19], v[172:175], v[216:219], v[16:19]
  v_mfma_f32_16x16x32_bf16 v[16:19], v[168:171], v[200:203], v[16:19]
  v_mfma_f32_16x16x32_bf16 v[16:19], v[164:167], a[156:159], v[16:19]
  s_waitcnt lgkmcnt(0)
  s_waitcnt vmcnt(8)
  v_readfirstlane_b32 s62, v255
  v_mfma_f32_16x16x32_bf16 v[32:35], v[176:179], a[156:159], v[32:35]
  ds_read_b64_tr_b16 v[164:165], v248 offset:17408
  v_mfma_f32_16x16x32_bf16 v[32:35], v[180:183], v[200:203], v[32:35]
  ds_read_b64_tr_b16 v[166:167], v248 offset:17920
L_hopb3:
  s_cbranch_execz L_mainb
  v_mfma_f32_16x16x32_bf16 v[32:35], v[184:187], v[216:219], v[32:35]
  v_add_u32 v2, s53, v248
  ds_read_b64_tr_b16 v[168:169], v2 offset:2048
  v_mfma_f32_16x16x32_bf16 v[28:31], v[184:187], v[212:215], v[28:31]
  ds_read_b64_tr_b16 v[170:171], v2 offset:2560
  v_mfma_f32_16x16x32_bf16 v[28:31], v[180:183], v[196:199], v[28:31]
  v_add_u32 v3, s53, v248
  ds_read_b64_tr_b16 v[172:173], v3 offset:3072
  v_mfma_f32_16x16x32_bf16 v[28:31], v[176:179], a[152:155], v[28:31]
  ds_read_b64_tr_b16 v[174:175], v3 offset:3584
  v_mfma_f32_16x16x32_bf16 v[24:27], v[176:179], a[148:151], v[24:27]
  s_cmp_ge_u32 s62, 4
  s_cbranch_scc0 Lp8_slow
Lp8_ok:
  s_add_u32 s60, s50, 12288
  v_mfma_f32_16x16x32_bf16 v[24:27], v[180:183], v[192:195], v[24:27]
  buffer_load_dwordx4 a[208:211], v252, s[28:31], s60 offen offset:0 sc1
  v_mfma_f32_16x16x32_bf16 v[24:27], v[184:187], v[208:211], v[24:27]
  v_mfma_f32_16x16x32_bf16 v[20:23], v[184:187], v[204:207], v[20:23]
  v_mfma_f32_16x16x32_bf16 v[20:23], v[180:183], v[188:191], v[20:23]
  v_mfma_f32_16x16x32_bf16 v[20:23], v[176:179], a[144:147], v[20:23]
  s_waitcnt lgkmcnt(0)
  v_mfma_f32_16x16x32_bf16 v[36:39], v[164:167], a[144:147], v[36:39]
  buffer_load_dwordx4 a[212:215], v252, s[28:31], s60 offen offset:1024 sc1
  v_mfma_f32_16x16x32_bf16 v[36:39], v[168:171], v[188:191], v[36:39]
  ds_read_b64_tr_b16 v[176:177], v240 offset:24576
  v_mfma_f32_16x16x32_bf16 v[36:39], v[172:175], v[204:207], v[36:39]
  ds_read_b64_tr_b16 v[178:179], v240 offset:30720
  v_mfma_f32_16x16x32_bf16 v[40:43], v[172:175], v[208:211], v[40:43]
  ds_read_b64_tr_b16 v[180:181], v240 offset:25600
  v_mfma_f32_16x16x32_bf16 v[40:43], v[168:171], v[192:195], v[40:43]
  buffer_load_dwordx4 a[216:219], v252, s[28:31], s60 offen offset:2048 sc1
  v_mfma_f32_16x16x32_bf16 v[40:43], v[164:167], a[148:151], v[40:43]
  ds_read_b64_tr_b16 v[182:183], v240 offset:31744
  v_mfma_f32_16x16x32_bf16 v[44:47], v[164:167], a[152:155], v[44:47]
  ds_read_b64_tr_b16 v[184:185], v240 offset:26624
  v_mfma_f32_16x16x32_bf16 v[44:47], v[168:171], v[196:199], v[44:47]
  ds_read_b64_tr_b16 v[186:187], v240 offset:32768
  v_mfma_f32_16x16x32_bf16 v[44:47], v[172:175], v[212:215], v[44:47]
  buffer_load_dwordx4 a[220:223], v252, s[28:31], s60 offen offset:3072 sc1
  v_mfma_f32_16x16x32_bf16 v[48:51], v[172:175], v[216:219], v[48:51]
  s_add_u32 s60, s51, 12288
  v_mfma_f32_16x16x32_bf16 v[48:51], v[168:171], v[200:203], v[48:51]
  v_mfma_f32_16x16x32_bf16 v[48:51], v[164:167], a[156:159], v[48:51]
  s_waitcnt lgkmcnt(0)
  s_barrier
  v_mfma_f32_16x16x32_bf16 v[60:63], v[176:179], a[152:155], v[60:63]
  ds_read_b64_tr_b16 v[164:165], v240 offset:36864
  v_mfma_f32_16x16x32_bf16 v[60:63], v[180:183], v[196:199], v[60:63]
  ds_read_b64_tr_b16 v[166:167], v240 offset:43008
  v_mfma_f32_16x16x32_bf16 v[60:63], v[184:187], v[212:215], v[60:63]
  ds_read_b64_tr_b16 v[168:169], v240 offset:37888
  v_mfma_f32_16x16x32_bf16 v[56:59], v[184:187], v[208:211], v[56:59]
  ds_read_b64_tr_b16 v[170:171], v240 offset:44032
  v_mfma_f32_16x16x32_bf16 v[56:59], v[180:183], v[192:195], v[56:59]
  ds_read_b64_tr_b16 v[172:173], v240 offset:38912
  v_mfma_f32_16x16x32_bf16 v[56:59], v[176:179], a[148:151], v[56:59]
  ds_read_b64_tr_b16 v[174:175], v240 offset:45056
  v_mfma_f32_16x16x32_bf16 v[52:55], v[176:179], a[144:147], v[52:55]
  buffer_load_dwordx4 a[224:227], v252, s[28:31], s60 offen offset:0 sc1
  v_mfma_f32_16x16x32_bf16 v[52:55], v[180:183], v[188:191], v[52:55]
  v_mfma_f32_16x16x32_bf16 v[52:55], v[184:187], v[204:207], v[52:55]
  s_waitcnt lgkmcnt(0) vmcnt(5)
  v_mfma_f32_16x16x32_bf16 v[132:135], v[164:167], a[160:163], v[132:135]
  ds_read_b64_tr_b16 v[176:177], v241 offset:36864
  v_mfma_f32_16x16x32_bf16 v[132:135], v[168:171], a[176:179], v[132:135]
  buffer_load_dwordx4 a[228:231], v252, s[28:31], s60 offen offset:1024 sc1
  v_mfma_f32_16x16x32_bf16 v[132:135], v[172:175], a[192:195], v[132:135]
  ds_read_b64_tr_b16 v[178:179], v241 offset:43008
  v_mfma_f32_16x16x32_bf16 v[136:139], v[172:175], a[196:199], v[136:139]
  ds_read_b64_tr_b16 v[180:181], v241 offset:37888
  v_mfma_f32_16x16x32_bf16 v[136:139], v[168:171], a[180:183], v[136:139]
  ds_read_b64_tr_b16 v[182:183], v241 offset:44032
  v_mfma_f32_16x16x32_bf16 v[136:139], v[164:167], a[164:167], v[136:139]
  buffer_load_dwordx4 a[232:235], v252, s[28:31], s60 offen offset:2048 sc1
  v_mfma_f32_16x16x32_bf16 v[140:143], v[164:167], a[168:171], v[140:143]
  ds_read_b64_tr_b16 v[184:185], v241 offset:38912
  v_mfma_f32_16x16x32_bf16 v[140:143], v[168:171], a[184:187], v[140:143]
  ds_read_b64_tr_b16 v[186:187], v241 offset:45056
  v_mfma_f32_16x16x32_bf16 v[140:143], v[172:175], a[200:203], v[140:143]
  v_mfma_f32_16x16x32_bf16 v[144:147], v[172:175], a[204:207], v[144:147]
  buffer_load_dwordx4 a[236:239], v252, s[28:31], s60 offen offset:3072 sc1
  v_mfma_f32_16x16x32_bf16 v[144:147], v[168:171], a[188:191], v[144:147]
  s_add_u32 s60, s52, 12288
  v_mfma_f32_16x16x32_bf16 v[144:147], v[164:167], a[172:175], v[144:147]
  s_waitcnt lgkmcnt(0)
  v_mfma_f32_16x16x32_bf16 v[160:163], v[176:179], a[172:175], v[160:163]
  ds_read_b64_tr_b16 v[164:165], v242 offset:36864
  v_mfma_f32_16x16x32_bf16 v[160:163], v[180:183], a[188:191], v[160:163]
  buffer_load_dwordx4 a[240:243], v252, s[28:31], s60 offen offset:0 sc1
  v_mfma_f32_16x16x32_bf16 v[160:163], v[184:187], a[204:207], v[160:163]
  ds_read_b64_tr_b16 v[166:167], v242 offset:43008
  v_mfma_f32_16x16x32_bf16 v[156:159], v[184:187], a[200:203], v[156:159]
  ds_read_b64_tr_b16 v[168:169], v242 offset:37888
  v_mfma_f32_16x16x32_bf16 v[156:159], v[180:183], a[184:187], v[156:159]
  ds_read_b64_tr_b16 v[170:171], v242 offset:44032
  v_mfma_f32_16x16x32_bf16 v[156:159], v[176:179], a[168:171], v[156:159]
  buffer_load_dwordx4 a[244:247], v252, s[28:31], s60 offen offset:1024 sc1
  v_mfma_f32_16x16x32_bf16 v[152:155], v[176:179], a[164:167], v[152:155]
  ds_read_b64_tr_b16 v[172:173], v242 offset:38912
  v_mfma_f32_16x16x32_bf16 v[152:155], v[180:183], a[180:183], v[152:155]
  ds_read_b64_tr_b16 v[174:175], v242 offset:45056
  v_mfma_f32_16x16x32_bf16 v[152:155], v[184:187], a[196:199], v[152:155]
  v_mfma_f32_16x16x32_bf16 v[148:151], v[184:187], a[192:195], v[148:151]
  buffer_load_dwordx4 a[248:251], v252, s[28:31], s60 offen offset:2048 sc1
  v_mfma_f32_16x16x32_bf16 v[148:151], v[180:183], a[176:179], v[148:151]
  v_mfma_f32_16x16x32_bf16 v[148:151], v[176:179], a[160:163], v[148:151]
  s_waitcnt lgkmcnt(0)
  v_mfma_f32_16x16x32_bf16 v[4:7], v[164:167], a[160:163], v[4:7]
  ds_read_b64_tr_b16 v[176:177], v243 offset:36864
  v_mfma_f32_16x16x32_bf16 v[4:7], v[168:171], a[176:179], v[4:7]
  buffer_load_dwordx4 a[252:255], v252, s[28:31], s60 offen offset:3072 sc1
  v_mfma_f32_16x16x32_bf16 v[4:7], v[172:175], a[192:195], v[4:7]
  ds_read_b64_tr_b16 v[178:179], v243 offset:43008
  v_mfma_f32_16x16x32_bf16 v[8:11], v[172:175], a[196:199], v[8:11]
  ds_read_b64_tr_b16 v[180:181], v243 offset:37888
  v_mfma_f32_16x16x32_bf16 v[8:11], v[168:171], a[180:183], v[8:11]
  ds_read_b64_tr_b16 v[182:183], v243 offset:44032
  v_mfma_f32_16x16x32_bf16 v[8:11], v[164:167], a[164:167], v[8:11]
  ds_read_b64_tr_b16 v[184:185], v243 offset:38912
  v_mfma_f32_16x16x32_bf16 v[12:15], v[164:167], a[168:171], v[12:15]
  ds_read_b64_tr_b16 v[186:187], v243 offset:45056
  v_mfma_f32_16x16x32_bf16 v[12:15], v[168:171], a[184:187], v[12:15]
  v_bfe_u32 v249, v252, 4, 4
  s_lshl_b32 s57, s78, 6
  v_mfma_f32_16x16x32_bf16 v[12:15], v[172:175], a[200:203], v[12:15]
  v_lshlrev_b32 v249, 2, v249
  s_add_u32 s58, s57, 53477376
  v_mfma_f32_16x16x32_bf16 v[16:19], v[172:175], a[204:207], v[16:19]
  buffer_load_dword v131, v249, s[28:31], s58 offen sc1
  v_mfma_f32_16x16x32_bf16 v[16:19], v[168:171], a[188:191], v[16:19]
  v_and_b32 v118, 0x300, v252
  s_lshl_b32 s57, s57, 4
  v_mfma_f32_16x16x32_bf16 v[16:19], v[164:167], a[172:175], v[16:19]
  s_waitcnt lgkmcnt(0)
  v_add_u32 v249, v249, v118
  s_add_u32 s57, s57, 49283072
  v_mfma_f32_16x16x32_bf16 v[32:35], v[176:179], a[172:175], v[32:35]
  v_add_u32 v1, s54, v248
  ds_read_b64_tr_b16 v[164:165], v1 offset:2048
  v_mfma_f32_16x16x32_bf16 v[32:35], v[180:183], a[188:191], v[32:35]
  buffer_load_dword v116, v249, s[28:31], s57 offen sc1
  v_mfma_f32_16x16x32_bf16 v[32:35], v[184:187], a[204:207], v[32:35]
  ds_read_b64_tr_b16 v[166:167], v1 offset:2560
  v_add_u32 v2, s55, v248
  v_mfma_f32_16x16x32_bf16 v[28:31], v[184:187], a[200:203], v[28:31]
  ds_read_b64_tr_b16 v[168:169], v2 offset:2048
  v_mfma_f32_16x16x32_bf16 v[28:31], v[180:183], a[184:187], v[28:31]
  ds_read_b64_tr_b16 v[170:171], v2 offset:2560
  v_add_u32 v3, s56, v248
  v_mfma_f32_16x16x32_bf16 v[28:31], v[176:179], a[168:171], v[28:31]
  buffer_load_dword v117, v249, s[28:31], s57 offen offset:128 sc1
  v_mfma_f32_16x16x32_bf16 v[24:27], v[176:179], a[164:167], v[24:27]
  ds_read_b64_tr_b16 v[172:173], v3 offset:2048
  v_mfma_f32_16x16x32_bf16 v[24:27], v[180:183], a[180:183], v[24:27]
  ds_read_b64_tr_b16 v[174:175], v3 offset:2560
  v_mfma_f32_16x16x32_bf16 v[24:27], v[184:187], a[196:199], v[24:27]
  s_lshl_b32 s57, s65, 1
  s_add_u32 s57, s57, s79
  v_mfma_f32_16x16x32_bf16 v[20:23], v[184:187], a[192:195], v[20:23]
  s_lshl_b32 s57, s57, 13
  s_add_u32 s57, s57, s27
  v_mfma_f32_16x16x32_bf16 v[20:23], v[180:183], a[176:179], v[20:23]
  buffer_load_dwordx4 v[64:67], v252, s[28:31], s57 offen sc1
  v_mfma_f32_16x16x32_bf16 v[20:23], v[176:179], a[160:163], v[20:23]
  s_waitcnt lgkmcnt(0)
  s_add_u32 s57, s57, 4096
  v_mfma_f32_16x16x32_bf16 v[36:39], v[164:167], a[160:163], v[36:39]
  ds_read_b64_tr_b16 v[176:177], v236 offset:0
  v_mfma_f32_16x16x32_bf16 v[36:39], v[168:171], a[176:179], v[36:39]
  ds_read_b64_tr_b16 v[178:179], v236 offset:6144
  v_mfma_f32_16x16x32_bf16 v[36:39], v[172:175], a[192:195], v[36:39]
  buffer_load_dwordx4 v[80:83], v252, s[28:31], s57 offen sc1
  v_mfma_f32_16x16x32_bf16 v[40:43], v[172:175], a[196:199], v[40:43]
  ds_read_b64_tr_b16 v[180:181], v236 offset:1024
  v_mfma_f32_16x16x32_bf16 v[40:43], v[168:171], a[180:183], v[40:43]
  ds_read_b64_tr_b16 v[182:183], v236 offset:7168
  v_mfma_f32_16x16x32_bf16 v[40:43], v[164:167], a[164:167], v[40:43]
  ds_read_b64_tr_b16 v[184:185], v236 offset:2048
  v_mfma_f32_16x16x32_bf16 v[44:47], v[164:167], a[168:171], v[44:47]
  ds_read_b64_tr_b16 v[186:187], v236 offset:8192
  v_mfma_f32_16x16x32_bf16 v[44:47], v[168:171], a[184:187], v[44:47]
  s_sub_u32 s57, s38, s39
  s_add_u32 s57, s57, s27
  v_mfma_f32_16x16x32_bf16 v[44:47], v[172:175], a[200:203], v[44:47]
  buffer_load_dwordx2 v[96:97], v253, s[28:31], s57 offen sc1
  v_mfma_f32_16x16x32_bf16 v[48:51], v[172:175], a[204:207], v[48:51]
  v_mfma_f32_16x16x32_bf16 v[48:51], v[168:171], a[188:191], v[48:51]
  v_mfma_f32_16x16x32_bf16 v[48:51], v[164:167], a[172:175], v[48:51]
  s_waitcnt lgkmcnt(0)
  v_mfma_f32_16x16x32_bf16 v[60:63], v[176:179], a[168:171], v[60:63]
  ds_read_b64_tr_b16 v[164:165], v240 offset:49152
  v_mfma_f32_16x16x32_bf16 v[60:63], v[180:183], a[184:187], v[60:63]
  ds_read_b64_tr_b16 v[166:167], v240 offset:55296
  v_mfma_f32_16x16x32_bf16 v[60:63], v[184:187], a[200:203], v[60:63]
  ds_read_b64_tr_b16 v[168:169], v240 offset:50176
  v_mfma_f32_16x16x32_bf16 v[56:59], v[184:187], a[196:199], v[56:59]
  ds_read_b64_tr_b16 v[170:171], v240 offset:56320
  v_mfma_f32_16x16x32_bf16 v[56:59], v[180:183], a[180:183], v[56:59]
  ds_read_b64_tr_b16 v[172:173], v240 offset:51200
  v_mfma_f32_16x16x32_bf16 v[56:59], v[176:179], a[164:167], v[56:59]
  ds_read_b64_tr_b16 v[174:175], v240 offset:57344
  v_mfma_f32_16x16x32_bf16 v[52:55], v[176:179], a[160:163], v[52:55]
  v_mfma_f32_16x16x32_bf16 v[52:55], v[180:183], a[176:179], v[52:55]
  v_mfma_f32_16x16x32_bf16 v[52:55], v[184:187], a[192:195], v[52:55]
  s_waitcnt lgkmcnt(0) vmcnt(6)
  v_mfma_f32_16x16x32_bf16 v[132:135], v[164:167], a[208:211], v[132:135]
  ds_read_b64_tr_b16 v[176:177], v241 offset:49152
  v_mfma_f32_16x16x32_bf16 v[132:135], v[168:171], a[224:227], v[132:135]
  ds_read_b64_tr_b16 v[178:179], v241 offset:55296
  v_mfma_f32_16x16x32_bf16 v[132:135], v[172:175], a[240:243], v[132:135]
  ds_read_b64_tr_b16 v[180:181], v241 offset:50176
  v_mfma_f32_16x16x32_bf16 v[136:139], v[172:175], a[244:247], v[136:139]
  ds_read_b64_tr_b16 v[182:183], v241 offset:56320
  v_mfma_f32_16x16x32_bf16 v[136:139], v[168:171], a[228:231], v[136:139]
  ds_read_b64_tr_b16 v[184:185], v241 offset:51200
  v_mfma_f32_16x16x32_bf16 v[136:139], v[164:167], a[212:215], v[136:139]
  ds_read_b64_tr_b16 v[186:187], v241 offset:57344
  v_mfma_f32_16x16x32_bf16 v[140:143], v[164:167], a[216:219], v[140:143]
  v_mfma_f32_16x16x32_bf16 v[140:143], v[168:171], a[232:235], v[140:143]
  v_mfma_f32_16x16x32_bf16 v[140:143], v[172:175], a[248:251], v[140:143]
  v_mfma_f32_16x16x32_bf16 v[144:147], v[172:175], a[252:255], v[144:147]
  v_mfma_f32_16x16x32_bf16 v[144:147], v[168:171], a[236:239], v[144:147]
  v_mfma_f32_16x16x32_bf16 v[144:147], v[164:167], a[220:223], v[144:147]
  s_waitcnt lgkmcnt(0)
  v_mfma_f32_16x16x32_bf16 v[160:163], v[176:179], a[220:223], v[160:163]
  ds_read_b64_tr_b16 v[164:165], v242 offset:49152
  v_mfma_f32_16x16x32_bf16 v[160:163], v[180:183], a[236:239], v[160:163]
  ds_read_b64_tr_b16 v[166:167], v242 offset:55296
  v_mfma_f32_16x16x32_bf16 v[160:163], v[184:187], a[252:255], v[160:163]
  ds_read_b64_tr_b16 v[168:169], v242 offset:50176
  v_mfma_f32_16x16x32_bf16 v[156:159], v[184:187], a[248:251], v[156:159]
  ds_read_b64_tr_b16 v[170:171], v242 offset:56320
  v_mfma_f32_16x16x32_bf16 v[156:159], v[180:183], a[232:235], v[156:159]
  ds_read_b64_tr_b16 v[172:173], v242 offset:51200
  v_mfma_f32_16x16x32_bf16 v[156:159], v[176:179], a[216:219], v[156:159]
  ds_read_b64_tr_b16 v[174:175], v242 offset:57344
  v_mfma_f32_16x16x32_bf16 v[152:155], v[176:179], a[212:215], v[152:155]
  v_mfma_f32_16x16x32_bf16 v[152:155], v[180:183], a[228:231], v[152:155]
  v_cvt_pk_bf16_f32 v220, v132, v133
  v_cvt_pk_bf16_f32 v221, v134, v135
  v_mfma_f32_16x16x32_bf16 v[152:155], v[184:187], a[244:247], v[152:155]
  v_cvt_pk_bf16_f32 v224, v136, v137
  v_cvt_pk_bf16_f32 v225, v138, v139
  v_mfma_f32_16x16x32_bf16 v[148:151], v[184:187], a[240:243], v[148:151]
  v_cvt_pk_bf16_f32 v228, v140, v141
  v_cvt_pk_bf16_f32 v229, v142, v143
  v_mfma_f32_16x16x32_bf16 v[148:151], v[180:183], a[224:227], v[148:151]
  v_cvt_pk_bf16_f32 v232, v144, v145
  v_cvt_pk_bf16_f32 v233, v146, v147
  v_mfma_f32_16x16x32_bf16 v[148:151], v[176:179], a[208:211], v[148:151]
  s_waitcnt lgkmcnt(0)
  v_mfma_f32_16x16x32_bf16 v[4:7], v[164:167], a[208:211], v[4:7]
  ds_read_b64_tr_b16 v[176:177], v243 offset:49152
  v_mfma_f32_16x16x32_bf16 v[4:7], v[168:171], a[224:227], v[4:7]
  ds_read_b64_tr_b16 v[178:179], v243 offset:55296
  v_mfma_f32_16x16x32_bf16 v[4:7], v[172:175], a[240:243], v[4:7]
  ds_read_b64_tr_b16 v[180:181], v243 offset:50176
  v_mfma_f32_16x16x32_bf16 v[8:11], v[172:175], a[244:247], v[8:11]
  ds_read_b64_tr_b16 v[182:183], v243 offset:56320
  v_mfma_f32_16x16x32_bf16 v[8:11], v[168:171], a[228:231], v[8:11]
  ds_read_b64_tr_b16 v[184:185], v243 offset:51200
  v_mfma_f32_16x16x32_bf16 v[8:11], v[164:167], a[212:215], v[8:11]
  ds_read_b64_tr_b16 v[186:187], v243 offset:57344
  v_mfma_f32_16x16x32_bf16 v[12:15], v[164:167], a[216:219], v[12:15]
  v_mfma_f32_16x16x32_bf16 v[12:15], v[168:171], a[232:235], v[12:15]
  v_cvt_pk_bf16_f32 v222, v148, v149
  v_cvt_pk_bf16_f32 v223, v150, v151
  v_mfma_f32_16x16x32_bf16 v[12:15], v[172:175], a[248:251], v[12:15]
  s_add_u32 s61, s67, s71
  v_mfma_f32_16x16x32_bf16 v[16:19], v[172:175], a[252:255], v[16:19]
  buffer_store_dwordx4 v[220:223], v252, s[28:31], s61 offen offset:0 sc1
  v_mfma_f32_16x16x32_bf16 v[16:19], v[168:171], a[236:239], v[16:19]
  v_cvt_pk_bf16_f32 v226, v152, v153
  v_cvt_pk_bf16_f32 v227, v154, v155
  v_mfma_f32_16x16x32_bf16 v[16:19], v[164:167], a[220:223], v[16:19]
  s_waitcnt lgkmcnt(0)
  s_add_u32 s61, s68, s71
  v_mfma_f32_16x16x32_bf16 v[32:35], v[176:179], a[220:223], v[32:35]
  v_add_u32 v1, s54, v248
  ds_read_b64_tr_b16 v[164:165], v1 offset:3072
  v_mfma_f32_16x16x32_bf16 v[32:35], v[180:183], a[236:239], v[32:35]
  ds_read_b64_tr_b16 v[166:167], v1 offset:3584
  v_mfma_f32_16x16x32_bf16 v[32:35], v[184:187], a[252:255], v[32:35]
  v_add_u32 v2, s55, v248
  ds_read_b64_tr_b16 v[168:169], v2 offset:3072
  v_mfma_f32_16x16x32_bf16 v[28:31], v[184:187], a[248:251], v[28:31]
  buffer_store_dwordx4 v[224:227], v252, s[28:31], s61 offen offset:0 sc1
  v_mfma_f32_16x16x32_bf16 v[28:31], v[180:183], a[232:235], v[28:31]
  ds_read_b64_tr_b16 v[170:171], v2 offset:3584
  v_add_u32 v3, s56, v248
  v_mfma_f32_16x16x32_bf16 v[28:31], v[176:179], a[216:219], v[28:31]
  ds_read_b64_tr_b16 v[172:173], v3 offset:3072
  v_cvt_pk_bf16_f32 v230, v156, v157
  v_mfma_f32_16x16x32_bf16 v[24:27], v[176:179], a[212:215], v[24:27]
  ds_read_b64_tr_b16 v[174:175], v3 offset:3584
  v_cvt_pk_bf16_f32 v231, v158, v159
  v_mfma_f32_16x16x32_bf16 v[24:27], v[180:183], a[228:231], v[24:27]
  s_add_u32 s61, s69, s71
  v_mfma_f32_16x16x32_bf16 v[24:27], v[184:187], a[244:247], v[24:27]
  v_mfma_f32_16x16x32_bf16 v[20:23], v[184:187], a[240:243], v[20:23]
  buffer_store_dwordx4 v[228:231], v252, s[28:31], s61 offen offset:0 sc1
  v_mfma_f32_16x16x32_bf16 v[20:23], v[180:183], a[224:227], v[20:23]
  v_cvt_pk_bf16_f32 v234, v160, v161
  v_cvt_pk_bf16_f32 v235, v162, v163
  v_mfma_f32_16x16x32_bf16 v[20:23], v[176:179], a[208:211], v[20:23]
  s_waitcnt lgkmcnt(0)
  s_add_u32 s61, s70, s71
  v_mfma_f32_16x16x32_bf16 v[36:39], v[164:167], a[208:211], v[36:39]
  ds_read_b64_tr_b16 v[176:177], v236 offset:12288
  v_mfma_f32_16x16x32_bf16 v[36:39], v[168:171], a[224:227], v[36:39]
  ds_read_b64_tr_b16 v[178:179], v236 offset:18432
  v_mfma_f32_16x16x32_bf16 v[36:39], v[172:175], a[240:243], v[36:39]
  ds_read_b64_tr_b16 v[180:181], v236 offset:13312
  v_mfma_f32_16x16x32_bf16 v[40:43], v[172:175], a[244:247], v[40:43]
  buffer_store_dwordx4 v[232:235], v252, s[28:31], s61 offen offset:0 sc1
  v_mfma_f32_16x16x32_bf16 v[40:43], v[168:171], a[228:231], v[40:43]
  ds_read_b64_tr_b16 v[182:183], v236 offset:19456
  v_cvt_pk_bf16_f32 v220, v4, v5
  v_mfma_f32_16x16x32_bf16 v[40:43], v[164:167], a[212:215], v[40:43]
  ds_read_b64_tr_b16 v[184:185], v236 offset:14336
  v_cvt_pk_bf16_f32 v221, v6, v7
  v_mfma_f32_16x16x32_bf16 v[44:47], v[164:167], a[216:219], v[44:47]
  ds_read_b64_tr_b16 v[186:187], v236 offset:20480
  v_cvt_pk_bf16_f32 v224, v8, v9
  v_mfma_f32_16x16x32_bf16 v[44:47], v[168:171], a[232:235], v[44:47]
  v_cvt_pk_bf16_f32 v225, v10, v11
  v_cvt_pk_bf16_f32 v228, v12, v13
  v_mfma_f32_16x16x32_bf16 v[44:47], v[172:175], a[248:251], v[44:47]
  v_cvt_pk_bf16_f32 v229, v14, v15
  v_cvt_pk_bf16_f32 v232, v16, v17
  v_mfma_f32_16x16x32_bf16 v[48:51], v[172:175], a[252:255], v[48:51]
  v_cvt_pk_bf16_f32 v233, v18, v19
  v_cvt_pk_bf16_f32 v222, v20, v21
  v_mfma_f32_16x16x32_bf16 v[48:51], v[168:171], a[236:239], v[48:51]
  v_cvt_pk_bf16_f32 v223, v22, v23
  s_add_u32 s61, s67, s71
  v_mfma_f32_16x16x32_bf16 v[48:51], v[164:167], a[220:223], v[48:51]
  s_waitcnt lgkmcnt(0)
  v_mfma_f32_16x16x32_bf16 v[60:63], v[176:179], a[216:219], v[60:63]
  ds_read_b64_tr_b16 v[164:165], v237 offset:24576
  v_mfma_f32_16x16x32_bf16 v[60:63], v[180:183], a[232:235], v[60:63]
  ds_read_b64_tr_b16 v[166:167], v237 offset:30720
  v_mfma_f32_16x16x32_bf16 v[60:63], v[184:187], a[248:251], v[60:63]
  ds_read_b64_tr_b16 v[168:169], v237 offset:25600
  v_mfma_f32_16x16x32_bf16 v[56:59], v[184:187], a[244:247], v[56:59]
  ds_read_b64_tr_b16 v[170:171], v237 offset:31744
  v_mfma_f32_16x16x32_bf16 v[56:59], v[180:183], a[228:231], v[56:59]
  ds_read_b64_tr_b16 v[172:173], v237 offset:26624
  v_mfma_f32_16x16x32_bf16 v[56:59], v[176:179], a[212:215], v[56:59]
  ds_read_b64_tr_b16 v[174:175], v237 offset:32768
  v_mfma_f32_16x16x32_bf16 v[52:55], v[176:179], a[208:211], v[52:55]
  buffer_store_dwordx4 v[220:223], v252, s[28:31], s61 offen offset:1024 sc1
  v_mfma_f32_16x16x32_bf16 v[52:55], v[180:183], a[224:227], v[52:55]
  v_cvt_pk_bf16_f32 v226, v24, v25
  v_cvt_pk_bf16_f32 v227, v26, v27
  v_mfma_f32_16x16x32_bf16 v[52:55], v[184:187], a[240:243], v[52:55]
  s_waitcnt lgkmcnt(0)
  s_add_u32 s61, s68, s71
  v_mfma_f32_16x16x32_bf16 v[68:71], v[164:167], a[0:3], 0
  ds_read_b64_tr_b16 v[176:177], v237 offset:36864
  v_mfma_f32_16x16x32_bf16 v[68:71], v[168:171], a[16:19], v[68:71]
  ds_read_b64_tr_b16 v[178:179], v237 offset:43008
  v_mfma_f32_16x16x32_bf16 v[68:71], v[172:175], a[32:35], v[68:71]
  ds_read_b64_tr_b16 v[180:181], v237 offset:37888
  v_mfma_f32_16x16x32_bf16 v[72:75], v[172:175], a[36:39], 0
  ds_read_b64_tr_b16 v[182:183], v237 offset:44032
  v_mfma_f32_16x16x32_bf16 v[72:75], v[168:171], a[20:23], v[72:75]
  ds_read_b64_tr_b16 v[184:185], v237 offset:38912
  v_mfma_f32_16x16x32_bf16 v[72:75], v[164:167], a[4:7], v[72:75]
  ds_read_b64_tr_b16 v[186:187], v237 offset:45056
  v_mfma_f32_16x16x32_bf16 v[76:79], v[164:167], a[8:11], 0
  buffer_store_dwordx4 v[224:227], v252, s[28:31], s61 offen offset:1024 sc1
  v_mfma_f32_16x16x32_bf16 v[76:79], v[168:171], a[24:27], v[76:79]
  v_cvt_pk_bf16_f32 v230, v28, v29
  v_cvt_pk_bf16_f32 v231, v30, v31
  v_mfma_f32_16x16x32_bf16 v[76:79], v[172:175], a[40:43], v[76:79]
  s_waitcnt lgkmcnt(0)
  s_add_u32 s61, s69, s71
  s_waitcnt vmcnt(6)
  v_mfma_f32_16x16x32_bf16 v[76:79], v[176:179], a[56:59], v[76:79]
  ds_read_b64_tr_b16 v[164:165], v241 offset:12288
  v_add_f32 v116, v116, v117
  v_mfma_f32_16x16x32_bf16 v[76:79], v[180:183], a[72:75], v[76:79]
  ds_read_b64_tr_b16 v[166:167], v241 offset:18432
  v_mov_b32 v117, v116
  v_mfma_f32_16x16x32_bf16 v[76:79], v[184:187], a[88:91], v[76:79]
  ds_read_b64_tr_b16 v[168:169], v241 offset:13312
  v_permlane32_swap_b32 v116, v117
  v_mfma_f32_16x16x32_bf16 v[72:75], v[184:187], a[84:87], v[72:75]
  ds_read_b64_tr_b16 v[170:171], v241 offset:19456
  v_add_f32 v116, v116, v117
  v_mfma_f32_16x16x32_bf16 v[72:75], v[180:183], a[68:71], v[72:75]
  ds_read_b64_tr_b16 v[172:173], v241 offset:14336
  v_mov_b32 v117, v116
  v_mfma_f32_16x16x32_bf16 v[72:75], v[176:179], a[52:55], v[72:75]
  ds_read_b64_tr_b16 v[174:175], v241 offset:20480
  v_permlane16_swap_b32 v116, v117
  v_mfma_f32_16x16x32_bf16 v[68:71], v[176:179], a[48:51], v[68:71]
  buffer_store_dwordx4 v[228:231], v252, s[28:31], s61 offen offset:1024 sc1
  v_mfma_f32_16x16x32_bf16 v[68:71], v[180:183], a[64:67], v[68:71]
  v_cvt_pk_bf16_f32 v234, v32, v33
  v_cvt_pk_bf16_f32 v235, v34, v35
  v_mfma_f32_16x16x32_bf16 v[68:71], v[184:187], a[80:83], v[68:71]
  s_waitcnt lgkmcnt(0)
  s_add_u32 s61, s70, s71
  v_add_f32 v116, v116, v117
  v_mfma_f32_16x16x32_bf16 v[68:71], v[164:167], a[96:99], v[68:71]
  ds_read_b64_tr_b16 v[176:177], v241 offset:24576
  v_mov_b32 v130, 0x3727c5ac
  v_mfma_f32_16x16x32_bf16 v[68:71], v[168:171], a[112:115], v[68:71]
  ds_read_b64_tr_b16 v[178:179], v241 offset:30720
  v_fmac_f32 v130, 0x3ae38e39, v116
  v_mfma_f32_16x16x32_bf16 v[68:71], v[172:175], a[128:131], v[68:71]
  ds_read_b64_tr_b16 v[180:181], v241 offset:25600
  v_mfma_f32_16x16x32_bf16 v[72:75], v[172:175], a[132:135], v[72:75]
  ds_read_b64_tr_b16 v[182:183], v241 offset:31744
  v_mfma_f32_16x16x32_bf16 v[72:75], v[168:171], a[116:119], v[72:75]
  ds_read_b64_tr_b16 v[184:185], v241 offset:26624
  v_mfma_f32_16x16x32_bf16 v[72:75], v[164:167], a[100:103], v[72:75]
  ds_read_b64_tr_b16 v[186:187], v241 offset:32768
  v_mfma_f32_16x16x32_bf16 v[76:79], v[164:167], a[104:107], v[76:79]
  buffer_store_dwordx4 v[232:235], v252, s[28:31], s61 offen offset:1024 sc1
  v_mfma_f32_16x16x32_bf16 v[76:79], v[168:171], a[120:123], v[76:79]
  v_cvt_pk_bf16_f32 v220, v36, v37
  v_cvt_pk_bf16_f32 v221, v38, v39
  v_mfma_f32_16x16x32_bf16 v[76:79], v[172:175], a[136:139], v[76:79]
  s_waitcnt lgkmcnt(0)
  s_add_u32 s61, s67, s73
  v_mfma_f32_16x16x32_bf16 v[76:79], v[176:179], a[152:155], v[76:79]
  ds_read_b64_tr_b16 v[164:165], v237 offset:0
  v_mfma_f32_16x16x32_bf16 v[76:79], v[180:183], v[196:199], v[76:79]
  ds_read_b64_tr_b16 v[166:167], v237 offset:6144
  v_mfma_f32_16x16x32_bf16 v[76:79], v[184:187], v[212:215], v[76:79]
  ds_read_b64_tr_b16 v[168:169], v237 offset:1024
  v_mfma_f32_16x16x32_bf16 v[72:75], v[184:187], v[208:211], v[72:75]
  ds_read_b64_tr_b16 v[170:171], v237 offset:7168
  v_mfma_f32_16x16x32_bf16 v[72:75], v[180:183], v[192:195], v[72:75]
  ds_read_b64_tr_b16 v[172:173], v237 offset:2048
  v_mfma_f32_16x16x32_bf16 v[72:75], v[176:179], a[148:151], v[72:75]
  ds_read_b64_tr_b16 v[174:175], v237 offset:8192
  v_mfma_f32_16x16x32_bf16 v[68:71], v[176:179], a[144:147], v[68:71]
  buffer_store_dwordx2 v[220:221], v253, s[28:31], s61 offen offset:2048 sc1
  v_mfma_f32_16x16x32_bf16 v[68:71], v[180:183], v[188:191], v[68:71]
  v_cvt_pk_bf16_f32 v224, v40, v41
  v_cvt_pk_bf16_f32 v225, v42, v43
  v_mfma_f32_16x16x32_bf16 v[68:71], v[184:187], v[204:207], v[68:71]
  s_waitcnt lgkmcnt(0)
  s_add_u32 s61, s68, s73
  v_mfma_f32_16x16x32_bf16 v[68:71], v[164:167], a[160:163], v[68:71]
  ds_read_b64_tr_b16 v[176:177], v237 offset:12288
  v_mfma_f32_16x16x32_bf16 v[68:71], v[168:171], a[176:179], v[68:71]
  ds_read_b64_tr_b16 v[178:179], v237 offset:18432
  v_mfma_f32_16x16x32_bf16 v[68:71], v[172:175], a[192:195], v[68:71]
  ds_read_b64_tr_b16 v[180:181], v237 offset:13312
  v_mfma_f32_16x16x32_bf16 v[72:75], v[172:175], a[196:199], v[72:75]
  ds_read_b64_tr_b16 v[182:183], v237 offset:19456
  v_mfma_f32_16x16x32_bf16 v[72:75], v[168:171], a[180:183], v[72:75]
  ds_read_b64_tr_b16 v[184:185], v237 offset:14336
  v_mfma_f32_16x16x32_bf16 v[72:75], v[164:167], a[164:167], v[72:75]
  ds_read_b64_tr_b16 v[186:187], v237 offset:20480
  v_mfma_f32_16x16x32_bf16 v[76:79], v[164:167], a[168:171], v[76:79]
  buffer_store_dwordx2 v[224:225], v253, s[28:31], s61 offen offset:2048 sc1
  v_mfma_f32_16x16x32_bf16 v[76:79], v[168:171], a[184:187], v[76:79]
  v_cvt_pk_bf16_f32 v228, v44, v45
  v_cvt_pk_bf16_f32 v229, v46, v47
  v_mfma_f32_16x16x32_bf16 v[76:79], v[172:175], a[200:203], v[76:79]
  s_waitcnt lgkmcnt(0)
  s_add_u32 s61, s69, s73
  v_mfma_f32_16x16x32_bf16 v[76:79], v[176:179], a[216:219], v[76:79]
  ds_read_b64_tr_b16 v[164:165], v238 offset:24576
  v_mfma_f32_16x16x32_bf16 v[76:79], v[180:183], a[232:235], v[76:79]
  ds_read_b64_tr_b16 v[166:167], v238 offset:30720
  v_mfma_f32_16x16x32_bf16 v[76:79], v[184:187], a[248:251], v[76:79]
  ds_read_b64_tr_b16 v[168:169], v238 offset:25600
  v_mfma_f32_16x16x32_bf16 v[72:75], v[184:187], a[244:247], v[72:75]
  ds_read_b64_tr_b16 v[170:171], v238 offset:31744
  v_mfma_f32_16x16x32_bf16 v[72:75], v[180:183], a[228:231], v[72:75]
  ds_read_b64_tr_b16 v[172:173], v238 offset:26624
  v_mfma_f32_16x16x32_bf16 v[72:75], v[176:179], a[212:215], v[72:75]
  ds_read_b64_tr_b16 v[174:175], v238 offset:32768
  v_mfma_f32_16x16x32_bf16 v[68:71], v[176:179], a[208:211], v[68:71]
  buffer_store_dwordx2 v[228:229], v253, s[28:31], s61 offen offset:2048 sc1
  v_mfma_f32_16x16x32_bf16 v[68:71], v[180:183], a[224:227], v[68:71]
  v_cvt_pk_bf16_f32 v232, v48, v49
  v_cvt_pk_bf16_f32 v233, v50, v51
  v_mfma_f32_16x16x32_bf16 v[68:71], v[184:187], a[240:243], v[68:71]
  s_waitcnt lgkmcnt(0)
  s_add_u32 s61, s70, s73
  v_mfma_f32_16x16x32_bf16 v[84:87], v[164:167], a[0:3], 0
  ds_read_b64_tr_b16 v[176:177], v238 offset:36864
  v_mfma_f32_16x16x32_bf16 v[84:87], v[168:171], a[16:19], v[84:87]
  ds_read_b64_tr_b16 v[178:179], v238 offset:43008
  v_mfma_f32_16x16x32_bf16 v[84:87], v[172:175], a[32:35], v[84:87]
  ds_read_b64_tr_b16 v[180:181], v238 offset:37888
  v_mfma_f32_16x16x32_bf16 v[88:91], v[172:175], a[36:39], 0
  ds_read_b64_tr_b16 v[182:183], v238 offset:44032
  v_mfma_f32_16x16x32_bf16 v[88:91], v[168:171], a[20:23], v[88:91]
  ds_read_b64_tr_b16 v[184:185], v238 offset:38912
  v_mfma_f32_16x16x32_bf16 v[88:91], v[164:167], a[4:7], v[88:91]
  ds_read_b64_tr_b16 v[186:187], v238 offset:45056
  v_mfma_f32_16x16x32_bf16 v[92:95], v[164:167], a[8:11], 0
  buffer_store_dwordx2 v[232:233], v253, s[28:31], s61 offen offset:2048 sc1
  v_mfma_f32_16x16x32_bf16 v[92:95], v[168:171], a[24:27], v[92:95]
  v_cvt_pk_bf16_f32 v220, v52, v53
  v_cvt_pk_bf16_f32 v221, v54, v55
  v_mfma_f32_16x16x32_bf16 v[92:95], v[172:175], a[40:43], v[92:95]
  s_waitcnt lgkmcnt(0)
  v_cvt_pk_bf16_f32 v224, v56, v57
  v_cvt_pk_bf16_f32 v225, v58, v59
  v_mfma_f32_16x16x32_bf16 v[92:95], v[176:179], a[56:59], v[92:95]
  ds_read_b64_tr_b16 v[164:165], v242 offset:12288
  v_cvt_pk_bf16_f32 v228, v60, v61
  v_mfma_f32_16x16x32_bf16 v[92:95], v[180:183], a[72:75], v[92:95]
  ds_read_b64_tr_b16 v[166:167], v242 offset:18432
  v_cvt_pk_bf16_f32 v229, v62, v63
  v_mfma_f32_16x16x32_bf16 v[92:95], v[184:187], a[88:91], v[92:95]
  ds_read_b64_tr_b16 v[168:169], v242 offset:13312
  v_cvt_pk_bf16_f32 v222, v68, v69
  v_mfma_f32_16x16x32_bf16 v[88:91], v[184:187], a[84:87], v[88:91]
  ds_read_b64_tr_b16 v[170:171], v242 offset:19456
  v_cvt_pk_bf16_f32 v223, v70, v71
  v_mfma_f32_16x16x32_bf16 v[88:91], v[180:183], a[68:71], v[88:91]
  s_add_u32 s61, s67, s72
  ds_read_b64_tr_b16 v[172:173], v242 offset:14336
  v_mfma_f32_16x16x32_bf16 v[88:91], v[176:179], a[52:55], v[88:91]
  ds_read_b64_tr_b16 v[174:175], v242 offset:20480
  v_mfma_f32_16x16x32_bf16 v[84:87], v[176:179], a[48:51], v[84:87]
  buffer_store_dwordx4 v[220:223], v252, s[28:31], s61 offen offset:0 sc1
  v_mfma_f32_16x16x32_bf16 v[84:87], v[180:183], a[64:67], v[84:87]
  v_cvt_pk_bf16_f32 v226, v72, v73
  v_cvt_pk_bf16_f32 v227, v74, v75
  v_mfma_f32_16x16x32_bf16 v[84:87], v[184:187], a[80:83], v[84:87]
  s_waitcnt lgkmcnt(0)
  s_add_u32 s61, s68, s72
  v_mfma_f32_16x16x32_bf16 v[84:87], v[164:167], a[96:99], v[84:87]
  ds_read_b64_tr_b16 v[176:177], v242 offset:24576
  v_mfma_f32_16x16x32_bf16 v[84:87], v[168:171], a[112:115], v[84:87]
  ds_read_b64_tr_b16 v[178:179], v242 offset:30720
  v_mfma_f32_16x16x32_bf16 v[84:87], v[172:175], a[128:131], v[84:87]
  ds_read_b64_tr_b16 v[180:181], v242 offset:25600
  v_mfma_f32_16x16x32_bf16 v[88:91], v[172:175], a[132:135], v[88:91]
  ds_read_b64_tr_b16 v[182:183], v242 offset:31744
  v_mfma_f32_16x16x32_bf16 v[88:91], v[168:171], a[116:119], v[88:91]
  ds_read_b64_tr_b16 v[184:185], v242 offset:26624
  v_mfma_f32_16x16x32_bf16 v[88:91], v[164:167], a[100:103], v[88:91]
L_hopb4:
  s_cbranch_execz L_mainb
  ds_read_b64_tr_b16 v[186:187], v242 offset:32768
  v_mfma_f32_16x16x32_bf16 v[92:95], v[164:167], a[104:107], v[92:95]
  buffer_store_dwordx4 v[224:227], v252, s[28:31], s61 offen offset:0 sc1
  v_mfma_f32_16x16x32_bf16 v[92:95], v[168:171], a[120:123], v[92:95]
  v_cvt_pk_bf16_f32 v230, v76, v77
  v_cvt_pk_bf16_f32 v231, v78, v79
  v_mfma_f32_16x16x32_bf16 v[92:95], v[172:175], a[136:139], v[92:95]
  s_waitcnt lgkmcnt(0)
  s_add_u32 s61, s69, s72
  v_mfma_f32_16x16x32_bf16 v[92:95], v[176:179], a[152:155], v[92:95]
  ds_read_b64_tr_b16 v[164:165], v238 offset:0
  v_mfma_f32_16x16x32_bf16 v[92:95], v[180:183], v[196:199], v[92:95]
  ds_read_b64_tr_b16 v[166:167], v238 offset:6144
  v_mfma_f32_16x16x32_bf16 v[92:95], v[184:187], v[212:215], v[92:95]
  ds_read_b64_tr_b16 v[168:169], v238 offset:1024
  v_mfma_f32_16x16x32_bf16 v[88:91], v[184:187], v[208:211], v[88:91]
  ds_read_b64_tr_b16 v[170:171], v238 offset:7168
  v_mfma_f32_16x16x32_bf16 v[88:91], v[180:183], v[192:195], v[88:91]
  ds_read_b64_tr_b16 v[172:173], v238 offset:2048
  v_mfma_f32_16x16x32_bf16 v[88:91], v[176:179], a[148:151], v[88:91]
  ds_read_b64_tr_b16 v[174:175], v238 offset:8192
  v_mfma_f32_16x16x32_bf16 v[84:87], v[176:179], a[144:147], v[84:87]
  buffer_store_dwordx4 v[228:231], v252, s[28:31], s61 offen offset:0 sc1
  v_mfma_f32_16x16x32_bf16 v[84:87], v[180:183], v[188:191], v[84:87]
  v_rcp_f32 v130, v130
  v_mfma_f32_16x16x32_bf16 v[84:87], v[184:187], v[204:207], v[84:87]
  s_waitcnt lgkmcnt(0)
  v_lshlrev_b32 v132, 16, v64
  v_and_b32 v133, 0xffff0000, v64
  v_mfma_f32_16x16x32_bf16 v[84:87], v[164:167], a[160:163], v[84:87]
  ds_read_b64_tr_b16 v[176:177], v238 offset:12288
  v_add_f32 v132, v132, v131
  v_mfma_f32_16x16x32_bf16 v[84:87], v[168:171], a[176:179], v[84:87]
  ds_read_b64_tr_b16 v[178:179], v238 offset:18432
  v_add_f32 v133, v133, v131
  v_mfma_f32_16x16x32_bf16 v[84:87], v[172:175], a[192:195], v[84:87]
  ds_read_b64_tr_b16 v[180:181], v238 offset:13312
  v_lshlrev_b32 v134, 16, v65
  v_mfma_f32_16x16x32_bf16 v[88:91], v[172:175], a[196:199], v[88:91]
  ds_read_b64_tr_b16 v[182:183], v238 offset:19456
  v_and_b32 v135, 0xffff0000, v65
  v_mfma_f32_16x16x32_bf16 v[88:91], v[168:171], a[180:183], v[88:91]
  ds_read_b64_tr_b16 v[184:185], v238 offset:14336
  v_add_f32 v134, v134, v131
  v_mfma_f32_16x16x32_bf16 v[88:91], v[164:167], a[164:167], v[88:91]
  ds_read_b64_tr_b16 v[186:187], v238 offset:20480
  v_add_f32 v135, v135, v131
  v_mfma_f32_16x16x32_bf16 v[92:95], v[164:167], a[168:171], v[92:95]
  v_lshlrev_b32 v136, 16, v66
  v_and_b32 v137, 0xffff0000, v66
  v_mfma_f32_16x16x32_bf16 v[92:95], v[168:171], a[184:187], v[92:95]
  v_add_f32 v136, v136, v131
  v_add_f32 v137, v137, v131
  v_mfma_f32_16x16x32_bf16 v[92:95], v[172:175], a[200:203], v[92:95]
  s_waitcnt lgkmcnt(0)
  v_lshlrev_b32 v138, 16, v67
  v_and_b32 v139, 0xffff0000, v67
  v_mfma_f32_16x16x32_bf16 v[92:95], v[176:179], a[216:219], v[92:95]
  ds_read_b64_tr_b16 v[164:165], v239 offset:24576
  v_add_f32 v138, v138, v131
  v_mfma_f32_16x16x32_bf16 v[92:95], v[180:183], a[232:235], v[92:95]
  ds_read_b64_tr_b16 v[166:167], v239 offset:30720
  v_add_f32 v139, v139, v131
  v_mfma_f32_16x16x32_bf16 v[92:95], v[184:187], a[248:251], v[92:95]
  ds_read_b64_tr_b16 v[168:169], v239 offset:25600
  v_lshlrev_b32 v140, 16, v80
  v_mfma_f32_16x16x32_bf16 v[88:91], v[184:187], a[244:247], v[88:91]
  ds_read_b64_tr_b16 v[170:171], v239 offset:31744
  v_and_b32 v141, 0xffff0000, v80
  v_mfma_f32_16x16x32_bf16 v[88:91], v[180:183], a[228:231], v[88:91]
  ds_read_b64_tr_b16 v[172:173], v239 offset:26624
  v_add_f32 v140, v140, v131
  v_mfma_f32_16x16x32_bf16 v[88:91], v[176:179], a[212:215], v[88:91]
  ds_read_b64_tr_b16 v[174:175], v239 offset:32768
  v_add_f32 v141, v141, v131
  v_mfma_f32_16x16x32_bf16 v[84:87], v[176:179], a[208:211], v[84:87]
  s_waitcnt vmcnt(3)
  buffer_atomic_add v0, v254, s[28:31], s43 offen offset:0 sc1
  v_mfma_f32_16x16x32_bf16 v[84:87], v[180:183], a[224:227], v[84:87]
  v_mov_b32 v255, 0
  ds_read_b64_tr_b16 v[4:5], v236 offset:24576
  v_mfma_f32_16x16x32_bf16 v[84:87], v[184:187], a[240:243], v[84:87]
  s_waitcnt lgkmcnt(1)
  ds_read_b64_tr_b16 v[6:7], v236 offset:30720
  v_lshlrev_b32 v142, 16, v81
  v_mfma_f32_16x16x32_bf16 v[100:103], v[164:167], a[0:3], 0
  ds_read_b64_tr_b16 v[176:177], v239 offset:36864
  v_and_b32 v143, 0xffff0000, v81
  v_mfma_f32_16x16x32_bf16 v[100:103], v[168:171], a[16:19], v[100:103]
  ds_read_b64_tr_b16 v[178:179], v239 offset:43008
  v_add_f32 v142, v142, v131
  v_mfma_f32_16x16x32_bf16 v[100:103], v[172:175], a[32:35], v[100:103]
  ds_read_b64_tr_b16 v[180:181], v239 offset:37888
  v_add_f32 v143, v143, v131
  v_mfma_f32_16x16x32_bf16 v[104:107], v[172:175], a[36:39], 0
  ds_read_b64_tr_b16 v[182:183], v239 offset:44032
  v_lshlrev_b32 v144, 16, v82
  v_mfma_f32_16x16x32_bf16 v[104:107], v[168:171], a[20:23], v[104:107]
  ds_read_b64_tr_b16 v[184:185], v239 offset:38912
  v_and_b32 v145, 0xffff0000, v82
  v_mfma_f32_16x16x32_bf16 v[104:107], v[164:167], a[4:7], v[104:107]
  ds_read_b64_tr_b16 v[186:187], v239 offset:45056
  v_add_f32 v144, v144, v131
  v_mfma_f32_16x16x32_bf16 v[108:111], v[164:167], a[8:11], 0
  ds_read_b64_tr_b16 v[8:9], v236 offset:25600
  v_add_f32 v145, v145, v131
  v_mfma_f32_16x16x32_bf16 v[108:111], v[168:171], a[24:27], v[108:111]
  v_cvt_pk_bf16_f32 v220, v84, v85
  v_cvt_pk_bf16_f32 v221, v86, v87
  v_mfma_f32_16x16x32_bf16 v[108:111], v[172:175], a[40:43], v[108:111]
  s_waitcnt lgkmcnt(1)
  v_cvt_pk_bf16_f32 v224, v88, v89
  v_cvt_pk_bf16_f32 v225, v90, v91
  v_mfma_f32_16x16x32_bf16 v[108:111], v[176:179], a[56:59], v[108:111]
  ds_read_b64_tr_b16 v[164:165], v243 offset:12288
  v_cvt_pk_bf16_f32 v228, v92, v93
  v_mfma_f32_16x16x32_bf16 v[108:111], v[180:183], a[72:75], v[108:111]
  ds_read_b64_tr_b16 v[166:167], v243 offset:18432
  v_cvt_pk_bf16_f32 v229, v94, v95
  v_mfma_f32_16x16x32_bf16 v[108:111], v[184:187], a[88:91], v[108:111]
  ds_read_b64_tr_b16 v[168:169], v243 offset:13312
  v_lshlrev_b32 v146, 16, v83
  v_mfma_f32_16x16x32_bf16 v[104:107], v[184:187], a[84:87], v[104:107]
  ds_read_b64_tr_b16 v[170:171], v243 offset:19456
  v_and_b32 v147, 0xffff0000, v83
  v_mfma_f32_16x16x32_bf16 v[104:107], v[180:183], a[68:71], v[104:107]
  ds_read_b64_tr_b16 v[172:173], v243 offset:14336
  v_add_f32 v146, v146, v131
  v_mfma_f32_16x16x32_bf16 v[104:107], v[176:179], a[52:55], v[104:107]
  ds_read_b64_tr_b16 v[174:175], v243 offset:20480
  v_add_f32 v147, v147, v131
  v_mfma_f32_16x16x32_bf16 v[100:103], v[176:179], a[48:51], v[100:103]
  ds_read_b64_tr_b16 v[10:11], v236 offset:31744
  v_lshlrev_b32 v148, 16, v96
  v_mfma_f32_16x16x32_bf16 v[100:103], v[180:183], a[64:67], v[100:103]
  ds_read_b64_tr_b16 v[12:13], v236 offset:26624
  v_and_b32 v149, 0xffff0000, v96
  v_mfma_f32_16x16x32_bf16 v[100:103], v[184:187], a[80:83], v[100:103]
  s_waitcnt lgkmcnt(2)
  ds_read_b64_tr_b16 v[14:15], v236 offset:32768
  v_add_f32 v148, v148, v131
  v_mfma_f32_16x16x32_bf16 v[100:103], v[164:167], a[96:99], v[100:103]
  ds_read_b64_tr_b16 v[176:177], v243 offset:24576
  v_add_f32 v149, v149, v131
  v_mfma_f32_16x16x32_bf16 v[100:103], v[168:171], a[112:115], v[100:103]
  ds_read_b64_tr_b16 v[178:179], v243 offset:30720
  v_lshlrev_b32 v150, 16, v97
  v_mfma_f32_16x16x32_bf16 v[100:103], v[172:175], a[128:131], v[100:103]
  ds_read_b64_tr_b16 v[180:181], v243 offset:25600
  v_and_b32 v151, 0xffff0000, v97
  v_mfma_f32_16x16x32_bf16 v[104:107], v[172:175], a[132:135], v[104:107]
  ds_read_b64_tr_b16 v[182:183], v243 offset:31744
  v_add_f32 v150, v150, v131
  v_mfma_f32_16x16x32_bf16 v[104:107], v[168:171], a[116:119], v[104:107]
  ds_read_b64_tr_b16 v[184:185], v243 offset:26624
  v_add_f32 v151, v151, v131
  v_mfma_f32_16x16x32_bf16 v[104:107], v[164:167], a[100:103], v[104:107]
  ds_read_b64_tr_b16 v[186:187], v243 offset:32768
  v_lshrrev_b32 v124, 6, v252
  v_mfma_f32_16x16x32_bf16 v[108:111], v[164:167], a[104:107], v[108:111]
  buffer_atomic_add v255, v254, s[28:31], s43 offen offset:0 sc0 sc1
  v_mfma_f32_16x16x32_bf16 v[108:111], v[168:171], a[120:123], v[108:111]
  ds_read_b64_tr_b16 v[16:17], v236 offset:36864
  v_and_b32 v124, 12, v124
  v_mfma_f32_16x16x32_bf16 v[108:111], v[172:175], a[136:139], v[108:111]
  s_waitcnt lgkmcnt(1)
  ds_read_b64_tr_b16 v[18:19], v236 offset:43008
  v_bfe_u32 v125, v252, 4, 4
  v_mfma_f32_16x16x32_bf16 v[108:111], v[176:179], a[152:155], v[108:111]
  ds_read_b64_tr_b16 v[164:165], v239 offset:0
  v_sub_u32 v124, v125, v124
  v_mfma_f32_16x16x32_bf16 v[108:111], v[180:183], v[196:199], v[108:111]
  ds_read_b64_tr_b16 v[166:167], v239 offset:6144
  v_and_b32 v125, 16, v252
  v_mfma_f32_16x16x32_bf16 v[108:111], v[184:187], v[212:215], v[108:111]
  ds_read_b64_tr_b16 v[168:169], v239 offset:1024
  v_mov_b32 v128, 0x3f80
  v_mfma_f32_16x16x32_bf16 v[104:107], v[184:187], v[208:211], v[104:107]
  ds_read_b64_tr_b16 v[170:171], v239 offset:7168
  v_lshlrev_b32 v125, v125, v128
  v_mfma_f32_16x16x32_bf16 v[104:107], v[180:183], v[192:195], v[104:107]
  ds_read_b64_tr_b16 v[172:173], v239 offset:2048
  v_lshrrev_b32 v124, 1, v124
  v_mfma_f32_16x16x32_bf16 v[104:107], v[176:179], a[148:151], v[104:107]
  ds_read_b64_tr_b16 v[174:175], v239 offset:8192
  v_cmp_eq_u32 vcc, 0, v124
  v_mfma_f32_16x16x32_bf16 v[100:103], v[176:179], a[144:147], v[100:103]
  ds_read_b64_tr_b16 v[20:21], v236 offset:37888
  v_mov_b32 v128, 0
  v_mfma_f32_16x16x32_bf16 v[100:103], v[180:183], v[188:191], v[100:103]
  ds_read_b64_tr_b16 v[22:23], v236 offset:44032
  v_mov_b32 v129, 0
  v_mfma_f32_16x16x32_bf16 v[100:103], v[184:187], v[204:207], v[100:103]
  s_waitcnt lgkmcnt(2)
  ds_read_b64_tr_b16 v[24:25], v236 offset:38912
  v_cndmask_b32 v126, 0, v125, vcc
  v_mfma_f32_16x16x32_bf16 v[100:103], v[164:167], a[160:163], v[100:103]
  ds_read_b64_tr_b16 v[176:177], v239 offset:12288
  v_cmp_eq_u32 vcc, 1, v124
  v_mfma_f32_16x16x32_bf16 v[100:103], v[168:171], a[176:179], v[100:103]
  ds_read_b64_tr_b16 v[178:179], v239 offset:18432
  v_mov_b32 v124, 0
  v_mfma_f32_16x16x32_bf16 v[100:103], v[172:175], a[192:195], v[100:103]
  ds_read_b64_tr_b16 v[180:181], v239 offset:13312
  v_bfe_u32 v116, v252, 4, 4
  v_mfma_f32_16x16x32_bf16 v[104:107], v[172:175], a[196:199], v[104:107]
  ds_read_b64_tr_b16 v[182:183], v239 offset:19456
  v_cndmask_b32 v127, 0, v125, vcc
  v_mfma_f32_16x16x32_bf16 v[104:107], v[168:171], a[180:183], v[104:107]
  ds_read_b64_tr_b16 v[184:185], v239 offset:14336
  v_mov_b32 v125, 0
  v_mfma_f32_16x16x32_bf16 v[104:107], v[164:167], a[164:167], v[104:107]
  ds_read_b64_tr_b16 v[186:187], v239 offset:20480
  v_mul_u32_u24 v116, 1152, v116
  v_mfma_f32_16x16x32_bf16 v[108:111], v[164:167], a[168:171], v[108:111]
  ds_read_b64_tr_b16 v[26:27], v236 offset:45056
  v_lshrrev_b32 v118, 8, v252
  v_mfma_f32_16x16x32_bf16 v[108:111], v[168:171], a[184:187], v[108:111]
  ds_read_b64_tr_b16 v[28:29], v240 offset:12288
  v_lshl_add_u32 v117, v118, 3, v116
  v_mfma_f32_16x16x32_bf16 v[108:111], v[172:175], a[200:203], v[108:111]
  s_waitcnt lgkmcnt(2)
  ds_read_b64_tr_b16 v[30:31], v240 offset:18432
  v_and_b32 v119, 1, v118
  v_mfma_f32_16x16x32_bf16 v[108:111], v[176:179], a[216:219], v[108:111]
  ds_read_b64_tr_b16 v[32:33], v240 offset:13312
  ds_read_b64_tr_b16 v[34:35], v240 offset:19456
  v_mfma_f32_16x16x32_bf16 v[108:111], v[180:183], a[232:235], v[108:111]
  ds_read_b64_tr_b16 v[36:37], v240 offset:14336
  ds_read_b64_tr_b16 v[38:39], v240 offset:20480
  v_mfma_f32_16x16x32_bf16 v[108:111], v[184:187], a[248:251], v[108:111]
  ds_read_b64_tr_b16 v[40:41], v240 offset:24576
  ds_read_b64_tr_b16 v[42:43], v240 offset:30720
  v_mfma_f32_16x16x32_bf16 v[104:107], v[184:187], a[244:247], v[104:107]
  ds_read_b64_tr_b16 v[44:45], v240 offset:25600
  ds_read_b64_tr_b16 v[46:47], v240 offset:31744
  v_mfma_f32_16x16x32_bf16 v[104:107], v[180:183], a[228:231], v[104:107]
  ds_read_b64_tr_b16 v[48:49], v240 offset:26624
  ds_read_b64_tr_b16 v[50:51], v240 offset:32768
  v_mfma_f32_16x16x32_bf16 v[104:107], v[176:179], a[212:215], v[104:107]
  v_lshl_add_u32 v116, v119, 5, v116
  v_lshrrev_b32 v118, 1, v118
  v_mfma_f32_16x16x32_bf16 v[100:103], v[176:179], a[208:211], v[100:103]
  v_cvt_pk_bf16_f32 v230, v108, v109
  v_cvt_pk_bf16_f32 v231, v110, v111
  s_add_u32 s61, s69, s72
  v_lshl_add_u32 v116, v118, 4, v116
  v_mfma_f32_16x16x32_bf16 v[100:103], v[180:183], a[224:227], v[100:103]
  buffer_store_dwordx4 v[228:231], v252, s[28:31], s61 offen offset:1024 sc1
  v_mfma_f32_16x16x32_bf16 v[100:103], v[184:187], a[240:243], v[100:103]
  v_mfma_f32_16x16x32_bf16 v[64:67], v[4:7], a[12:15], 0
  v_cvt_pk_bf16_f32 v226, v104, v105
  v_cvt_pk_bf16_f32 v227, v106, v107
  s_add_u32 s61, s68, s72
  v_mfma_f32_16x16x32_bf16 v[64:67], v[8:11], a[28:31], v[64:67]
  buffer_store_dwordx4 v[224:227], v252, s[28:31], s61 offen offset:1024 sc1
  v_mfma_f32_16x16x32_bf16 v[64:67], v[12:15], a[44:47], v[64:67]
  ds_read_b64_tr_b16 v[4:5], v236 offset:0
  ds_read_b64_tr_b16 v[6:7], v236 offset:6144
  v_mfma_f32_16x16x32_bf16 v[64:67], v[16:19], a[60:63], v[64:67]
  s_waitcnt lgkmcnt(14)
  v_cvt_pk_bf16_f32 v222, v100, v101
  v_cvt_pk_bf16_f32 v223, v102, v103
  s_add_u32 s61, s67, s72
  v_mfma_f32_16x16x32_bf16 v[64:67], v[20:23], a[76:79], v[64:67]
  buffer_store_dwordx4 v[220:223], v252, s[28:31], s61 offen offset:1024 sc1
  ds_read_b64_tr_b16 v[8:9], v236 offset:1024
  ds_read_b64_tr_b16 v[10:11], v236 offset:7168
  v_mfma_f32_16x16x32_bf16 v[64:67], v[24:27], a[92:95], v[64:67]
  s_waitcnt lgkmcnt(12)
  ds_read_b64_tr_b16 v[12:13], v236 offset:2048
  ds_read_b64_tr_b16 v[14:15], v236 offset:8192
  v_mfma_f32_16x16x32_bf16 v[64:67], v[28:31], a[108:111], v[64:67]
  ds_read_b64_tr_b16 v[16:17], v236 offset:12288
  ds_read_b64_tr_b16 v[18:19], v236 offset:18432
  v_mfma_f32_16x16x32_bf16 v[64:67], v[32:35], a[124:127], v[64:67]
  s_waitcnt lgkmcnt(12)
  ds_read_b64_tr_b16 v[20:21], v236 offset:13312
  ds_read_b64_tr_b16 v[22:23], v236 offset:19456
  v_mfma_f32_16x16x32_bf16 v[64:67], v[36:39], a[140:143], v[64:67]
  ds_read_b64_tr_b16 v[24:25], v236 offset:14336
  ds_read_b64_tr_b16 v[26:27], v236 offset:20480
  v_mfma_f32_16x16x32_bf16 v[64:67], v[40:43], a[156:159], v[64:67]
  s_waitcnt lgkmcnt(12)
  ds_read_b64_tr_b16 v[28:29], v237 offset:24576
  ds_read_b64_tr_b16 v[30:31], v237 offset:30720
  v_mfma_f32_16x16x32_bf16 v[64:67], v[44:47], v[200:203], v[64:67]
  ds_read_b64_tr_b16 v[32:33], v237 offset:25600
  ds_read_b64_tr_b16 v[34:35], v237 offset:31744
  v_mfma_f32_16x16x32_bf16 v[64:67], v[48:51], v[216:219], v[64:67]
  s_waitcnt lgkmcnt(12)
  ds_read_b64_tr_b16 v[36:37], v237 offset:26624
  ds_read_b64_tr_b16 v[38:39], v237 offset:32768
  v_mfma_f32_16x16x32_bf16 v[64:67], v[4:7], a[172:175], v[64:67]
  ds_read_b64_tr_b16 v[40:41], v237 offset:36864
  ds_read_b64_tr_b16 v[42:43], v237 offset:43008
  v_mfma_f32_16x16x32_bf16 v[64:67], v[8:11], a[188:191], v[64:67]
  s_waitcnt lgkmcnt(12)
  ds_read_b64_tr_b16 v[44:45], v237 offset:37888
  ds_read_b64_tr_b16 v[46:47], v237 offset:44032
  v_mfma_f32_16x16x32_bf16 v[64:67], v[12:15], a[204:207], v[64:67]
  ds_read_b64_tr_b16 v[48:49], v237 offset:38912
  ds_read_b64_tr_b16 v[50:51], v237 offset:45056
  v_mfma_f32_16x16x32_bf16 v[64:67], v[16:19], a[220:223], v[64:67]
  s_waitcnt lgkmcnt(12)
  s_waitcnt vmcnt(3)
  v_readfirstlane_b32 s62, v255
  v_mfma_f32_16x16x32_bf16 v[64:67], v[20:23], a[236:239], v[64:67]
  ds_read_b64_tr_b16 v[4:5], v241 offset:12288
  ds_read_b64_tr_b16 v[6:7], v241 offset:18432
  ds_read_b64_tr_b16 v[8:9], v241 offset:13312
  ds_read_b64_tr_b16 v[10:11], v241 offset:19456
  v_mfma_f32_16x16x32_bf16 v[64:67], v[24:27], a[252:255], v[64:67]
  s_waitcnt lgkmcnt(12)
  s_cmp_ge_u32 s62, 8
  s_cbranch_scc0 Lp9_slow
Lp9_ok:
  s_lshr_b32 s57, s71, 3
  s_add_u32 s57, s57, s76
  buffer_load_dwordx4 a[0:3], v252, s[28:31], s57 offen offset:0 sc1
  v_mfma_f32_16x16x32_bf16 v[80:83], v[28:31], a[12:15], 0
  ds_read_b64_tr_b16 v[12:13], v241 offset:14336
  ds_read_b64_tr_b16 v[14:15], v241 offset:20480
  ds_read_b64_tr_b16 v[16:17], v241 offset:24576
  ds_read_b64_tr_b16 v[18:19], v241 offset:30720
  v_mfma_f32_16x16x32_bf16 v[80:83], v[32:35], a[28:31], v[80:83]
  s_waitcnt lgkmcnt(12)
  ds_read_b64_tr_b16 v[20:21], v241 offset:25600
  ds_read_b64_tr_b16 v[22:23], v241 offset:31744
  v_mfma_f32_16x16x32_bf16 v[80:83], v[36:39], a[44:47], v[80:83]
  buffer_load_dwordx4 a[4:7], v252, s[28:31], s57 offen offset:1024 sc1
  ds_read_b64_tr_b16 v[24:25], v241 offset:26624
  ds_read_b64_tr_b16 v[26:27], v241 offset:32768
  v_mfma_f32_16x16x32_bf16 v[80:83], v[40:43], a[60:63], v[80:83]
  s_waitcnt lgkmcnt(12)
  s_add_u32 s57, s57, 2560
  ds_read_b64_tr_b16 v[28:29], v237 offset:0
  v_mfma_f32_16x16x32_bf16 v[80:83], v[44:47], a[76:79], v[80:83]
  ds_read_b64_tr_b16 v[30:31], v237 offset:6144
  ds_read_b64_tr_b16 v[32:33], v237 offset:1024
  ds_read_b64_tr_b16 v[34:35], v237 offset:7168
  v_mfma_f32_16x16x32_bf16 v[80:83], v[48:51], a[92:95], v[80:83]
  s_waitcnt lgkmcnt(12)
  buffer_load_dwordx4 a[8:11], v252, s[28:31], s57 offen offset:0 sc1
  v_mfma_f32_16x16x32_bf16 v[80:83], v[4:7], a[108:111], v[80:83]
  ds_read_b64_tr_b16 v[36:37], v237 offset:2048
  ds_read_b64_tr_b16 v[38:39], v237 offset:8192
  ds_read_b64_tr_b16 v[40:41], v237 offset:12288
  ds_read_b64_tr_b16 v[42:43], v237 offset:18432
  v_mfma_f32_16x16x32_bf16 v[80:83], v[8:11], a[124:127], v[80:83]
  s_waitcnt lgkmcnt(12)
  ds_read_b64_tr_b16 v[44:45], v237 offset:13312
  ds_read_b64_tr_b16 v[46:47], v237 offset:19456
  v_mfma_f32_16x16x32_bf16 v[80:83], v[12:15], a[140:143], v[80:83]
  buffer_load_dwordx4 a[16:19], v252, s[28:31], s57 offen offset:1024 sc1
  ds_read_b64_tr_b16 v[48:49], v237 offset:14336
  ds_read_b64_tr_b16 v[50:51], v237 offset:20480
  v_mfma_f32_16x16x32_bf16 v[80:83], v[16:19], a[156:159], v[80:83]
  s_waitcnt lgkmcnt(12)
  s_waitcnt vmcnt(4)
  v_mov_b32 v232, 1
  buffer_atomic_add v232, v254, s[28:31], s77 offen offset:128 sc0 sc1
  v_mfma_f32_16x16x32_bf16 v[80:83], v[20:23], v[200:203], v[80:83]
  ds_read_b64_tr_b16 v[4:5], v238 offset:24576
  ds_read_b64_tr_b16 v[6:7], v238 offset:30720
  ds_read_b64_tr_b16 v[8:9], v238 offset:25600
  ds_read_b64_tr_b16 v[10:11], v238 offset:31744
  v_mfma_f32_16x16x32_bf16 v[80:83], v[24:27], v[216:219], v[80:83]
  s_waitcnt lgkmcnt(12)
  s_add_u32 s57, s57, 2560
  buffer_load_dwordx4 a[20:23], v252, s[28:31], s57 offen offset:0 sc1
  v_mfma_f32_16x16x32_bf16 v[80:83], v[28:31], a[172:175], v[80:83]
  ds_read_b64_tr_b16 v[12:13], v238 offset:26624
  ds_read_b64_tr_b16 v[14:15], v238 offset:32768
  ds_read_b64_tr_b16 v[16:17], v238 offset:36864
  ds_read_b64_tr_b16 v[18:19], v238 offset:43008
  v_mfma_f32_16x16x32_bf16 v[80:83], v[32:35], a[188:191], v[80:83]
  s_waitcnt lgkmcnt(12)
  ds_read_b64_tr_b16 v[20:21], v238 offset:37888
  ds_read_b64_tr_b16 v[22:23], v238 offset:44032
  v_mfma_f32_16x16x32_bf16 v[80:83], v[36:39], a[204:207], v[80:83]
  buffer_load_dwordx4 a[24:27], v252, s[28:31], s57 offen offset:1024 sc1
  ds_read_b64_tr_b16 v[24:25], v238 offset:38912
  ds_read_b64_tr_b16 v[26:27], v238 offset:45056
  v_mfma_f32_16x16x32_bf16 v[80:83], v[40:43], a[220:223], v[80:83]
  s_waitcnt lgkmcnt(12)
  s_add_u32 s57, s57, 2560
  ds_read_b64_tr_b16 v[28:29], v242 offset:12288
  v_mfma_f32_16x16x32_bf16 v[80:83], v[44:47], a[236:239], v[80:83]
  ds_read_b64_tr_b16 v[30:31], v242 offset:18432
  ds_read_b64_tr_b16 v[32:33], v242 offset:13312
  ds_read_b64_tr_b16 v[34:35], v242 offset:19456
  v_mfma_f32_16x16x32_bf16 v[80:83], v[48:51], a[252:255], v[80:83]
  s_waitcnt lgkmcnt(12)
  buffer_load_dwordx4 a[32:35], v252, s[28:31], s57 offen offset:0 sc1
  v_mfma_f32_16x16x32_bf16 v[96:99], v[4:7], a[12:15], 0
  ds_read_b64_tr_b16 v[36:37], v242 offset:14336
  ds_read_b64_tr_b16 v[38:39], v242 offset:20480
  ds_read_b64_tr_b16 v[40:41], v242 offset:24576
  ds_read_b64_tr_b16 v[42:43], v242 offset:30720
  v_mfma_f32_16x16x32_bf16 v[96:99], v[8:11], a[28:31], v[96:99]
  s_waitcnt lgkmcnt(12)
  ds_read_b64_tr_b16 v[44:45], v242 offset:25600
  ds_read_b64_tr_b16 v[46:47], v242 offset:31744
  v_mfma_f32_16x16x32_bf16 v[96:99], v[12:15], a[44:47], v[96:99]
  buffer_load_dwordx4 a[36:39], v252, s[28:31], s57 offen offset:1024 sc1
  ds_read_b64_tr_b16 v[48:49], v242 offset:26624
  ds_read_b64_tr_b16 v[50:51], v242 offset:32768
  v_mfma_f32_16x16x32_bf16 v[96:99], v[16:19], a[60:63], v[96:99]
  s_waitcnt lgkmcnt(12)
  s_add_u32 s57, s76, s32
  ds_read_b64_tr_b16 v[4:5], v238 offset:0
  v_mfma_f32_16x16x32_bf16 v[96:99], v[20:23], a[76:79], v[96:99]
  ds_read_b64_tr_b16 v[6:7], v238 offset:6144
  ds_read_b64_tr_b16 v[8:9], v238 offset:1024
  ds_read_b64_tr_b16 v[10:11], v238 offset:7168
  v_mfma_f32_16x16x32_bf16 v[96:99], v[24:27], a[92:95], v[96:99]
  s_waitcnt lgkmcnt(12)
  buffer_load_dwordx2 a[72:73], v253, s[28:31], s57 offen offset:2048 sc1
  v_mfma_f32_16x16x32_bf16 v[96:99], v[28:31], a[108:111], v[96:99]
  ds_read_b64_tr_b16 v[12:13], v238 offset:2048
  ds_read_b64_tr_b16 v[14:15], v238 offset:8192
  ds_read_b64_tr_b16 v[16:17], v238 offset:12288
  ds_read_b64_tr_b16 v[18:19], v238 offset:18432
  v_mfma_f32_16x16x32_bf16 v[96:99], v[32:35], a[124:127], v[96:99]
  s_waitcnt lgkmcnt(12)
  s_add_u32 s57, s57, 2560
  buffer_load_dwordx2 a[74:75], v253, s[28:31], s57 offen offset:2048 sc1
  v_mfma_f32_16x16x32_bf16 v[96:99], v[36:39], a[140:143], v[96:99]
  ds_read_b64_tr_b16 v[20:21], v238 offset:13312
  ds_read_b64_tr_b16 v[22:23], v238 offset:19456
  ds_read_b64_tr_b16 v[24:25], v238 offset:14336
  ds_read_b64_tr_b16 v[26:27], v238 offset:20480
  v_mfma_f32_16x16x32_bf16 v[96:99], v[40:43], a[156:159], v[96:99]
  s_waitcnt lgkmcnt(12)
  s_add_u32 s57, s57, 2560
  buffer_load_dwordx2 a[80:81], v253, s[28:31], s57 offen offset:2048 sc1
  v_mfma_f32_16x16x32_bf16 v[96:99], v[44:47], v[200:203], v[96:99]
  ds_read_b64_tr_b16 v[28:29], v239 offset:24576
  ds_read_b64_tr_b16 v[30:31], v239 offset:30720
  ds_read_b64_tr_b16 v[32:33], v239 offset:25600
  ds_read_b64_tr_b16 v[34:35], v239 offset:31744
  v_mfma_f32_16x16x32_bf16 v[96:99], v[48:51], v[216:219], v[96:99]
  s_waitcnt lgkmcnt(12)
  s_add_u32 s57, s57, 2560
  buffer_load_dwordx2 a[82:83], v253, s[28:31], s57 offen offset:2048 sc1
  v_mfma_f32_16x16x32_bf16 v[96:99], v[4:7], a[172:175], v[96:99]
  ds_read_b64_tr_b16 v[36:37], v239 offset:26624
  ds_read_b64_tr_b16 v[38:39], v239 offset:32768
  ds_read_b64_tr_b16 v[40:41], v239 offset:36864
  ds_read_b64_tr_b16 v[42:43], v239 offset:43008
  v_mfma_f32_16x16x32_bf16 v[96:99], v[8:11], a[188:191], v[96:99]
  s_waitcnt lgkmcnt(12)
  s_add_u32 s57, s57, 2560
  buffer_load_dwordx2 a[84:85], v253, s[28:31], s57 offen offset:2048 sc1
  v_mfma_f32_16x16x32_bf16 v[96:99], v[12:15], a[204:207], v[96:99]
  ds_read_b64_tr_b16 v[44:45], v239 offset:37888
  ds_read_b64_tr_b16 v[46:47], v239 offset:44032
  ds_read_b64_tr_b16 v[48:49], v239 offset:38912
  ds_read_b64_tr_b16 v[50:51], v239 offset:45056
  v_mfma_f32_16x16x32_bf16 v[96:99], v[16:19], a[220:223], v[96:99]
  s_waitcnt lgkmcnt(12)
  s_add_u32 s57, s57, 2560
  buffer_load_dwordx2 a[86:87], v253, s[28:31], s57 offen offset:2048 sc1
  v_mfma_f32_16x16x32_bf16 v[96:99], v[20:23], a[236:239], v[96:99]
  ds_read_b64_tr_b16 v[4:5], v243 offset:12288
  ds_read_b64_tr_b16 v[6:7], v243 offset:18432
  ds_read_b64_tr_b16 v[8:9], v243 offset:13312
  ds_read_b64_tr_b16 v[10:11], v243 offset:19456
  v_mfma_f32_16x16x32_bf16 v[96:99], v[24:27], a[252:255], v[96:99]
  s_waitcnt lgkmcnt(12)
  s_add_u32 s57, s57, 2560
  buffer_load_dwordx2 a[88:89], v253, s[28:31], s57 offen offset:2048 sc1
  v_mfma_f32_16x16x32_bf16 v[112:115], v[28:31], a[12:15], 0
  ds_read_b64_tr_b16 v[12:13], v243 offset:14336
  ds_read_b64_tr_b16 v[14:15], v243 offset:20480
  ds_read_b64_tr_b16 v[16:17], v243 offset:24576
  ds_read_b64_tr_b16 v[18:19], v243 offset:30720
  v_mfma_f32_16x16x32_bf16 v[112:115], v[32:35], a[28:31], v[112:115]
  s_waitcnt lgkmcnt(12)
  s_add_u32 s57, s57, 2560
  buffer_load_dwordx2 a[90:91], v253, s[28:31], s57 offen offset:2048 sc1
  v_mfma_f32_16x16x32_bf16 v[112:115], v[36:39], a[44:47], v[112:115]
  ds_read_b64_tr_b16 v[20:21], v243 offset:25600
  ds_read_b64_tr_b16 v[22:23], v243 offset:31744
  ds_read_b64_tr_b16 v[24:25], v243 offset:26624
  ds_read_b64_tr_b16 v[26:27], v243 offset:32768
  v_mfma_f32_16x16x32_bf16 v[112:115], v[40:43], a[60:63], v[112:115]
  s_waitcnt lgkmcnt(12)
  ds_read_b64_tr_b16 v[28:29], v239 offset:0
  ds_read_b64_tr_b16 v[30:31], v239 offset:6144
  v_mfma_f32_16x16x32_bf16 v[112:115], v[44:47], a[76:79], v[112:115]
  ds_read_b64_tr_b16 v[32:33], v239 offset:1024
  ds_read_b64_tr_b16 v[34:35], v239 offset:7168
  v_mfma_f32_16x16x32_bf16 v[112:115], v[48:51], a[92:95], v[112:115]
  s_waitcnt lgkmcnt(12)
  ds_read_b64_tr_b16 v[36:37], v239 offset:2048
  ds_read_b64_tr_b16 v[38:39], v239 offset:8192
  v_mfma_f32_16x16x32_bf16 v[112:115], v[4:7], a[108:111], v[112:115]
  ds_read_b64_tr_b16 v[40:41], v239 offset:12288
  ds_read_b64_tr_b16 v[42:43], v239 offset:18432
  v_mfma_f32_16x16x32_bf16 v[112:115], v[8:11], a[124:127], v[112:115]
  s_waitcnt lgkmcnt(12)
  ds_read_b64_tr_b16 v[44:45], v239 offset:13312
  ds_read_b64_tr_b16 v[46:47], v239 offset:19456
  v_mfma_f32_16x16x32_bf16 v[112:115], v[12:15], a[140:143], v[112:115]
  ds_read_b64_tr_b16 v[48:49], v239 offset:14336
  ds_read_b64_tr_b16 v[50:51], v239 offset:20480
  v_mfma_f32_16x16x32_bf16 v[112:115], v[16:19], a[156:159], v[112:115]
  s_waitcnt lgkmcnt(12)
  v_mfma_f32_16x16x32_bf16 v[112:115], v[20:23], v[200:203], v[112:115]
  v_mfma_f32_16x16x32_bf16 v[112:115], v[24:27], v[216:219], v[112:115]
  s_waitcnt lgkmcnt(8)
  v_mfma_f32_16x16x32_bf16 v[112:115], v[28:31], a[172:175], v[112:115]
  v_mfma_f32_16x16x32_bf16 v[112:115], v[32:35], a[188:191], v[112:115]
  s_waitcnt lgkmcnt(4)
  v_mfma_f32_16x16x32_bf16 v[112:115], v[36:39], a[204:207], v[112:115]
  v_mfma_f32_16x16x32_bf16 v[112:115], v[40:43], a[220:223], v[112:115]
  s_waitcnt lgkmcnt(0)
  v_mfma_f32_16x16x32_bf16 v[112:115], v[44:47], a[236:239], v[112:115]
  v_mfma_f32_16x16x32_bf16 v[112:115], v[48:51], a[252:255], v[112:115]
  s_mov_b32 s12, s10
  s_and_b32 s13, s11, 0xffff
  s_mov_b32 s14, 2359296
  s_mov_b32 s15, 0x20000
  s_mul_i32 s59, s78, 18432
  s_lshl_b32 s57, s65, 5
  s_add_u32 s58, s32, s57
  s_add_u32 s58, s58, s59
  s_lshl_b32 s57, s65, 1
  s_add_u32 s57, s57, s79
  s_lshl_b32 s57, s57, 7
  s_add_u32 s59, s59, s57
  s_xor_b32 s57, s64, 1
  s_mul_i32 s57, s57, 2560
  s_add_u32 s46, s57, s76
  s_xor_b32 s57, s64, 2
  s_mul_i32 s57, s57, 2560
  s_add_u32 s47, s57, s76
  s_xor_b32 s57, s64, 3
  s_mul_i32 s57, s57, 2560
  s_add_u32 s48, s57, s76
  s_mov_b32 s63, 0
  s_waitcnt vmcnt(12)
  v_readfirstlane_b32 s62, v232
  v_mov_b32 v232, 0
  s_nop 1
  s_cmp_ge_u32 s62, 3
  s_cbranch_scc1 Lw10_ok
Lw10:
  buffer_atomic_add v232, v254, s[28:31], s77 offen offset:128 sc0 sc1
  s_add_u32 s63, s63, 1
  s_cmp_gt_u32 s63, 100000
  s_waitcnt vmcnt(0)
  v_readfirstlane_b32 s62, v232
  v_mov_b32 v232, 0
  s_cbranch_scc1 Lw10_ok
  s_nop 0
  s_cmp_ge_u32 s62, 4
  s_cbranch_scc0 Lw10
Lw10_ok:
  buffer_load_dwordx4 a[40:43], v252, s[28:31], s46 offen offset:0 sc1
  buffer_load_dwordx4 a[52:55], v252, s[28:31], s47 offen offset:0 sc1
  buffer_load_dwordx4 a[64:67], v252, s[28:31], s48 offen offset:0 sc1
  buffer_load_dwordx4 a[48:51], v252, s[28:31], s46 offen offset:1024 sc1
  buffer_load_dwordx4 a[56:59], v252, s[28:31], s47 offen offset:1024 sc1
  buffer_load_dwordx4 a[68:71], v252, s[28:31], s48 offen offset:1024 sc1
  s_waitcnt vmcnt(6)
  v_mfma_f32_16x16x16_bf16 v[52:55], v[126:127], a[72:73], 0
  v_mfma_f32_16x16x16_bf16 v[52:55], v[126:127], a[74:75], v[52:55]
  v_mfma_f32_16x16x16_bf16 v[52:55], v[126:127], a[80:81], v[52:55]
  v_mfma_f32_16x16x16_bf16 v[52:55], v[126:127], a[82:83], v[52:55]
  v_mfma_f32_16x16x16_bf16 v[52:55], v[126:127], a[84:85], v[52:55]
  v_mfma_f32_16x16x16_bf16 v[52:55], v[126:127], a[86:87], v[52:55]
  v_mfma_f32_16x16x16_bf16 v[52:55], v[126:127], a[88:89], v[52:55]
  v_mfma_f32_16x16x16_bf16 v[52:55], v[126:127], a[90:91], v[52:55]
  v_mfma_f32_16x16x32_bf16 v[64:67], v[126:129], a[0:3], v[64:67]
  v_mfma_f32_16x16x32_bf16 v[80:83], v[124:127], a[0:3], v[80:83]
  v_mfma_f32_16x16x32_bf16 v[96:99], v[126:129], a[4:7], v[96:99]
  v_mfma_f32_16x16x32_bf16 v[112:115], v[124:127], a[4:7], v[112:115]
  v_mfma_f32_16x16x32_bf16 v[64:67], v[126:129], a[8:11], v[64:67]
  v_mfma_f32_16x16x32_bf16 v[80:83], v[124:127], a[8:11], v[80:83]
L_hopb5:
  s_cbranch_execz L_mainb
  v_mfma_f32_16x16x32_bf16 v[96:99], v[126:129], a[16:19], v[96:99]
  v_mfma_f32_16x16x32_bf16 v[112:115], v[124:127], a[16:19], v[112:115]
  v_mfma_f32_16x16x32_bf16 v[64:67], v[126:129], a[20:23], v[64:67]
  v_mfma_f32_16x16x32_bf16 v[80:83], v[124:127], a[20:23], v[80:83]
  v_mfma_f32_16x16x32_bf16 v[96:99], v[126:129], a[24:27], v[96:99]
  v_mfma_f32_16x16x32_bf16 v[112:115], v[124:127], a[24:27], v[112:115]
  v_mfma_f32_16x16x32_bf16 v[64:67], v[126:129], a[32:35], v[64:67]
  v_mfma_f32_16x16x32_bf16 v[80:83], v[124:127], a[32:35], v[80:83]
  v_mfma_f32_16x16x32_bf16 v[96:99], v[126:129], a[36:39], v[96:99]
  v_mfma_f32_16x16x32_bf16 v[112:115], v[124:127], a[36:39], v[112:115]
  v_fmac_f32 v148, v52, v130
  v_fmac_f32 v149, v53, v130
  v_fmac_f32 v150, v54, v130
  v_fmac_f32 v151, v55, v130
  v_cvt_pk_bf16_f32 v148, v148, v149
  v_cvt_pk_bf16_f32 v149, v150, v151
  buffer_store_dwordx2 v[148:149], v117, s[12:15], s58 offen offset:1024
  s_waitcnt vmcnt(4)
  v_mfma_f32_16x16x32_bf16 v[64:67], v[126:129], a[40:43], v[64:67]
  v_mfma_f32_16x16x32_bf16 v[80:83], v[124:127], a[40:43], v[80:83]
  v_mfma_f32_16x16x32_bf16 v[64:67], v[126:129], a[52:55], v[64:67]
  v_mfma_f32_16x16x32_bf16 v[80:83], v[124:127], a[52:55], v[80:83]
  v_mfma_f32_16x16x32_bf16 v[64:67], v[126:129], a[64:67], v[64:67]
  v_mfma_f32_16x16x32_bf16 v[80:83], v[124:127], a[64:67], v[80:83]
  s_waitcnt vmcnt(1)
  v_mfma_f32_16x16x32_bf16 v[96:99], v[126:129], a[48:51], v[96:99]
  v_mfma_f32_16x16x32_bf16 v[112:115], v[124:127], a[48:51], v[112:115]
  v_mfma_f32_16x16x32_bf16 v[96:99], v[126:129], a[56:59], v[96:99]
  v_mfma_f32_16x16x32_bf16 v[112:115], v[124:127], a[56:59], v[112:115]
  v_mfma_f32_16x16x32_bf16 v[96:99], v[126:129], a[68:71], v[96:99]
  v_mfma_f32_16x16x32_bf16 v[112:115], v[124:127], a[68:71], v[112:115]
  v_fmac_f32 v132, v64, v130
  v_fmac_f32 v133, v65, v130
  v_fmac_f32 v134, v66, v130
  v_fmac_f32 v135, v67, v130
  v_fmac_f32 v136, v80, v130
  v_fmac_f32 v137, v81, v130
  v_fmac_f32 v138, v82, v130
  v_fmac_f32 v139, v83, v130
  v_cvt_pk_bf16_f32 v220, v132, v133
  v_cvt_pk_bf16_f32 v222, v136, v137
  v_cvt_pk_bf16_f32 v221, v134, v135
  v_cvt_pk_bf16_f32 v223, v138, v139
  v_permlane16_swap_b32 v220, v222
  s_nop 0
  v_permlane16_swap_b32 v221, v223
  buffer_store_dwordx4 v[220:223], v116, s[12:15], s59 offen offset:0
  v_fmac_f32 v140, v96, v130
  v_fmac_f32 v141, v97, v130
  v_fmac_f32 v142, v98, v130
  v_fmac_f32 v143, v99, v130
  v_fmac_f32 v144, v112, v130
  v_fmac_f32 v145, v113, v130
  v_fmac_f32 v146, v114, v130
  v_fmac_f32 v147, v115, v130
  v_cvt_pk_bf16_f32 v224, v140, v141
  v_cvt_pk_bf16_f32 v226, v144, v145
  v_cvt_pk_bf16_f32 v225, v142, v143
  v_cvt_pk_bf16_f32 v227, v146, v147
  v_permlane16_swap_b32 v224, v226
  s_nop 0
  v_permlane16_swap_b32 v225, v227
  buffer_store_dwordx4 v[224:227], v116, s[12:15], s59 offen offset:64
L_end:
  s_endpgm
Lp1_slow:
  s_mov_b32 s51, 0
Lp1_spin:
  buffer_load_dword v16, off, s[32:35], 0 offset:0 sc1
  s_add_u32 s51, s51, 1
  s_waitcnt vmcnt(0)
  v_readfirstlane_b32 s50, v16
  s_cmp_gt_u32 s51, 100000
  s_cbranch_scc1 Lp1_ok
  s_nop 0
  s_cmp_ge_u32 s50, 10
  s_cbranch_scc1 Lp1_ok
  s_branch Lp1_spin
Lp2_slow:
  s_mov_b32 s71, 0
Lp2_spin:
  buffer_load_dword v99, off, s[32:35], 0 offset:128 sc1
  s_add_u32 s71, s71, 1
  s_waitcnt vmcnt(0)
  v_readfirstlane_b32 s70, v99
  s_cmp_gt_u32 s71, 100000
  s_cbranch_scc1 Lp2_ok
  s_nop 0
  s_cmp_ge_u32 s70, 72
  s_cbranch_scc1 Lp2_ok
  s_branch Lp2_spin
Lp5_slow:
  s_mov_b32 s63, 0
Lp5_spin:
  v_mov_b32 v255, 0
  buffer_atomic_add v255, v254, s[28:31], s42 offen offset:0 sc0 sc1
  s_add_u32 s63, s63, 1
  s_waitcnt vmcnt(0)
  v_readfirstlane_b32 s62, v255
  s_cmp_gt_u32 s63, 100000
  s_cbranch_scc1 Lp5_ok
  s_nop 0
  s_cmp_ge_u32 s62, 4
  s_cbranch_scc1 Lp5_ok
  s_branch Lp5_spin
Lp6_slow:
  s_mov_b32 s63, 0
Lp6_spin:
  buffer_load_dword v255, off, s[28:31], s36 offset:4 sc1
  s_add_u32 s63, s63, 1
  s_waitcnt vmcnt(0)
  v_readfirstlane_b32 s62, v255
  s_cmp_gt_u32 s63, 100000
  s_cbranch_scc1 Lp6_ok
  s_nop 0
  s_cmp_ge_u32 s62, 8
  s_cbranch_scc1 Lp6_ok
  s_branch Lp6_spin
Lp7_slow:
  s_mov_b32 s63, 0
Lp7_spin:
  v_mov_b32 v255, 0
  buffer_atomic_add v255, v254, s[28:31], s42 offen offset:128 sc0 sc1
  s_add_u32 s63, s63, 1
  s_waitcnt vmcnt(0)
  v_readfirstlane_b32 s62, v255
  s_cmp_gt_u32 s63, 100000
  s_cbranch_scc1 Lp7_ok
  s_nop 0
  s_cmp_ge_u32 s62, 4
  s_cbranch_scc1 Lp7_ok
  s_branch Lp7_spin
Lp8_slow:
  s_mov_b32 s63, 0
Lp8_spin:
  v_mov_b32 v255, 0
  buffer_atomic_add v255, v254, s[28:31], s42 offen offset:256 sc0 sc1
  s_add_u32 s63, s63, 1
  s_waitcnt vmcnt(0)
  v_readfirstlane_b32 s62, v255
  s_cmp_gt_u32 s63, 100000
  s_cbranch_scc1 Lp8_ok
  s_nop 0
  s_cmp_ge_u32 s62, 4
  s_cbranch_scc1 Lp8_ok
  s_branch Lp8_spin
Lp9_slow:
  s_mov_b32 s63, 0
Lp9_spin:
  v_mov_b32 v255, 0
  buffer_atomic_add v255, v254, s[28:31], s43 offen offset:0 sc0 sc1
  s_add_u32 s63, s63, 1
  s_waitcnt vmcnt(0)
  v_readfirstlane_b32 s62, v255
  s_cmp_gt_u32 s63, 100000
  s_cbranch_scc1 Lp9_ok
  s_nop 0
  s_cmp_ge_u32 s62, 8
  s_cbranch_scc1 Lp9_ok
  s_branch Lp9_spin
L_code_end:
.section .rodata,"a"
.p2align 6
.amdhsa_kernel sequential_preLN__linear_kernel_hedgehog__glu_gated_bilinear__prompt_kernel
  .amdhsa_next_free_vgpr 512
  .amdhsa_next_free_sgpr 80
  .amdhsa_accum_offset 256
  .amdhsa_group_segment_fixed_size 0
  .amdhsa_kernarg_size 88
  .amdhsa_user_sgpr_count 2
  .amdhsa_user_sgpr_kernarg_segment_ptr 1
  .amdhsa_system_sgpr_workgroup_id_x 1
  .amdhsa_float_denorm_mode_32 3
.end_amdhsa_kernel
```
